```python
import torch

def _softmax(x, axis=-1):
    return torch.softmax(x, dim=axis)
def _gelu(x):
    return torch.nn.functional.gelu(x, approximate="tanh")
def _silu(x):
    return torch.nn.functional.silu(x)
def _sigmoid(x):
    return torch.sigmoid(x)
def _layernorm(x, axis=-1, eps=1e-5):
    m = x.mean(dim=axis, keepdim=True)
    v = x.var(dim=axis, keepdim=True, unbiased=False)
    return (x - m) / torch.sqrt(v + eps)
def _scatter_add(tgt, idx, src, axis=0):
    return tgt.clone().index_add_(axis, idx, src)
def _segment_sum(src, seg, n):
    out = torch.zeros((n,) + src.shape[1:], dtype=src.dtype)
    return out.index_add_(0, seg, src)
def _pad(x, pw):
    flat = tuple(v for pair in reversed(pw) for v in pair)
    return torch.nn.functional.pad(x, flat)

kernel_name = 'concat_heads__gqa_block_cached__gqa_block_cached__near_ridge'

def setup_inputs():

    _w = (lambda a: (lambda t: t.to(torch.bfloat16) if t.is_floating_point() else t)(torch.as_tensor(a)))
    def _A_setup():
        B, Sq, D = 8, 144, 576
        Hq, Hkv, Sk, Dh = 32, 16, 1024, 128
        assert Hq % Hkv == 0, (Hq, Hkv)
        return {
            "x": _w((lambda *s: torch.randn(*s, dtype=torch.bfloat16) * 0.8)(B, Sq, D)),
            "k_cache": _w((lambda *s: torch.randn(*s, dtype=torch.bfloat16) * 0.8)(B, Hkv, Sk, Dh)),
            "v_cache": _w((lambda *s: torch.randn(*s, dtype=torch.bfloat16) * 0.05)(B, Hkv, Sk, Dh)),
            "wq": _w((lambda *s: torch.randn(*s, dtype=torch.bfloat16) * 0.8)(D, Hq * Dh) * (D ** -0.5)),
            "wo": _w((lambda *s: torch.randn(*s, dtype=torch.bfloat16) * 0.05)(Hq * Dh, D) * ((Hq * Dh) ** -0.5)),
        }
    _A_in = _A_setup()

    def _B_setup():
        B, Sq, D = 8, 144, 576
        Hq, Hkv, Sk, Dh = 32, 16, 1024, 128
        assert Hq % Hkv == 0, (Hq, Hkv)
        return {
            "x": _w((lambda *s: torch.randn(*s, dtype=torch.bfloat16) * 0.8)(B, Sq, D)),
            "k_cache": _w((lambda *s: torch.randn(*s, dtype=torch.bfloat16) * 0.8)(B, Hkv, Sk, Dh)),
            "v_cache": _w((lambda *s: torch.randn(*s, dtype=torch.bfloat16) * 0.05)(B, Hkv, Sk, Dh)),
            "wq": _w((lambda *s: torch.randn(*s, dtype=torch.bfloat16) * 0.8)(D, Hq * Dh) * (D ** -0.5)),
            "wo": _w((lambda *s: torch.randn(*s, dtype=torch.bfloat16) * 0.05)(Hq * Dh, D) * ((Hq * Dh) ** -0.5)),
        }
    _B_in = _B_setup()

    return {
        "A_x": _A_in["x"],
        "A_k_cache": _A_in["k_cache"],
        "A_v_cache": _A_in["v_cache"],
        "A_wq": _A_in["wq"],
        "A_wo": _A_in["wo"],
        "B_x": _B_in["x"],
        "B_k_cache": _B_in["k_cache"],
        "B_v_cache": _B_in["v_cache"],
        "B_wq": _B_in["wq"],
        "B_wo": _B_in["wo"],
    }

def reference(A_x, A_k_cache, A_v_cache, A_wq, A_wo, B_x, B_k_cache, B_v_cache, B_wq, B_wo):
    def _A_ref(x, k_cache, v_cache, wq, wo):
        B, Sq, D = x.shape
        Hq, Dh = 32, 128
        Hkv = k_cache.shape[1]
        rep = Hq // Hkv
        q = (lambda x, *d: x.permute(*d))((x @ wq).reshape(B, Sq, Hq, Dh), 0, 2, 1, 3)
        k = (lambda x, n, axis: torch.repeat_interleave(x, n, dim=axis))(k_cache, rep, axis=1)
        v = (lambda x, n, axis: torch.repeat_interleave(x, n, dim=axis))(v_cache, rep, axis=1)
        scores = torch.einsum("bhqd,bhkd->bhqk", q, k) * (Dh ** -0.5)
        p = _softmax(scores, axis=-1)
        o = torch.einsum("bhqk,bhkd->bhqd", p, v)
        return (lambda x, *d: x.permute(*d))(o, 0, 2, 1, 3).reshape(B, Sq, Hq * Dh) @ wo

    def _B_ref(x, k_cache, v_cache, wq, wo):
        B, Sq, D = x.shape
        Hq, Dh = 32, 128
        Hkv = k_cache.shape[1]
        rep = Hq // Hkv
        q = (lambda x, *d: x.permute(*d))((x @ wq).reshape(B, Sq, Hq, Dh), 0, 2, 1, 3)
        k = (lambda x, n, axis: torch.repeat_interleave(x, n, dim=axis))(k_cache, rep, axis=1)
        v = (lambda x, n, axis: torch.repeat_interleave(x, n, dim=axis))(v_cache, rep, axis=1)
        scores = torch.einsum("bhqd,bhkd->bhqk", q, k) * (Dh ** -0.5)
        p = _softmax(scores, axis=-1)
        o = torch.einsum("bhqk,bhkd->bhqd", p, v)
        return (lambda x, *d: x.permute(*d))(o, 0, 2, 1, 3).reshape(B, Sq, Hq * Dh) @ wo

    a = _A_ref(A_x, A_k_cache, A_v_cache, A_wq, A_wo)
    b = _B_ref(B_x, B_k_cache, B_v_cache, B_wq, B_wo)
    return torch.concatenate([a, b], axis=-1)
```

```asm
; @launch grid=(256,1,1) block=(256,1,1) lds=163840
.amdgcn_target "amdgcn-amd-amdhsa--gfx950"
.text
.globl concat_heads__gqa_block_cached__gqa_block_cached__near_ridge_kernel
.p2align 8
.type concat_heads__gqa_block_cached__gqa_block_cached__near_ridge_kernel,@function
concat_heads__gqa_block_cached__gqa_block_cached__near_ridge_kernel:
L_begin:
    s_cmp_ge_u32 s2, 256
    s_cbranch_scc1 L_exit
    s_bfe_u32 s4, s2, 0x10002
    s_mul_i32 s52, s4, 40
    s_load_dwordx8 s[8:15], s[0:1], s52
    s_load_dwordx2 s[16:17], s[0:1], 96
    s_load_dwordx4 s[96:99], s[0:1], 80
    s_add_u32 s52, s52, 32
    s_load_dwordx2 s[18:19], s[0:1], s52
    v_lshrrev_b32 v1, 6, v0
    s_and_b32 s5, s2, 3
    s_lshl_b32 s5, s5, 2
    s_bfe_u32 s52, s2, 0x20003
    s_add_u32 s5, s5, s52
    s_lshr_b32 s6, s2, 5
    v_readfirstlane_b32 s3, v1
    s_mov_b32 s49, 0
    s_and_b32 s7, s3, 1
L_front:
    v_mbcnt_lo_u32_b32 v90, -1, 0
    v_mbcnt_hi_u32_b32 v90, -1, v90
    v_and_b32 v91, 3, v90
    v_lshlrev_b32 v91, 4, v91
    v_bfe_u32 v92, v90, 2, 2
    v_lshl_add_u32 v91, v92, 13, v91
    v_lshrrev_b32 v92, 4, v90
    v_lshl_add_u32 v91, v92, 6, v91
    s_lshr_b32 s52, s3, 1
    s_lshl_b32 s52, s52, 8
    s_lshl_b32 s53, s7, 17
    s_add_u32 s52, s52, s53
    v_add_u32 v80, s52, v91
    v_add_u32 v81, 31744, v80
    v_xor_b32 v91, 32, v80
    v_add_u32 v82, 63488, v91
    v_add_u32 v83, 95232, v91
    v_bfe_u32 v91, v90, 2, 3
    v_mul_u32_u24 v91, 1152, v91
    v_lshrrev_b32 v92, 5, v90
    v_lshl_add_u32 v91, v92, 6, v91
    v_bfe_u32 v92, v90, 4, 1
    v_lshlrev_b32 v92, 1, v92
    v_and_b32 v93, 3, v90
    v_xor_b32 v92, v92, v93
    v_lshl_add_u32 v91, v92, 4, v91
    s_mul_i32 s52, s3, 36864
    v_add_u32 v84, s52, v91
    v_add_u32 v85, 8192, v84
    v_add_u32 v86, 16384, v84
    v_add_u32 v87, 24576, v84
    s_mul_i32 s52, s3, 9216
    s_add_u32 s52, s52, 147456
    v_add_u32 v88, s52, v91
    s_lshl_b32 s81, s3, 12
    s_lshl_b32 s52, s3, 10
    s_mov_b32 s53, 159744
    s_cmp_lt_u32 s3, 2
    s_cselect_b32 s60, 49152, s53
    s_add_u32 s60, s60, s52
    s_cmp_lt_u32 s3, 2
    s_cselect_b32 s61, 100352, s53
    s_add_u32 s61, s61, s52
    s_cmp_lt_u32 s3, 2
    s_cselect_b32 s62, 151552, s53
    s_add_u32 s62, s62, s52
    s_lshr_b32 s52, s6, 0
    s_mul_i32 s52, s52, 3
    s_and_b32 s53, s5, 3
    s_mul_i32 s53, s53, 3
    s_add_u32 s52, s52, s53
    s_mul_i32 s53, s52, 57
    s_lshr_b32 s53, s53, 9
    s_mul_i32 s53, s53, 9
    s_sub_u32 s52, s52, s53
    s_lshl_b32 s82, s52, 7
    s_add_u32 s83, s82, 128
    s_cmp_eq_u32 s83, 1152
    s_cselect_b32 s83, 0, s83
    s_add_u32 s84, s83, 128
    s_cmp_eq_u32 s84, 1152
    s_cselect_b32 s84, 0, s84
    s_add_u32 s85, s84, 128
    s_cmp_eq_u32 s85, 1152
    s_cselect_b32 s85, 0, s85
    s_add_u32 s86, s85, 128
    s_cmp_eq_u32 s86, 1152
    s_cselect_b32 s86, 0, s86
    s_add_u32 s87, s86, 128
    s_cmp_eq_u32 s87, 1152
    s_cselect_b32 s87, 0, s87
    s_add_u32 s88, s87, 128
    s_cmp_eq_u32 s88, 1152
    s_cselect_b32 s88, 0, s88
    s_add_u32 s89, s88, 128
    s_cmp_eq_u32 s89, 1152
    s_cselect_b32 s89, 0, s89
    s_add_u32 s90, s89, 128
    s_cmp_eq_u32 s90, 1152
    s_cselect_b32 s90, 0, s90
    s_waitcnt lgkmcnt(0)
    s_mul_i32 s52, s6, 165888
    s_add_u32 s20, s8, s52
    s_addc_u32 s21, s9, 0
    s_mov_b32 s22, 165888
    s_mov_b32 s23, 0x00020000
    s_lshl_b32 s52, s5, 9
    s_add_u32 s24, s14, s52
    s_addc_u32 s25, s15, 0
    s_sub_u32 s26, 4718592, s52
    s_mov_b32 s27, 0x00020000
    s_lshl_b32 s52, s6, 4
    s_add_u32 s52, s52, s5
    s_lshl_b32 s52, s52, 18
    s_add_u32 s28, s10, s52
    s_addc_u32 s29, s11, 0
    s_mov_b32 s30, 262144
    s_mov_b32 s31, 0x00020000
    s_add_u32 s32, s12, s52
    s_addc_u32 s33, s13, 0
    s_mov_b32 s34, 262144
    s_mov_b32 s35, 0x00020000
    s_add_u32 m0, s81, 32768
    s_nop 0
    buffer_load_dwordx4 v84, s[20:23], s82 offen offset:0 lds
    buffer_load_dwordx4 v85, s[20:23], s82 offen offset:1024 lds
    buffer_load_dwordx4 v86, s[20:23], s82 offen offset:2048 lds
    buffer_load_dwordx4 v87, s[20:23], s82 offen offset:3072 lds
    s_mov_b32 m0, s60
    s_nop 0
    buffer_load_dwordx4 v88, s[20:23], s82 offen lds
    s_add_u32 m0, s81, 0
    s_lshl_b32 s91, s82, 12
    buffer_load_dwordx4 v80, s[24:27], s91 offen offset:0 lds
    buffer_load_dwordx4 v81, s[24:27], s91 offen offset:1024 lds
    buffer_load_dwordx4 v82, s[24:27], s91 offen offset:2048 lds
    buffer_load_dwordx4 v83, s[24:27], s91 offen offset:3072 lds
    s_add_u32 m0, s81, 16384
    s_add_u32 s91, s91, 262144
    buffer_load_dwordx4 v80, s[24:27], s91 offen offset:0 lds
    buffer_load_dwordx4 v81, s[24:27], s91 offen offset:1024 lds
    buffer_load_dwordx4 v82, s[24:27], s91 offen offset:2048 lds
    buffer_load_dwordx4 v83, s[24:27], s91 offen offset:3072 lds
    s_getpc_b64 s[54:55]
L_pc1:
    s_sub_u32 s54, s54, L_pc1-L_begin
    s_subb_u32 s55, s55, 0
    s_and_b32 s52, s6, 1
    s_lshl_b32 s52, s52, 2
    s_add_u32 s52, s52, s3
    s_lshl_b32 s52, s52, 13
    v_lshlrev_b32 v91, 7, v90
    v_add_u32 v91, s52, v91
    s_mov_b32 s53, L_end-L_begin-4
    v_min_u32 v91, s53, v91
    global_load_dword a184, v91, s[54:55]
    v_mbcnt_lo_u32_b32 v70, -1, 0
    v_mbcnt_hi_u32_b32 v70, -1, v70
    v_bfe_u32 v71, v70, 2, 2
    v_lshlrev_b32 v71, 10, v71
    v_and_b32 v72, 3, v70
    v_lshl_add_u32 v71, v72, 6, v71
    v_lshrrev_b32 v73, 4, v70
    v_bfe_u32 v72, v70, 2, 1
    v_lshlrev_b32 v72, 1, v72
    v_xor_b32 v72, v72, v73
    s_lshl_b32 s52, s7, 1
    v_xor_b32 v72, s52, v72
    v_lshl_add_u32 v71, v72, 4, v71
    s_lshl_b32 s53, s7, 13
    v_add_u32 v0, s53, v71
    v_xor_b32 v1, 0x2000, v0
    v_lshlrev_b32 v71, 10, v73
    v_bfe_u32 v72, v70, 2, 2
    v_lshl_add_u32 v71, v72, 6, v71
    v_and_b32 v72, 3, v70
    v_lshl_add_u32 v71, v72, 3, v71
    v_and_b32 v72, 1, v73
    v_lshl_add_u32 v71, v72, 5, v71
    s_add_u32 s53, s53, 65536
    v_add_u32 v2, s53, v71
    v_xor_b32 v3, 32, v2
    v_xor_b32 v4, 0x2000, v2
    v_xor_b32 v5, 32, v4
    v_and_b32 v71, 3, v70
    v_lshlrev_b32 v71, 4, v71
    v_bfe_u32 v72, v70, 2, 2
    v_lshl_add_u32 v71, v72, 8, v71
    v_lshl_add_u32 v6, v73, 6, v71
    v_xor_b32 v7, 32, v6
    v_mov_b32 v8, v6
    v_mov_b32 v9, v7
    v_lshrrev_b32 v93, 4, v90
    v_lshlrev_b32 v91, 11, v93
    v_bfe_u32 v92, v90, 2, 2
    v_lshl_add_u32 v91, v92, 6, v91
    v_and_b32 v92, 1, v90
    v_lshl_add_u32 v91, v92, 4, v91
    v_bfe_u32 v92, v90, 1, 1
    v_lshl_add_u32 v91, v92, 3, v91
    v_and_b32 v92, 1, v93
    v_xor_b32 v92, s7, v92
    v_lshl_add_u32 v91, v92, 5, v91
    s_lshr_b32 s52, s3, 1
    s_lshl_b32 s53, s52, 13
    v_add_u32 v64, s53, v91
    v_xor_b32 v65, 32, v64
    v_bfe_u32 v91, v90, 3, 1
    v_lshlrev_b32 v91, 10, v91
    v_and_b32 v92, 7, v90
    v_lshl_add_u32 v91, v92, 6, v91
    v_bfe_u32 v92, v90, 2, 1
    v_lshlrev_b32 v92, 1, v92
    v_xor_b32 v92, v92, v93
    v_lshl_add_u32 v91, v92, 4, v91
    v_add_u32 v67, 49152, v91
    s_lshl_b32 s53, s7, 13
    s_add_u32 s53, s53, 32768
    v_add_u32 v66, s53, v91
    v_lshlrev_b32 v91, 4, v90
    v_add_u32 v13, s81, v91
    v_add_u32 v26, 65536, v13
    s_lshl_b32 s52, s52, 12
    s_add_u32 s52, s52, 153600
    s_lshl_b32 s53, s7, 9
    v_xor_b32 v91, s53, v91
    v_add_u32 v69, s52, v91
    v_and_b32 v91, 31, v90
    v_lshlrev_b32 v91, 4, v91
    v_lshrrev_b32 v92, 5, v90
    v_lshl_add_u32 v91, v92, 3, v91
    s_add_u32 s52, s52, s53
    v_add_u32 v68, s52, v91
    s_mov_b32 s50, 0x3e0293ee
    v_mov_b32 v10, 0
    v_mov_b32 v11, 0
    v_mov_b32 v12, 0
    v_lshrrev_b32 v91, 3, v90
    v_mul_u32_u24 v92, 1152, v91
    v_lshrrev_b32 v91, 4, v90
    v_lshlrev_b32 v91, 1, v91
    v_and_b32 v29, 7, v90
    v_xor_b32 v91, v91, v29
    v_lshl_add_u32 v91, v91, 4, v92
    s_mul_i32 s52, s3, 1179648
    v_add_u32 v28, s52, v91
    v_add_u32 v29, 8192, v28
    v_add_u32 v30, 16384, v28
    v_add_u32 v31, 24576, v28
    v_lshrrev_b32 v91, 5, v90
    v_lshlrev_b32 v91, 10, v91
    v_bfe_u32 v92, v90, 2, 3
    v_lshl_add_u32 v91, v92, 7, v91
    v_and_b32 v92, 3, v90
    v_lshl_add_u32 v91, v92, 3, v91
    v_add_u32 v91, s81, v91
    v_bfe_u32 v92, v90, 3, 2
    v_xor_b32 v92, s3, v92
    v_lshl_add_u32 v14, v92, 5, v91
    v_xor_b32 v15, 32, v14
    v_xor_b32 v16, 64, v14
    v_xor_b32 v17, 96, v14
    v_xor_b32 v18, 65536, v14
    v_xor_b32 v19, 65568, v14
    v_xor_b32 v20, 65600, v14
    v_xor_b32 v21, 65632, v14
    v_xor_b32 v22, 131072, v14
    v_xor_b32 v23, 131104, v14
    v_xor_b32 v24, 131136, v14
    v_xor_b32 v25, 131168, v14
    v_lshlrev_b32 v27, 8, v90
    s_mov_b32 s51, 16384
    s_lshr_b32 s53, s2, 3
    s_lshl_b32 s53, s53, 2
    s_and_b32 s52, s2, 3
    s_add_u32 s53, s53, s52
    s_mul_i32 s52, s3, 1179648
    s_mul_i32 s53, s53, 9216
    s_add_u32 s52, s52, s53
    s_add_u32 s52, s52, 0
    s_add_u32 s40, s18, s52
    s_addc_u32 s41, s19, 0
    s_mov_b32 s42, 9216
    s_mov_b32 s43, 0x00020000
    s_add_u32 m0, s81, 83968
    s_nop 0
    buffer_load_dwordx4 v84, s[20:23], s83 offen offset:0 lds
    buffer_load_dwordx4 v85, s[20:23], s83 offen offset:1024 lds
    buffer_load_dwordx4 v86, s[20:23], s83 offen offset:2048 lds
    buffer_load_dwordx4 v87, s[20:23], s83 offen offset:3072 lds
    s_mov_b32 m0, s61
    s_nop 0
    buffer_load_dwordx4 v88, s[20:23], s83 offen lds
    s_add_u32 m0, s81, 51200
    s_lshl_b32 s91, s83, 12
    buffer_load_dwordx4 v80, s[24:27], s91 offen offset:0 lds
    buffer_load_dwordx4 v81, s[24:27], s91 offen offset:1024 lds
    buffer_load_dwordx4 v82, s[24:27], s91 offen offset:2048 lds
    buffer_load_dwordx4 v83, s[24:27], s91 offen offset:3072 lds
    s_waitcnt vmcnt(14) lgkmcnt(0)
    s_barrier
    s_mov_b32 s56, 0x3f803f80
    ds_read_b64_tr_b16 a[0:1], v64 offset:0
    ds_read_b64_tr_b16 a[2:3], v64 offset:1024
    ds_read_b128 a[32:35], v66 offset:0
    s_waitcnt lgkmcnt(0)
    v_mfma_f32_16x16x32_bf16 v[128:131], a[0:3], a[32:35], 0
    ds_read_b128 a[36:39], v66 offset:2048
    ds_read_b128 a[40:43], v66 offset:4096
    s_waitcnt lgkmcnt(1)
    v_mfma_f32_16x16x32_bf16 v[160:163], a[0:3], a[36:39], 0
    s_waitcnt lgkmcnt(0)
    ds_read_b128 a[44:47], v66 offset:6144
    ds_read_b128 a[48:51], v67 offset:0
    v_mfma_f32_16x16x32_bf16 v[192:195], a[0:3], a[40:43], 0
    s_waitcnt lgkmcnt(1)
    ds_read_b64_tr_b16 a[4:5], v65 offset:0
    ds_read_b64_tr_b16 a[6:7], v65 offset:1024
    v_mfma_f32_16x16x32_bf16 v[224:227], a[0:3], a[44:47], 0
    s_waitcnt lgkmcnt(2)
    ds_read_b64_tr_b16 a[8:9], v64 offset:256
    ds_read_b64_tr_b16 a[10:11], v64 offset:1280
    v_mfma_f32_16x16x32_bf16 v[112:115], a[0:3], a[48:51], 0
    s_waitcnt lgkmcnt(2)
    ds_read_b64_tr_b16 a[12:13], v65 offset:256
    ds_read_b64_tr_b16 a[14:15], v65 offset:1280
    v_mfma_f32_16x16x32_bf16 v[132:135], a[4:7], a[32:35], 0
    ds_read_b64_tr_b16 a[16:17], v64 offset:512
    ds_read_b64_tr_b16 a[18:19], v64 offset:1536
    v_mfma_f32_16x16x32_bf16 v[164:167], a[4:7], a[36:39], 0
    ds_read_b64_tr_b16 a[20:21], v65 offset:512
    ds_read_b64_tr_b16 a[22:23], v65 offset:1536
    v_mfma_f32_16x16x32_bf16 v[196:199], a[4:7], a[40:43], 0
    ds_read_b64_tr_b16 a[24:25], v64 offset:768
    ds_read_b64_tr_b16 a[26:27], v64 offset:1792
    v_mfma_f32_16x16x32_bf16 v[228:231], a[4:7], a[44:47], 0
    s_waitcnt lgkmcnt(6)
    ds_read_b64_tr_b16 a[28:29], v65 offset:768
    ds_read_b64_tr_b16 a[30:31], v65 offset:1792
    v_mfma_f32_16x16x32_bf16 v[136:139], a[8:11], a[32:35], 0
    s_add_u32 m0, s81, 67584
    s_add_u32 s91, s91, 262144
    v_accvgpr_write_b32 a180, s56
    v_mfma_f32_16x16x32_bf16 v[168:171], a[8:11], a[36:39], 0
    v_accvgpr_write_b32 a181, s56
    v_accvgpr_write_b32 a182, s56
    v_mfma_f32_16x16x32_bf16 v[200:203], a[8:11], a[40:43], 0
    v_accvgpr_write_b32 a183, s56
    v_mfma_f32_16x16x32_bf16 v[232:235], a[8:11], a[44:47], 0
    v_mfma_f32_16x16x32_bf16 v[116:119], a[8:11], a[48:51], 0
    s_waitcnt vmcnt(10) lgkmcnt(0)
    s_barrier
    ds_read_b64_tr_b16 a[52:53], v64 offset:16384
    v_mfma_f32_16x16x32_bf16 v[140:143], a[12:15], a[32:35], 0
    buffer_load_dwordx4 v80, s[24:27], s91 offen offset:0 lds
    v_mfma_f32_16x16x32_bf16 v[172:175], a[12:15], a[36:39], 0
    buffer_load_dwordx4 v81, s[24:27], s91 offen offset:1024 lds
    v_mfma_f32_16x16x32_bf16 v[204:207], a[12:15], a[40:43], 0
    buffer_load_dwordx4 v82, s[24:27], s91 offen offset:2048 lds
    v_mfma_f32_16x16x32_bf16 v[236:239], a[12:15], a[44:47], 0
    buffer_load_dwordx4 v83, s[24:27], s91 offen offset:3072 lds
    v_mfma_f32_16x16x32_bf16 v[144:147], a[16:19], a[32:35], 0
    s_add_u32 m0, s81, 135168
    ds_read_b64_tr_b16 a[54:55], v64 offset:17408
    ds_read_b128 a[84:87], v66 offset:512
    v_mfma_f32_16x16x32_bf16 v[176:179], a[16:19], a[36:39], 0
    buffer_load_dwordx4 v84, s[20:23], s84 offen offset:0 lds
    v_mfma_f32_16x16x32_bf16 v[208:211], a[16:19], a[40:43], 0
    ds_read_b128 a[88:91], v66 offset:2560
    ds_read_b128 a[92:95], v66 offset:4608
    v_mfma_f32_16x16x32_bf16 v[240:243], a[16:19], a[44:47], 0
    ds_read_b128 a[96:99], v66 offset:6656
    ds_read_b128 a[100:103], v67 offset:512
    v_mfma_f32_16x16x32_bf16 v[120:123], a[16:19], a[48:51], 0
    buffer_load_dwordx4 v85, s[20:23], s84 offen offset:1024 lds
    v_mfma_f32_16x16x32_bf16 v[148:151], a[20:23], a[32:35], 0
    ds_read_b64_tr_b16 a[56:57], v65 offset:16384
    ds_read_b64_tr_b16 a[58:59], v65 offset:17408
    v_mfma_f32_16x16x32_bf16 v[180:183], a[20:23], a[36:39], 0
    ds_read_b64_tr_b16 a[60:61], v64 offset:16640
    ds_read_b64_tr_b16 a[62:63], v64 offset:17664
    v_mfma_f32_16x16x32_bf16 v[212:215], a[20:23], a[40:43], 0
    ds_read_b64_tr_b16 a[64:65], v65 offset:16640
    ds_read_b64_tr_b16 a[66:67], v65 offset:17664
    v_mfma_f32_16x16x32_bf16 v[244:247], a[20:23], a[44:47], 0
    buffer_load_dwordx4 v86, s[20:23], s84 offen offset:2048 lds
    v_mfma_f32_16x16x32_bf16 v[152:155], a[24:27], a[32:35], 0
    ds_read_b64_tr_b16 a[68:69], v64 offset:16896
    ds_read_b64_tr_b16 a[70:71], v64 offset:17920
    v_mfma_f32_16x16x32_bf16 v[184:187], a[24:27], a[36:39], 0
    ds_read_b64_tr_b16 a[72:73], v65 offset:16896
    ds_read_b64_tr_b16 a[74:75], v65 offset:17920
    v_mfma_f32_16x16x32_bf16 v[216:219], a[24:27], a[40:43], 0
    ds_read_b64_tr_b16 a[76:77], v64 offset:17152
    ds_read_b64_tr_b16 a[78:79], v64 offset:18176
    v_mfma_f32_16x16x32_bf16 v[248:251], a[24:27], a[44:47], 0
    buffer_load_dwordx4 v87, s[20:23], s84 offen offset:3072 lds
    v_mfma_f32_16x16x32_bf16 v[124:127], a[24:27], a[48:51], 0
    ds_read_b64_tr_b16 a[80:81], v65 offset:17152
    ds_read_b64_tr_b16 a[82:83], v65 offset:18176
    v_mfma_f32_16x16x32_bf16 v[156:159], a[28:31], a[32:35], 0
    v_add_u32 v64, 51200, v64
    v_add_u32 v65, 51200, v65
    v_mfma_f32_16x16x32_bf16 v[188:191], a[28:31], a[36:39], 0
    s_mov_b32 m0, s62
    v_add_u32 v66, 51200, v66
    v_add_u32 v67, 51200, v67
    v_mfma_f32_16x16x32_bf16 v[220:223], a[28:31], a[40:43], 0
    buffer_load_dwordx4 v88, s[20:23], s84 offen lds
    v_mfma_f32_16x16x32_bf16 v[252:255], a[28:31], a[44:47], 0
    s_waitcnt lgkmcnt(0)
    v_mfma_f32_16x16x32_bf16 v[128:131], a[52:55], a[84:87], v[128:131]
    v_mfma_f32_16x16x32_bf16 v[160:163], a[52:55], a[88:91], v[160:163]
    s_waitcnt vmcnt(9) lgkmcnt(0)
    s_barrier
    s_add_u32 m0, s81, 102400
    v_mfma_f32_16x16x32_bf16 v[192:195], a[52:55], a[92:95], v[192:195]
    s_lshl_b32 s91, s84, 12
    buffer_load_dwordx4 v80, s[24:27], s91 offen offset:0 lds
    v_mfma_f32_16x16x32_bf16 v[224:227], a[52:55], a[96:99], v[224:227]
    ds_read_b64_tr_b16 a[0:1], v64 offset:0
    ds_read_b64_tr_b16 a[2:3], v64 offset:1024
    v_mfma_f32_16x16x32_bf16 v[112:115], a[52:55], a[100:103], v[112:115]
    ds_read_b128 a[32:35], v66 offset:0
    v_mfma_f32_16x16x32_bf16 v[132:135], a[56:59], a[84:87], v[132:135]
    ds_read_b128 a[36:39], v66 offset:2048
    v_mfma_f32_16x16x32_bf16 v[164:167], a[56:59], a[88:91], v[164:167]
    buffer_load_dwordx4 v81, s[24:27], s91 offen offset:1024 lds
    v_mfma_f32_16x16x32_bf16 v[196:199], a[56:59], a[92:95], v[196:199]
    ds_read_b128 a[40:43], v66 offset:4096
    ds_read_b128 a[44:47], v66 offset:6144
    v_mfma_f32_16x16x32_bf16 v[228:231], a[56:59], a[96:99], v[228:231]
    ds_read_b128 a[48:51], v67 offset:0
    v_mfma_f32_16x16x32_bf16 v[136:139], a[60:63], a[84:87], v[136:139]
    ds_read_b64_tr_b16 a[4:5], v65 offset:0
    v_mfma_f32_16x16x32_bf16 v[168:171], a[60:63], a[88:91], v[168:171]
    buffer_load_dwordx4 v82, s[24:27], s91 offen offset:2048 lds
    v_mfma_f32_16x16x32_bf16 v[200:203], a[60:63], a[92:95], v[200:203]
    ds_read_b64_tr_b16 a[6:7], v65 offset:1024
    ds_read_b64_tr_b16 a[8:9], v64 offset:256
    v_mfma_f32_16x16x32_bf16 v[232:235], a[60:63], a[96:99], v[232:235]
    ds_read_b64_tr_b16 a[10:11], v64 offset:1280
    v_mfma_f32_16x16x32_bf16 v[116:119], a[60:63], a[100:103], v[116:119]
    ds_read_b64_tr_b16 a[12:13], v65 offset:256
    v_mfma_f32_16x16x32_bf16 v[140:143], a[64:67], a[84:87], v[140:143]
    buffer_load_dwordx4 v83, s[24:27], s91 offen offset:3072 lds
    v_mfma_f32_16x16x32_bf16 v[172:175], a[64:67], a[88:91], v[172:175]
    ds_read_b64_tr_b16 a[14:15], v65 offset:1280
    ds_read_b64_tr_b16 a[16:17], v64 offset:512
    v_mfma_f32_16x16x32_bf16 v[204:207], a[64:67], a[92:95], v[204:207]
    ds_read_b64_tr_b16 a[18:19], v64 offset:1536
    v_mfma_f32_16x16x32_bf16 v[236:239], a[64:67], a[96:99], v[236:239]
    s_add_u32 m0, s81, 118784
    s_add_u32 s91, s91, 262144
    ds_read_b64_tr_b16 a[20:21], v65 offset:512
    v_mfma_f32_16x16x32_bf16 v[144:147], a[68:71], a[84:87], v[144:147]
    buffer_load_dwordx4 v80, s[24:27], s91 offen offset:0 lds
    v_mfma_f32_16x16x32_bf16 v[176:179], a[68:71], a[88:91], v[176:179]
    ds_read_b64_tr_b16 a[22:23], v65 offset:1536
    ds_read_b64_tr_b16 a[24:25], v64 offset:768
    v_mfma_f32_16x16x32_bf16 v[208:211], a[68:71], a[92:95], v[208:211]
    ds_read_b64_tr_b16 a[26:27], v64 offset:1792
    v_mfma_f32_16x16x32_bf16 v[240:243], a[68:71], a[96:99], v[240:243]
    ds_read_b64_tr_b16 a[28:29], v65 offset:768
    v_mfma_f32_16x16x32_bf16 v[120:123], a[68:71], a[100:103], v[120:123]
    buffer_load_dwordx4 v81, s[24:27], s91 offen offset:1024 lds
    v_mfma_f32_16x16x32_bf16 v[148:151], a[72:75], a[84:87], v[148:151]
    ds_read_b64_tr_b16 a[30:31], v65 offset:1792
    v_mfma_f32_16x16x32_bf16 v[180:183], a[72:75], a[88:91], v[180:183]
    v_mfma_f32_16x16x32_bf16 v[212:215], a[72:75], a[92:95], v[212:215]
    v_mfma_f32_16x16x32_bf16 v[244:247], a[72:75], a[96:99], v[244:247]
    buffer_load_dwordx4 v82, s[24:27], s91 offen offset:2048 lds
    v_mfma_f32_16x16x32_bf16 v[152:155], a[76:79], a[84:87], v[152:155]
    v_mfma_f32_16x16x32_bf16 v[184:187], a[76:79], a[88:91], v[184:187]
    v_mfma_f32_16x16x32_bf16 v[216:219], a[76:79], a[92:95], v[216:219]
    v_mfma_f32_16x16x32_bf16 v[248:251], a[76:79], a[96:99], v[248:251]
    buffer_load_dwordx4 v83, s[24:27], s91 offen offset:3072 lds
    v_mfma_f32_16x16x32_bf16 v[124:127], a[76:79], a[100:103], v[124:127]
    v_mfma_f32_16x16x32_bf16 v[156:159], a[80:83], a[84:87], v[156:159]
    v_mfma_f32_16x16x32_bf16 v[188:191], a[80:83], a[88:91], v[188:191]
    s_add_u32 m0, s81, 32768
    v_mfma_f32_16x16x32_bf16 v[220:223], a[80:83], a[92:95], v[220:223]
    buffer_load_dwordx4 v84, s[20:23], s85 offen offset:0 lds
    v_mfma_f32_16x16x32_bf16 v[252:255], a[80:83], a[96:99], v[252:255]
    s_waitcnt lgkmcnt(0)
    v_mfma_f32_16x16x32_bf16 v[128:131], a[0:3], a[32:35], v[128:131]
    v_mfma_f32_16x16x32_bf16 v[160:163], a[0:3], a[36:39], v[160:163]
    s_waitcnt vmcnt(14) lgkmcnt(0)
    s_barrier
    v_mfma_f32_16x16x32_bf16 v[192:195], a[0:3], a[40:43], v[192:195]
    buffer_load_dwordx4 v85, s[20:23], s85 offen offset:1024 lds
    v_mfma_f32_16x16x32_bf16 v[224:227], a[0:3], a[44:47], v[224:227]
    ds_read_b64_tr_b16 a[52:53], v64 offset:16384
    ds_read_b64_tr_b16 a[54:55], v64 offset:17408
    v_mfma_f32_16x16x32_bf16 v[112:115], a[0:3], a[48:51], v[112:115]
    ds_read_b128 a[84:87], v66 offset:512
    v_mfma_f32_16x16x32_bf16 v[132:135], a[4:7], a[32:35], v[132:135]
    ds_read_b128 a[88:91], v66 offset:2560
    v_mfma_f32_16x16x32_bf16 v[164:167], a[4:7], a[36:39], v[164:167]
    buffer_load_dwordx4 v86, s[20:23], s85 offen offset:2048 lds
    v_mfma_f32_16x16x32_bf16 v[196:199], a[4:7], a[40:43], v[196:199]
    ds_read_b128 a[92:95], v66 offset:4608
    ds_read_b128 a[96:99], v66 offset:6656
    v_mfma_f32_16x16x32_bf16 v[228:231], a[4:7], a[44:47], v[228:231]
    ds_read_b128 a[100:103], v67 offset:512
    v_mfma_f32_16x16x32_bf16 v[136:139], a[8:11], a[32:35], v[136:139]
    ds_read_b64_tr_b16 a[56:57], v65 offset:16384
    v_mfma_f32_16x16x32_bf16 v[168:171], a[8:11], a[36:39], v[168:171]
    buffer_load_dwordx4 v87, s[20:23], s85 offen offset:3072 lds
    v_mfma_f32_16x16x32_bf16 v[200:203], a[8:11], a[40:43], v[200:203]
    ds_read_b64_tr_b16 a[58:59], v65 offset:17408
    ds_read_b64_tr_b16 a[60:61], v64 offset:16640
    v_mfma_f32_16x16x32_bf16 v[232:235], a[8:11], a[44:47], v[232:235]
    ds_read_b64_tr_b16 a[62:63], v64 offset:17664
    v_mfma_f32_16x16x32_bf16 v[116:119], a[8:11], a[48:51], v[116:119]
    s_mov_b32 m0, s60
    ds_read_b64_tr_b16 a[64:65], v65 offset:16640
    v_mfma_f32_16x16x32_bf16 v[140:143], a[12:15], a[32:35], v[140:143]
    buffer_load_dwordx4 v88, s[20:23], s85 offen lds
    v_mfma_f32_16x16x32_bf16 v[172:175], a[12:15], a[36:39], v[172:175]
    ds_read_b64_tr_b16 a[66:67], v65 offset:17664
    ds_read_b64_tr_b16 a[68:69], v64 offset:16896
    v_mfma_f32_16x16x32_bf16 v[204:207], a[12:15], a[40:43], v[204:207]
    ds_read_b64_tr_b16 a[70:71], v64 offset:17920
    v_mfma_f32_16x16x32_bf16 v[236:239], a[12:15], a[44:47], v[236:239]
    s_add_u32 m0, s81, 0
    s_lshl_b32 s91, s85, 12
    ds_read_b64_tr_b16 a[72:73], v65 offset:16896
    v_mfma_f32_16x16x32_bf16 v[144:147], a[16:19], a[32:35], v[144:147]
    buffer_load_dwordx4 v80, s[24:27], s91 offen offset:0 lds
    v_mfma_f32_16x16x32_bf16 v[176:179], a[16:19], a[36:39], v[176:179]
    ds_read_b64_tr_b16 a[74:75], v65 offset:17920
    ds_read_b64_tr_b16 a[76:77], v64 offset:17152
    v_mfma_f32_16x16x32_bf16 v[208:211], a[16:19], a[40:43], v[208:211]
    ds_read_b64_tr_b16 a[78:79], v64 offset:18176
    v_mfma_f32_16x16x32_bf16 v[240:243], a[16:19], a[44:47], v[240:243]
    ds_read_b64_tr_b16 a[80:81], v65 offset:17152
    v_mfma_f32_16x16x32_bf16 v[120:123], a[16:19], a[48:51], v[120:123]
    buffer_load_dwordx4 v81, s[24:27], s91 offen offset:1024 lds
    v_mfma_f32_16x16x32_bf16 v[148:151], a[20:23], a[32:35], v[148:151]
    ds_read_b64_tr_b16 a[82:83], v65 offset:18176
    v_add_u32 v64, 51200, v64
    v_mfma_f32_16x16x32_bf16 v[180:183], a[20:23], a[36:39], v[180:183]
    v_add_u32 v65, 51200, v65
    v_mfma_f32_16x16x32_bf16 v[212:215], a[20:23], a[40:43], v[212:215]
    v_add_u32 v66, 51200, v66
    v_mfma_f32_16x16x32_bf16 v[244:247], a[20:23], a[44:47], v[244:247]
    buffer_load_dwordx4 v82, s[24:27], s91 offen offset:2048 lds
    v_mfma_f32_16x16x32_bf16 v[152:155], a[24:27], a[32:35], v[152:155]
    v_add_u32 v67, 51200, v67
    v_mfma_f32_16x16x32_bf16 v[184:187], a[24:27], a[36:39], v[184:187]
    v_mfma_f32_16x16x32_bf16 v[216:219], a[24:27], a[40:43], v[216:219]
    v_mfma_f32_16x16x32_bf16 v[248:251], a[24:27], a[44:47], v[248:251]
    buffer_load_dwordx4 v83, s[24:27], s91 offen offset:3072 lds
    v_mfma_f32_16x16x32_bf16 v[124:127], a[24:27], a[48:51], v[124:127]
    v_mfma_f32_16x16x32_bf16 v[156:159], a[28:31], a[32:35], v[156:159]
    v_mfma_f32_16x16x32_bf16 v[188:191], a[28:31], a[36:39], v[188:191]
    s_add_u32 m0, s81, 16384
    s_add_u32 s91, s91, 262144
    v_mfma_f32_16x16x32_bf16 v[220:223], a[28:31], a[40:43], v[220:223]
    buffer_load_dwordx4 v80, s[24:27], s91 offen offset:0 lds
    v_mfma_f32_16x16x32_bf16 v[252:255], a[28:31], a[44:47], v[252:255]
    s_waitcnt lgkmcnt(0)
    v_mfma_f32_16x16x32_bf16 v[128:131], a[52:55], a[84:87], v[128:131]
    v_mfma_f32_16x16x32_bf16 v[160:163], a[52:55], a[88:91], v[160:163]
    s_waitcnt vmcnt(14) lgkmcnt(0)
    s_barrier
    v_mfma_f32_16x16x32_bf16 v[192:195], a[52:55], a[92:95], v[192:195]
    buffer_load_dwordx4 v81, s[24:27], s91 offen offset:1024 lds
    v_mfma_f32_16x16x32_bf16 v[224:227], a[52:55], a[96:99], v[224:227]
    ds_read_b64_tr_b16 a[0:1], v64 offset:0
    ds_read_b64_tr_b16 a[2:3], v64 offset:1024
    v_mfma_f32_16x16x32_bf16 v[112:115], a[52:55], a[100:103], v[112:115]
    ds_read_b128 a[32:35], v66 offset:0
    v_mfma_f32_16x16x32_bf16 v[132:135], a[56:59], a[84:87], v[132:135]
    ds_read_b128 a[36:39], v66 offset:2048
    v_mfma_f32_16x16x32_bf16 v[164:167], a[56:59], a[88:91], v[164:167]
    buffer_load_dwordx4 v82, s[24:27], s91 offen offset:2048 lds
    v_mfma_f32_16x16x32_bf16 v[196:199], a[56:59], a[92:95], v[196:199]
    ds_read_b128 a[40:43], v66 offset:4096
    ds_read_b128 a[44:47], v66 offset:6144
    v_mfma_f32_16x16x32_bf16 v[228:231], a[56:59], a[96:99], v[228:231]
    ds_read_b128 a[48:51], v67 offset:0
    v_mfma_f32_16x16x32_bf16 v[136:139], a[60:63], a[84:87], v[136:139]
    ds_read_b64_tr_b16 a[4:5], v65 offset:0
    v_mfma_f32_16x16x32_bf16 v[168:171], a[60:63], a[88:91], v[168:171]
    buffer_load_dwordx4 v83, s[24:27], s91 offen offset:3072 lds
    v_mfma_f32_16x16x32_bf16 v[200:203], a[60:63], a[92:95], v[200:203]
    ds_read_b64_tr_b16 a[6:7], v65 offset:1024
    ds_read_b64_tr_b16 a[8:9], v64 offset:256
    v_mfma_f32_16x16x32_bf16 v[232:235], a[60:63], a[96:99], v[232:235]
    ds_read_b64_tr_b16 a[10:11], v64 offset:1280
    v_mfma_f32_16x16x32_bf16 v[116:119], a[60:63], a[100:103], v[116:119]
    s_add_u32 m0, s81, 83968
    ds_read_b64_tr_b16 a[12:13], v65 offset:256
    v_mfma_f32_16x16x32_bf16 v[140:143], a[64:67], a[84:87], v[140:143]
    buffer_load_dwordx4 v84, s[20:23], s86 offen offset:0 lds
    v_mfma_f32_16x16x32_bf16 v[172:175], a[64:67], a[88:91], v[172:175]
    ds_read_b64_tr_b16 a[14:15], v65 offset:1280
    ds_read_b64_tr_b16 a[16:17], v64 offset:512
    v_mfma_f32_16x16x32_bf16 v[204:207], a[64:67], a[92:95], v[204:207]
    ds_read_b64_tr_b16 a[18:19], v64 offset:1536
    v_mfma_f32_16x16x32_bf16 v[236:239], a[64:67], a[96:99], v[236:239]
    ds_read_b64_tr_b16 a[20:21], v65 offset:512
    v_mfma_f32_16x16x32_bf16 v[144:147], a[68:71], a[84:87], v[144:147]
    buffer_load_dwordx4 v85, s[20:23], s86 offen offset:1024 lds
    v_mfma_f32_16x16x32_bf16 v[176:179], a[68:71], a[88:91], v[176:179]
    ds_read_b64_tr_b16 a[22:23], v65 offset:1536
    ds_read_b64_tr_b16 a[24:25], v64 offset:768
    v_mfma_f32_16x16x32_bf16 v[208:211], a[68:71], a[92:95], v[208:211]
    ds_read_b64_tr_b16 a[26:27], v64 offset:1792
    v_mfma_f32_16x16x32_bf16 v[240:243], a[68:71], a[96:99], v[240:243]
    ds_read_b64_tr_b16 a[28:29], v65 offset:768
    v_mfma_f32_16x16x32_bf16 v[120:123], a[68:71], a[100:103], v[120:123]
    buffer_load_dwordx4 v86, s[20:23], s86 offen offset:2048 lds
    v_mfma_f32_16x16x32_bf16 v[148:151], a[72:75], a[84:87], v[148:151]
    ds_read_b64_tr_b16 a[30:31], v65 offset:1792
    v_mfma_f32_16x16x32_bf16 v[180:183], a[72:75], a[88:91], v[180:183]
    v_mfma_f32_16x16x32_bf16 v[212:215], a[72:75], a[92:95], v[212:215]
    v_mfma_f32_16x16x32_bf16 v[244:247], a[72:75], a[96:99], v[244:247]
    buffer_load_dwordx4 v87, s[20:23], s86 offen offset:3072 lds
    v_mfma_f32_16x16x32_bf16 v[152:155], a[76:79], a[84:87], v[152:155]
    v_mfma_f32_16x16x32_bf16 v[184:187], a[76:79], a[88:91], v[184:187]
    v_mfma_f32_16x16x32_bf16 v[216:219], a[76:79], a[92:95], v[216:219]
    s_mov_b32 m0, s61
    v_mfma_f32_16x16x32_bf16 v[248:251], a[76:79], a[96:99], v[248:251]
    buffer_load_dwordx4 v88, s[20:23], s86 offen lds
    v_mfma_f32_16x16x32_bf16 v[124:127], a[76:79], a[100:103], v[124:127]
    v_mfma_f32_16x16x32_bf16 v[156:159], a[80:83], a[84:87], v[156:159]
    v_mfma_f32_16x16x32_bf16 v[188:191], a[80:83], a[88:91], v[188:191]
    s_add_u32 m0, s81, 51200
    s_lshl_b32 s91, s86, 12
    v_mfma_f32_16x16x32_bf16 v[220:223], a[80:83], a[92:95], v[220:223]
    buffer_load_dwordx4 v80, s[24:27], s91 offen offset:0 lds
    v_mfma_f32_16x16x32_bf16 v[252:255], a[80:83], a[96:99], v[252:255]
    s_waitcnt lgkmcnt(0)
    v_mfma_f32_16x16x32_bf16 v[128:131], a[0:3], a[32:35], v[128:131]
    v_mfma_f32_16x16x32_bf16 v[160:163], a[0:3], a[36:39], v[160:163]
    s_waitcnt vmcnt(19) lgkmcnt(0)
    s_barrier
    v_mfma_f32_16x16x32_bf16 v[192:195], a[0:3], a[40:43], v[192:195]
    buffer_load_dwordx4 v81, s[24:27], s91 offen offset:1024 lds
    v_mfma_f32_16x16x32_bf16 v[224:227], a[0:3], a[44:47], v[224:227]
    ds_read_b64_tr_b16 a[52:53], v64 offset:16384
    ds_read_b64_tr_b16 a[54:55], v64 offset:17408
    v_mfma_f32_16x16x32_bf16 v[112:115], a[0:3], a[48:51], v[112:115]
    ds_read_b128 a[84:87], v66 offset:512
    v_mfma_f32_16x16x32_bf16 v[132:135], a[4:7], a[32:35], v[132:135]
    ds_read_b128 a[88:91], v66 offset:2560
    v_mfma_f32_16x16x32_bf16 v[164:167], a[4:7], a[36:39], v[164:167]
    buffer_load_dwordx4 v82, s[24:27], s91 offen offset:2048 lds
    v_mfma_f32_16x16x32_bf16 v[196:199], a[4:7], a[40:43], v[196:199]
    ds_read_b128 a[92:95], v66 offset:4608
    ds_read_b128 a[96:99], v66 offset:6656
    v_mfma_f32_16x16x32_bf16 v[228:231], a[4:7], a[44:47], v[228:231]
    ds_read_b128 a[100:103], v67 offset:512
    v_mfma_f32_16x16x32_bf16 v[136:139], a[8:11], a[32:35], v[136:139]
    ds_read_b64_tr_b16 a[56:57], v65 offset:16384
    v_mfma_f32_16x16x32_bf16 v[168:171], a[8:11], a[36:39], v[168:171]
    buffer_load_dwordx4 v83, s[24:27], s91 offen offset:3072 lds
    v_mfma_f32_16x16x32_bf16 v[200:203], a[8:11], a[40:43], v[200:203]
    ds_read_b64_tr_b16 a[58:59], v65 offset:17408
    ds_read_b64_tr_b16 a[60:61], v64 offset:16640
    v_mfma_f32_16x16x32_bf16 v[232:235], a[8:11], a[44:47], v[232:235]
    ds_read_b64_tr_b16 a[62:63], v64 offset:17664
    v_mfma_f32_16x16x32_bf16 v[116:119], a[8:11], a[48:51], v[116:119]
    s_add_u32 m0, s81, 67584
    s_add_u32 s91, s91, 262144
    ds_read_b64_tr_b16 a[64:65], v65 offset:16640
    v_mfma_f32_16x16x32_bf16 v[140:143], a[12:15], a[32:35], v[140:143]
    buffer_load_dwordx4 v80, s[24:27], s91 offen offset:0 lds
    v_mfma_f32_16x16x32_bf16 v[172:175], a[12:15], a[36:39], v[172:175]
    ds_read_b64_tr_b16 a[66:67], v65 offset:17664
    ds_read_b64_tr_b16 a[68:69], v64 offset:16896
    v_mfma_f32_16x16x32_bf16 v[204:207], a[12:15], a[40:43], v[204:207]
    ds_read_b64_tr_b16 a[70:71], v64 offset:17920
    v_mfma_f32_16x16x32_bf16 v[236:239], a[12:15], a[44:47], v[236:239]
    ds_read_b64_tr_b16 a[72:73], v65 offset:16896
    v_mfma_f32_16x16x32_bf16 v[144:147], a[16:19], a[32:35], v[144:147]
    buffer_load_dwordx4 v81, s[24:27], s91 offen offset:1024 lds
    v_mfma_f32_16x16x32_bf16 v[176:179], a[16:19], a[36:39], v[176:179]
    ds_read_b64_tr_b16 a[74:75], v65 offset:17920
    ds_read_b64_tr_b16 a[76:77], v64 offset:17152
    v_mfma_f32_16x16x32_bf16 v[208:211], a[16:19], a[40:43], v[208:211]
    ds_read_b64_tr_b16 a[78:79], v64 offset:18176
    v_mfma_f32_16x16x32_bf16 v[240:243], a[16:19], a[44:47], v[240:243]
    ds_read_b64_tr_b16 a[80:81], v65 offset:17152
    v_mfma_f32_16x16x32_bf16 v[120:123], a[16:19], a[48:51], v[120:123]
    buffer_load_dwordx4 v82, s[24:27], s91 offen offset:2048 lds
    v_mfma_f32_16x16x32_bf16 v[148:151], a[20:23], a[32:35], v[148:151]
    ds_read_b64_tr_b16 a[82:83], v65 offset:18176
    v_add_u32 v64, -102400, v64
    v_mfma_f32_16x16x32_bf16 v[180:183], a[20:23], a[36:39], v[180:183]
    v_add_u32 v65, -102400, v65
    v_mfma_f32_16x16x32_bf16 v[212:215], a[20:23], a[40:43], v[212:215]
    v_add_u32 v66, -102400, v66
    v_mfma_f32_16x16x32_bf16 v[244:247], a[20:23], a[44:47], v[244:247]
    buffer_load_dwordx4 v83, s[24:27], s91 offen offset:3072 lds
    v_mfma_f32_16x16x32_bf16 v[152:155], a[24:27], a[32:35], v[152:155]
    v_add_u32 v67, -102400, v67
    v_mfma_f32_16x16x32_bf16 v[184:187], a[24:27], a[36:39], v[184:187]
    v_mfma_f32_16x16x32_bf16 v[216:219], a[24:27], a[40:43], v[216:219]
    s_add_u32 m0, s81, 102400
    s_lshl_b32 s91, s87, 12
    v_mfma_f32_16x16x32_bf16 v[248:251], a[24:27], a[44:47], v[248:251]
    buffer_load_dwordx4 v80, s[24:27], s91 offen offset:0 lds
    v_mfma_f32_16x16x32_bf16 v[124:127], a[24:27], a[48:51], v[124:127]
    v_mfma_f32_16x16x32_bf16 v[156:159], a[28:31], a[32:35], v[156:159]
    v_mfma_f32_16x16x32_bf16 v[188:191], a[28:31], a[36:39], v[188:191]
    v_mfma_f32_16x16x32_bf16 v[220:223], a[28:31], a[40:43], v[220:223]
    buffer_load_dwordx4 v81, s[24:27], s91 offen offset:1024 lds
    v_mfma_f32_16x16x32_bf16 v[252:255], a[28:31], a[44:47], v[252:255]
    s_waitcnt lgkmcnt(0)
    v_mfma_f32_16x16x32_bf16 v[128:131], a[52:55], a[84:87], v[128:131]
    v_mfma_f32_16x16x32_bf16 v[160:163], a[52:55], a[88:91], v[160:163]
    s_waitcnt vmcnt(19) lgkmcnt(0)
    s_barrier
    v_mfma_f32_16x16x32_bf16 v[192:195], a[52:55], a[92:95], v[192:195]
    buffer_load_dwordx4 v82, s[24:27], s91 offen offset:2048 lds
    v_mfma_f32_16x16x32_bf16 v[224:227], a[52:55], a[96:99], v[224:227]
    ds_read_b64_tr_b16 a[0:1], v64 offset:0
    ds_read_b64_tr_b16 a[2:3], v64 offset:1024
    v_mfma_f32_16x16x32_bf16 v[112:115], a[52:55], a[100:103], v[112:115]
    ds_read_b128 a[32:35], v66 offset:0
    v_mfma_f32_16x16x32_bf16 v[132:135], a[56:59], a[84:87], v[132:135]
    ds_read_b128 a[36:39], v66 offset:2048
    v_mfma_f32_16x16x32_bf16 v[164:167], a[56:59], a[88:91], v[164:167]
    buffer_load_dwordx4 v83, s[24:27], s91 offen offset:3072 lds
    v_mfma_f32_16x16x32_bf16 v[196:199], a[56:59], a[92:95], v[196:199]
    ds_read_b128 a[40:43], v66 offset:4096
    ds_read_b128 a[44:47], v66 offset:6144
    v_mfma_f32_16x16x32_bf16 v[228:231], a[56:59], a[96:99], v[228:231]
    ds_read_b128 a[48:51], v67 offset:0
    v_mfma_f32_16x16x32_bf16 v[136:139], a[60:63], a[84:87], v[136:139]
    s_add_u32 m0, s81, 135168
    ds_read_b64_tr_b16 a[4:5], v65 offset:0
    v_mfma_f32_16x16x32_bf16 v[168:171], a[60:63], a[88:91], v[168:171]
    buffer_load_dwordx4 v84, s[20:23], s87 offen offset:0 lds
    v_mfma_f32_16x16x32_bf16 v[200:203], a[60:63], a[92:95], v[200:203]
    ds_read_b64_tr_b16 a[6:7], v65 offset:1024
    ds_read_b64_tr_b16 a[8:9], v64 offset:256
    v_mfma_f32_16x16x32_bf16 v[232:235], a[60:63], a[96:99], v[232:235]
    ds_read_b64_tr_b16 a[10:11], v64 offset:1280
    v_mfma_f32_16x16x32_bf16 v[116:119], a[60:63], a[100:103], v[116:119]
    ds_read_b64_tr_b16 a[12:13], v65 offset:256
    v_mfma_f32_16x16x32_bf16 v[140:143], a[64:67], a[84:87], v[140:143]
    buffer_load_dwordx4 v85, s[20:23], s87 offen offset:1024 lds
    v_mfma_f32_16x16x32_bf16 v[172:175], a[64:67], a[88:91], v[172:175]
    ds_read_b64_tr_b16 a[14:15], v65 offset:1280
    ds_read_b64_tr_b16 a[16:17], v64 offset:512
    v_mfma_f32_16x16x32_bf16 v[204:207], a[64:67], a[92:95], v[204:207]
    ds_read_b64_tr_b16 a[18:19], v64 offset:1536
    v_mfma_f32_16x16x32_bf16 v[236:239], a[64:67], a[96:99], v[236:239]
    ds_read_b64_tr_b16 a[20:21], v65 offset:512
    v_mfma_f32_16x16x32_bf16 v[144:147], a[68:71], a[84:87], v[144:147]
    buffer_load_dwordx4 v86, s[20:23], s87 offen offset:2048 lds
    v_mfma_f32_16x16x32_bf16 v[176:179], a[68:71], a[88:91], v[176:179]
    ds_read_b64_tr_b16 a[22:23], v65 offset:1536
    ds_read_b64_tr_b16 a[24:25], v64 offset:768
    v_mfma_f32_16x16x32_bf16 v[208:211], a[68:71], a[92:95], v[208:211]
    ds_read_b64_tr_b16 a[26:27], v64 offset:1792
    v_mfma_f32_16x16x32_bf16 v[240:243], a[68:71], a[96:99], v[240:243]
    ds_read_b64_tr_b16 a[28:29], v65 offset:768
    v_mfma_f32_16x16x32_bf16 v[120:123], a[68:71], a[100:103], v[120:123]
    buffer_load_dwordx4 v87, s[20:23], s87 offen offset:3072 lds
    v_mfma_f32_16x16x32_bf16 v[148:151], a[72:75], a[84:87], v[148:151]
    ds_read_b64_tr_b16 a[30:31], v65 offset:1792
    v_mfma_f32_16x16x32_bf16 v[180:183], a[72:75], a[88:91], v[180:183]
    v_mfma_f32_16x16x32_bf16 v[212:215], a[72:75], a[92:95], v[212:215]
    s_mov_b32 m0, s62
    v_mfma_f32_16x16x32_bf16 v[244:247], a[72:75], a[96:99], v[244:247]
    buffer_load_dwordx4 v88, s[20:23], s87 offen lds
    v_mfma_f32_16x16x32_bf16 v[152:155], a[76:79], a[84:87], v[152:155]
    v_mfma_f32_16x16x32_bf16 v[184:187], a[76:79], a[88:91], v[184:187]
    v_mfma_f32_16x16x32_bf16 v[216:219], a[76:79], a[92:95], v[216:219]
    s_add_u32 m0, s81, 118784
    s_add_u32 s91, s91, 262144
    v_mfma_f32_16x16x32_bf16 v[248:251], a[76:79], a[96:99], v[248:251]
    buffer_load_dwordx4 v80, s[24:27], s91 offen offset:0 lds
    v_mfma_f32_16x16x32_bf16 v[124:127], a[76:79], a[100:103], v[124:127]
    v_mfma_f32_16x16x32_bf16 v[156:159], a[80:83], a[84:87], v[156:159]
    v_mfma_f32_16x16x32_bf16 v[188:191], a[80:83], a[88:91], v[188:191]
    v_mfma_f32_16x16x32_bf16 v[220:223], a[80:83], a[92:95], v[220:223]
    buffer_load_dwordx4 v81, s[24:27], s91 offen offset:1024 lds
    v_mfma_f32_16x16x32_bf16 v[252:255], a[80:83], a[96:99], v[252:255]
    s_waitcnt lgkmcnt(0)
    v_mfma_f32_16x16x32_bf16 v[128:131], a[0:3], a[32:35], v[128:131]
    v_mfma_f32_16x16x32_bf16 v[160:163], a[0:3], a[36:39], v[160:163]
    s_waitcnt vmcnt(24) lgkmcnt(0)
    s_barrier
    v_mfma_f32_16x16x32_bf16 v[192:195], a[0:3], a[40:43], v[192:195]
    buffer_load_dwordx4 v82, s[24:27], s91 offen offset:2048 lds
    v_mfma_f32_16x16x32_bf16 v[224:227], a[0:3], a[44:47], v[224:227]
    ds_read_b64_tr_b16 a[52:53], v64 offset:16384
    ds_read_b64_tr_b16 a[54:55], v64 offset:17408
    v_mfma_f32_16x16x32_bf16 v[112:115], a[0:3], a[48:51], v[112:115]
    ds_read_b128 a[84:87], v66 offset:512
    v_mfma_f32_16x16x32_bf16 v[132:135], a[4:7], a[32:35], v[132:135]
    ds_read_b128 a[88:91], v66 offset:2560
    v_mfma_f32_16x16x32_bf16 v[164:167], a[4:7], a[36:39], v[164:167]
    buffer_load_dwordx4 v83, s[24:27], s91 offen offset:3072 lds
    v_mfma_f32_16x16x32_bf16 v[196:199], a[4:7], a[40:43], v[196:199]
    ds_read_b128 a[92:95], v66 offset:4608
    ds_read_b128 a[96:99], v66 offset:6656
    v_mfma_f32_16x16x32_bf16 v[228:231], a[4:7], a[44:47], v[228:231]
    ds_read_b128 a[100:103], v67 offset:512
    v_mfma_f32_16x16x32_bf16 v[136:139], a[8:11], a[32:35], v[136:139]
    s_add_u32 m0, s81, 0
    s_lshl_b32 s91, s88, 12
    ds_read_b64_tr_b16 a[56:57], v65 offset:16384
    v_mfma_f32_16x16x32_bf16 v[168:171], a[8:11], a[36:39], v[168:171]
    buffer_load_dwordx4 v80, s[24:27], s91 offen offset:0 lds
    v_mfma_f32_16x16x32_bf16 v[200:203], a[8:11], a[40:43], v[200:203]
    ds_read_b64_tr_b16 a[58:59], v65 offset:17408
    ds_read_b64_tr_b16 a[60:61], v64 offset:16640
    v_mfma_f32_16x16x32_bf16 v[232:235], a[8:11], a[44:47], v[232:235]
    ds_read_b64_tr_b16 a[62:63], v64 offset:17664
    v_mfma_f32_16x16x32_bf16 v[116:119], a[8:11], a[48:51], v[116:119]
    ds_read_b64_tr_b16 a[64:65], v65 offset:16640
    v_mfma_f32_16x16x32_bf16 v[140:143], a[12:15], a[32:35], v[140:143]
    buffer_load_dwordx4 v81, s[24:27], s91 offen offset:1024 lds
    v_mfma_f32_16x16x32_bf16 v[172:175], a[12:15], a[36:39], v[172:175]
    ds_read_b64_tr_b16 a[66:67], v65 offset:17664
    ds_read_b64_tr_b16 a[68:69], v64 offset:16896
    v_mfma_f32_16x16x32_bf16 v[204:207], a[12:15], a[40:43], v[204:207]
    ds_read_b64_tr_b16 a[70:71], v64 offset:17920
    v_mfma_f32_16x16x32_bf16 v[236:239], a[12:15], a[44:47], v[236:239]
    ds_read_b64_tr_b16 a[72:73], v65 offset:16896
    v_mfma_f32_16x16x32_bf16 v[144:147], a[16:19], a[32:35], v[144:147]
    buffer_load_dwordx4 v82, s[24:27], s91 offen offset:2048 lds
    v_mfma_f32_16x16x32_bf16 v[176:179], a[16:19], a[36:39], v[176:179]
    ds_read_b64_tr_b16 a[74:75], v65 offset:17920
    ds_read_b64_tr_b16 a[76:77], v64 offset:17152
    v_mfma_f32_16x16x32_bf16 v[208:211], a[16:19], a[40:43], v[208:211]
    ds_read_b64_tr_b16 a[78:79], v64 offset:18176
    v_mfma_f32_16x16x32_bf16 v[240:243], a[16:19], a[44:47], v[240:243]
    ds_read_b64_tr_b16 a[80:81], v65 offset:17152
    v_mfma_f32_16x16x32_bf16 v[120:123], a[16:19], a[48:51], v[120:123]
    buffer_load_dwordx4 v83, s[24:27], s91 offen offset:3072 lds
    v_mfma_f32_16x16x32_bf16 v[148:151], a[20:23], a[32:35], v[148:151]
    ds_read_b64_tr_b16 a[82:83], v65 offset:18176
    v_add_u32 v64, 51200, v64
    v_mfma_f32_16x16x32_bf16 v[180:183], a[20:23], a[36:39], v[180:183]
    v_add_u32 v65, 51200, v65
    v_mfma_f32_16x16x32_bf16 v[212:215], a[20:23], a[40:43], v[212:215]
    v_add_u32 v66, 51200, v66
    v_mfma_f32_16x16x32_bf16 v[244:247], a[20:23], a[44:47], v[244:247]
    v_add_u32 v67, 51200, v67
    v_mfma_f32_16x16x32_bf16 v[152:155], a[24:27], a[32:35], v[152:155]
    v_mfma_f32_16x16x32_bf16 v[184:187], a[24:27], a[36:39], v[184:187]
    v_mfma_f32_16x16x32_bf16 v[216:219], a[24:27], a[40:43], v[216:219]
    v_mfma_f32_16x16x32_bf16 v[248:251], a[24:27], a[44:47], v[248:251]
    v_mfma_f32_16x16x32_bf16 v[124:127], a[24:27], a[48:51], v[124:127]
    v_mfma_f32_16x16x32_bf16 v[156:159], a[28:31], a[32:35], v[156:159]
    v_mfma_f32_16x16x32_bf16 v[188:191], a[28:31], a[36:39], v[188:191]
    v_mfma_f32_16x16x32_bf16 v[220:223], a[28:31], a[40:43], v[220:223]
    v_mfma_f32_16x16x32_bf16 v[252:255], a[28:31], a[44:47], v[252:255]
    s_waitcnt lgkmcnt(0)
    v_mfma_f32_16x16x32_bf16 v[128:131], a[52:55], a[84:87], v[128:131]
    v_mfma_f32_16x16x32_bf16 v[160:163], a[52:55], a[88:91], v[160:163]
    s_waitcnt vmcnt(21) lgkmcnt(0)
    s_barrier
    s_add_u32 m0, s81, 32768
    v_mfma_f32_16x16x32_bf16 v[192:195], a[52:55], a[92:95], v[192:195]
    buffer_load_dwordx4 v84, s[20:23], s88 offen offset:0 lds
    v_mfma_f32_16x16x32_bf16 v[224:227], a[52:55], a[96:99], v[224:227]
    ds_read_b64_tr_b16 a[0:1], v64 offset:0
    ds_read_b64_tr_b16 a[2:3], v64 offset:1024
    v_mfma_f32_16x16x32_bf16 v[112:115], a[52:55], a[100:103], v[112:115]
    ds_read_b128 a[32:35], v66 offset:0
    v_mfma_f32_16x16x32_bf16 v[132:135], a[56:59], a[84:87], v[132:135]
    ds_read_b128 a[36:39], v66 offset:2048
    v_mfma_f32_16x16x32_bf16 v[164:167], a[56:59], a[88:91], v[164:167]
    buffer_load_dwordx4 v85, s[20:23], s88 offen offset:1024 lds
    v_mfma_f32_16x16x32_bf16 v[196:199], a[56:59], a[92:95], v[196:199]
    ds_read_b128 a[40:43], v66 offset:4096
    ds_read_b128 a[44:47], v66 offset:6144
    v_mfma_f32_16x16x32_bf16 v[228:231], a[56:59], a[96:99], v[228:231]
    ds_read_b128 a[48:51], v67 offset:0
    v_mfma_f32_16x16x32_bf16 v[136:139], a[60:63], a[84:87], v[136:139]
    ds_read_b64_tr_b16 a[4:5], v65 offset:0
    v_mfma_f32_16x16x32_bf16 v[168:171], a[60:63], a[88:91], v[168:171]
    buffer_load_dwordx4 v86, s[20:23], s88 offen offset:2048 lds
    v_mfma_f32_16x16x32_bf16 v[200:203], a[60:63], a[92:95], v[200:203]
    ds_read_b64_tr_b16 a[6:7], v65 offset:1024
    ds_read_b64_tr_b16 a[8:9], v64 offset:256
    v_mfma_f32_16x16x32_bf16 v[232:235], a[60:63], a[96:99], v[232:235]
    ds_read_b64_tr_b16 a[10:11], v64 offset:1280
    v_mfma_f32_16x16x32_bf16 v[116:119], a[60:63], a[100:103], v[116:119]
    ds_read_b64_tr_b16 a[12:13], v65 offset:256
    v_mfma_f32_16x16x32_bf16 v[140:143], a[64:67], a[84:87], v[140:143]
    buffer_load_dwordx4 v87, s[20:23], s88 offen offset:3072 lds
    v_mfma_f32_16x16x32_bf16 v[172:175], a[64:67], a[88:91], v[172:175]
    ds_read_b64_tr_b16 a[14:15], v65 offset:1280
    ds_read_b64_tr_b16 a[16:17], v64 offset:512
    v_mfma_f32_16x16x32_bf16 v[204:207], a[64:67], a[92:95], v[204:207]
    ds_read_b64_tr_b16 a[18:19], v64 offset:1536
    v_mfma_f32_16x16x32_bf16 v[236:239], a[64:67], a[96:99], v[236:239]
    s_mov_b32 m0, s60
    ds_read_b64_tr_b16 a[20:21], v65 offset:512
    v_mfma_f32_16x16x32_bf16 v[144:147], a[68:71], a[84:87], v[144:147]
    buffer_load_dwordx4 v88, s[20:23], s88 offen lds
    v_mfma_f32_16x16x32_bf16 v[176:179], a[68:71], a[88:91], v[176:179]
    ds_read_b64_tr_b16 a[22:23], v65 offset:1536
    ds_read_b64_tr_b16 a[24:25], v64 offset:768
    v_mfma_f32_16x16x32_bf16 v[208:211], a[68:71], a[92:95], v[208:211]
    ds_read_b64_tr_b16 a[26:27], v64 offset:1792
    v_mfma_f32_16x16x32_bf16 v[240:243], a[68:71], a[96:99], v[240:243]
    s_add_u32 m0, s81, 16384
    s_add_u32 s91, s91, 262144
    ds_read_b64_tr_b16 a[28:29], v65 offset:768
    v_mfma_f32_16x16x32_bf16 v[120:123], a[68:71], a[100:103], v[120:123]
    buffer_load_dwordx4 v80, s[24:27], s91 offen offset:0 lds
    v_mfma_f32_16x16x32_bf16 v[148:151], a[72:75], a[84:87], v[148:151]
    ds_read_b64_tr_b16 a[30:31], v65 offset:1792
    v_mfma_f32_16x16x32_bf16 v[180:183], a[72:75], a[88:91], v[180:183]
    v_mfma_f32_16x16x32_bf16 v[212:215], a[72:75], a[92:95], v[212:215]
    v_mfma_f32_16x16x32_bf16 v[244:247], a[72:75], a[96:99], v[244:247]
    buffer_load_dwordx4 v81, s[24:27], s91 offen offset:1024 lds
    v_mfma_f32_16x16x32_bf16 v[152:155], a[76:79], a[84:87], v[152:155]
    v_mfma_f32_16x16x32_bf16 v[184:187], a[76:79], a[88:91], v[184:187]
    v_mfma_f32_16x16x32_bf16 v[216:219], a[76:79], a[92:95], v[216:219]
    v_mfma_f32_16x16x32_bf16 v[248:251], a[76:79], a[96:99], v[248:251]
    buffer_load_dwordx4 v82, s[24:27], s91 offen offset:2048 lds
    v_mfma_f32_16x16x32_bf16 v[124:127], a[76:79], a[100:103], v[124:127]
    v_mfma_f32_16x16x32_bf16 v[156:159], a[80:83], a[84:87], v[156:159]
    v_mfma_f32_16x16x32_bf16 v[188:191], a[80:83], a[88:91], v[188:191]
    v_mfma_f32_16x16x32_bf16 v[220:223], a[80:83], a[92:95], v[220:223]
    buffer_load_dwordx4 v83, s[24:27], s91 offen offset:3072 lds
    v_mfma_f32_16x16x32_bf16 v[252:255], a[80:83], a[96:99], v[252:255]
    s_waitcnt lgkmcnt(0)
    v_mfma_f32_16x16x32_bf16 v[128:131], a[0:3], a[32:35], v[128:131]
    v_mfma_f32_16x16x32_bf16 v[160:163], a[0:3], a[36:39], v[160:163]
    s_waitcnt vmcnt(26) lgkmcnt(0)
    s_barrier
    s_add_u32 m0, s81, 51200
    v_mfma_f32_16x16x32_bf16 v[192:195], a[0:3], a[40:43], v[192:195]
    s_lshl_b32 s91, s89, 12
    buffer_load_dwordx4 v80, s[24:27], s91 offen offset:0 lds
    v_mfma_f32_16x16x32_bf16 v[224:227], a[0:3], a[44:47], v[224:227]
    ds_read_b64_tr_b16 a[52:53], v64 offset:16384
    ds_read_b64_tr_b16 a[54:55], v64 offset:17408
    v_mfma_f32_16x16x32_bf16 v[112:115], a[0:3], a[48:51], v[112:115]
    ds_read_b128 a[84:87], v66 offset:512
    v_mfma_f32_16x16x32_bf16 v[132:135], a[4:7], a[32:35], v[132:135]
    ds_read_b128 a[88:91], v66 offset:2560
    v_mfma_f32_16x16x32_bf16 v[164:167], a[4:7], a[36:39], v[164:167]
    buffer_load_dwordx4 v81, s[24:27], s91 offen offset:1024 lds
    v_mfma_f32_16x16x32_bf16 v[196:199], a[4:7], a[40:43], v[196:199]
    ds_read_b128 a[92:95], v66 offset:4608
    ds_read_b128 a[96:99], v66 offset:6656
    v_mfma_f32_16x16x32_bf16 v[228:231], a[4:7], a[44:47], v[228:231]
    ds_read_b128 a[100:103], v67 offset:512
    v_mfma_f32_16x16x32_bf16 v[136:139], a[8:11], a[32:35], v[136:139]
    ds_read_b64_tr_b16 a[56:57], v65 offset:16384
    v_mfma_f32_16x16x32_bf16 v[168:171], a[8:11], a[36:39], v[168:171]
    buffer_load_dwordx4 v82, s[24:27], s91 offen offset:2048 lds
    v_mfma_f32_16x16x32_bf16 v[200:203], a[8:11], a[40:43], v[200:203]
    ds_read_b64_tr_b16 a[58:59], v65 offset:17408
    ds_read_b64_tr_b16 a[60:61], v64 offset:16640
    v_mfma_f32_16x16x32_bf16 v[232:235], a[8:11], a[44:47], v[232:235]
    ds_read_b64_tr_b16 a[62:63], v64 offset:17664
    v_mfma_f32_16x16x32_bf16 v[116:119], a[8:11], a[48:51], v[116:119]
    ds_read_b64_tr_b16 a[64:65], v65 offset:16640
    v_mfma_f32_16x16x32_bf16 v[140:143], a[12:15], a[32:35], v[140:143]
    buffer_load_dwordx4 v83, s[24:27], s91 offen offset:3072 lds
    v_mfma_f32_16x16x32_bf16 v[172:175], a[12:15], a[36:39], v[172:175]
    ds_read_b64_tr_b16 a[66:67], v65 offset:17664
    ds_read_b64_tr_b16 a[68:69], v64 offset:16896
    v_mfma_f32_16x16x32_bf16 v[204:207], a[12:15], a[40:43], v[204:207]
    ds_read_b64_tr_b16 a[70:71], v64 offset:17920
    v_mfma_f32_16x16x32_bf16 v[236:239], a[12:15], a[44:47], v[236:239]
    ds_read_b64_tr_b16 a[72:73], v65 offset:16896
    v_mfma_f32_16x16x32_bf16 v[144:147], a[16:19], a[32:35], v[144:147]
    ds_read_b64_tr_b16 a[74:75], v65 offset:17920
    v_mfma_f32_16x16x32_bf16 v[176:179], a[16:19], a[36:39], v[176:179]
    ds_read_b64_tr_b16 a[76:77], v64 offset:17152
    v_mfma_f32_16x16x32_bf16 v[208:211], a[16:19], a[40:43], v[208:211]
    ds_read_b64_tr_b16 a[78:79], v64 offset:18176
    v_mfma_f32_16x16x32_bf16 v[240:243], a[16:19], a[44:47], v[240:243]
    ds_read_b64_tr_b16 a[80:81], v65 offset:17152
    v_mfma_f32_16x16x32_bf16 v[120:123], a[16:19], a[48:51], v[120:123]
    ds_read_b64_tr_b16 a[82:83], v65 offset:18176
    v_mfma_f32_16x16x32_bf16 v[148:151], a[20:23], a[32:35], v[148:151]
    v_add_u32 v64, 51200, v64
    v_mfma_f32_16x16x32_bf16 v[180:183], a[20:23], a[36:39], v[180:183]
    v_add_u32 v65, 51200, v65
    v_mfma_f32_16x16x32_bf16 v[212:215], a[20:23], a[40:43], v[212:215]
    v_add_u32 v66, 51200, v66
    v_mfma_f32_16x16x32_bf16 v[244:247], a[20:23], a[44:47], v[244:247]
    v_add_u32 v67, 51200, v67
    v_mfma_f32_16x16x32_bf16 v[152:155], a[24:27], a[32:35], v[152:155]
    v_mfma_f32_16x16x32_bf16 v[184:187], a[24:27], a[36:39], v[184:187]
    v_mfma_f32_16x16x32_bf16 v[216:219], a[24:27], a[40:43], v[216:219]
    v_mfma_f32_16x16x32_bf16 v[248:251], a[24:27], a[44:47], v[248:251]
    v_mfma_f32_16x16x32_bf16 v[124:127], a[24:27], a[48:51], v[124:127]
    v_mfma_f32_16x16x32_bf16 v[156:159], a[28:31], a[32:35], v[156:159]
    v_mfma_f32_16x16x32_bf16 v[188:191], a[28:31], a[36:39], v[188:191]
    v_mfma_f32_16x16x32_bf16 v[220:223], a[28:31], a[40:43], v[220:223]
    v_mfma_f32_16x16x32_bf16 v[252:255], a[28:31], a[44:47], v[252:255]
    s_waitcnt lgkmcnt(0)
    v_mfma_f32_16x16x32_bf16 v[128:131], a[52:55], a[84:87], v[128:131]
    v_mfma_f32_16x16x32_bf16 v[160:163], a[52:55], a[88:91], v[160:163]
    s_waitcnt vmcnt(21) lgkmcnt(0)
    s_barrier
    s_add_u32 m0, s81, 83968
    v_mfma_f32_16x16x32_bf16 v[192:195], a[52:55], a[92:95], v[192:195]
    buffer_load_dwordx4 v84, s[20:23], s89 offen offset:0 lds
    v_mfma_f32_16x16x32_bf16 v[224:227], a[52:55], a[96:99], v[224:227]
    ds_read_b64_tr_b16 a[0:1], v64 offset:0
    ds_read_b64_tr_b16 a[2:3], v64 offset:1024
    v_mfma_f32_16x16x32_bf16 v[112:115], a[52:55], a[100:103], v[112:115]
    ds_read_b128 a[32:35], v66 offset:0
    v_mfma_f32_16x16x32_bf16 v[132:135], a[56:59], a[84:87], v[132:135]
    ds_read_b128 a[36:39], v66 offset:2048
    v_mfma_f32_16x16x32_bf16 v[164:167], a[56:59], a[88:91], v[164:167]
    buffer_load_dwordx4 v85, s[20:23], s89 offen offset:1024 lds
    v_mfma_f32_16x16x32_bf16 v[196:199], a[56:59], a[92:95], v[196:199]
    ds_read_b128 a[40:43], v66 offset:4096
    ds_read_b128 a[44:47], v66 offset:6144
    v_mfma_f32_16x16x32_bf16 v[228:231], a[56:59], a[96:99], v[228:231]
    ds_read_b128 a[48:51], v67 offset:0
    v_mfma_f32_16x16x32_bf16 v[136:139], a[60:63], a[84:87], v[136:139]
    ds_read_b64_tr_b16 a[4:5], v65 offset:0
    v_mfma_f32_16x16x32_bf16 v[168:171], a[60:63], a[88:91], v[168:171]
    buffer_load_dwordx4 v86, s[20:23], s89 offen offset:2048 lds
    v_mfma_f32_16x16x32_bf16 v[200:203], a[60:63], a[92:95], v[200:203]
    ds_read_b64_tr_b16 a[6:7], v65 offset:1024
    ds_read_b64_tr_b16 a[8:9], v64 offset:256
    v_mfma_f32_16x16x32_bf16 v[232:235], a[60:63], a[96:99], v[232:235]
    ds_read_b64_tr_b16 a[10:11], v64 offset:1280
    v_mfma_f32_16x16x32_bf16 v[116:119], a[60:63], a[100:103], v[116:119]
    ds_read_b64_tr_b16 a[12:13], v65 offset:256
    v_mfma_f32_16x16x32_bf16 v[140:143], a[64:67], a[84:87], v[140:143]
    buffer_load_dwordx4 v87, s[20:23], s89 offen offset:3072 lds
    v_mfma_f32_16x16x32_bf16 v[172:175], a[64:67], a[88:91], v[172:175]
    ds_read_b64_tr_b16 a[14:15], v65 offset:1280
    ds_read_b64_tr_b16 a[16:17], v64 offset:512
    v_mfma_f32_16x16x32_bf16 v[204:207], a[64:67], a[92:95], v[204:207]
    ds_read_b64_tr_b16 a[18:19], v64 offset:1536
    v_mfma_f32_16x16x32_bf16 v[236:239], a[64:67], a[96:99], v[236:239]
    s_mov_b32 m0, s61
    ds_read_b64_tr_b16 a[20:21], v65 offset:512
    v_mfma_f32_16x16x32_bf16 v[144:147], a[68:71], a[84:87], v[144:147]
    buffer_load_dwordx4 v88, s[20:23], s89 offen lds
    v_mfma_f32_16x16x32_bf16 v[176:179], a[68:71], a[88:91], v[176:179]
    ds_read_b64_tr_b16 a[22:23], v65 offset:1536
    ds_read_b64_tr_b16 a[24:25], v64 offset:768
    v_mfma_f32_16x16x32_bf16 v[208:211], a[68:71], a[92:95], v[208:211]
    ds_read_b64_tr_b16 a[26:27], v64 offset:1792
    v_mfma_f32_16x16x32_bf16 v[240:243], a[68:71], a[96:99], v[240:243]
    s_add_u32 m0, s81, 67584
    s_add_u32 s91, s91, 262144
    ds_read_b64_tr_b16 a[28:29], v65 offset:768
    v_mfma_f32_16x16x32_bf16 v[120:123], a[68:71], a[100:103], v[120:123]
    buffer_load_dwordx4 v80, s[24:27], s91 offen offset:0 lds
    v_mfma_f32_16x16x32_bf16 v[148:151], a[72:75], a[84:87], v[148:151]
    ds_read_b64_tr_b16 a[30:31], v65 offset:1792
    v_mfma_f32_16x16x32_bf16 v[180:183], a[72:75], a[88:91], v[180:183]
    v_mfma_f32_16x16x32_bf16 v[212:215], a[72:75], a[92:95], v[212:215]
    v_mfma_f32_16x16x32_bf16 v[244:247], a[72:75], a[96:99], v[244:247]
    buffer_load_dwordx4 v81, s[24:27], s91 offen offset:1024 lds
    v_mfma_f32_16x16x32_bf16 v[152:155], a[76:79], a[84:87], v[152:155]
    v_mfma_f32_16x16x32_bf16 v[184:187], a[76:79], a[88:91], v[184:187]
    v_mfma_f32_16x16x32_bf16 v[216:219], a[76:79], a[92:95], v[216:219]
    v_mfma_f32_16x16x32_bf16 v[248:251], a[76:79], a[96:99], v[248:251]
    buffer_load_dwordx4 v82, s[24:27], s91 offen offset:2048 lds
    v_mfma_f32_16x16x32_bf16 v[124:127], a[76:79], a[100:103], v[124:127]
    v_mfma_f32_16x16x32_bf16 v[156:159], a[80:83], a[84:87], v[156:159]
    v_mfma_f32_16x16x32_bf16 v[188:191], a[80:83], a[88:91], v[188:191]
    v_mfma_f32_16x16x32_bf16 v[220:223], a[80:83], a[92:95], v[220:223]
    buffer_load_dwordx4 v83, s[24:27], s91 offen offset:3072 lds
    v_mfma_f32_16x16x32_bf16 v[252:255], a[80:83], a[96:99], v[252:255]
    s_waitcnt lgkmcnt(0)
    v_mfma_f32_16x16x32_bf16 v[128:131], a[0:3], a[32:35], v[128:131]
    v_mfma_f32_16x16x32_bf16 v[160:163], a[0:3], a[36:39], v[160:163]
    s_waitcnt vmcnt(26) lgkmcnt(0)
    s_barrier
    s_add_u32 m0, s81, 102400
    v_mfma_f32_16x16x32_bf16 v[192:195], a[0:3], a[40:43], v[192:195]
    s_lshl_b32 s91, s90, 12
    buffer_load_dwordx4 v80, s[24:27], s91 offen offset:0 lds
    v_mfma_f32_16x16x32_bf16 v[224:227], a[0:3], a[44:47], v[224:227]
    ds_read_b64_tr_b16 a[52:53], v64 offset:16384
    ds_read_b64_tr_b16 a[54:55], v64 offset:17408
    v_mfma_f32_16x16x32_bf16 v[112:115], a[0:3], a[48:51], v[112:115]
    ds_read_b128 a[84:87], v66 offset:512
    v_mfma_f32_16x16x32_bf16 v[132:135], a[4:7], a[32:35], v[132:135]
    ds_read_b128 a[88:91], v66 offset:2560
    v_mfma_f32_16x16x32_bf16 v[164:167], a[4:7], a[36:39], v[164:167]
    buffer_load_dwordx4 v81, s[24:27], s91 offen offset:1024 lds
    v_mfma_f32_16x16x32_bf16 v[196:199], a[4:7], a[40:43], v[196:199]
    ds_read_b128 a[92:95], v66 offset:4608
    ds_read_b128 a[96:99], v66 offset:6656
    v_mfma_f32_16x16x32_bf16 v[228:231], a[4:7], a[44:47], v[228:231]
    ds_read_b128 a[100:103], v67 offset:512
    v_mfma_f32_16x16x32_bf16 v[136:139], a[8:11], a[32:35], v[136:139]
    ds_read_b64_tr_b16 a[56:57], v65 offset:16384
    v_mfma_f32_16x16x32_bf16 v[168:171], a[8:11], a[36:39], v[168:171]
    buffer_load_dwordx4 v82, s[24:27], s91 offen offset:2048 lds
    v_mfma_f32_16x16x32_bf16 v[200:203], a[8:11], a[40:43], v[200:203]
    ds_read_b64_tr_b16 a[58:59], v65 offset:17408
    ds_read_b64_tr_b16 a[60:61], v64 offset:16640
    v_mfma_f32_16x16x32_bf16 v[232:235], a[8:11], a[44:47], v[232:235]
    ds_read_b64_tr_b16 a[62:63], v64 offset:17664
    v_mfma_f32_16x16x32_bf16 v[116:119], a[8:11], a[48:51], v[116:119]
    ds_read_b64_tr_b16 a[64:65], v65 offset:16640
    v_mfma_f32_16x16x32_bf16 v[140:143], a[12:15], a[32:35], v[140:143]
    buffer_load_dwordx4 v83, s[24:27], s91 offen offset:3072 lds
    v_mfma_f32_16x16x32_bf16 v[172:175], a[12:15], a[36:39], v[172:175]
    ds_read_b64_tr_b16 a[66:67], v65 offset:17664
    ds_read_b64_tr_b16 a[68:69], v64 offset:16896
    v_mfma_f32_16x16x32_bf16 v[204:207], a[12:15], a[40:43], v[204:207]
    ds_read_b64_tr_b16 a[70:71], v64 offset:17920
    v_mfma_f32_16x16x32_bf16 v[236:239], a[12:15], a[44:47], v[236:239]
    ds_read_b64_tr_b16 a[72:73], v65 offset:16896
    v_mfma_f32_16x16x32_bf16 v[144:147], a[16:19], a[32:35], v[144:147]
    ds_read_b64_tr_b16 a[74:75], v65 offset:17920
    v_mfma_f32_16x16x32_bf16 v[176:179], a[16:19], a[36:39], v[176:179]
    ds_read_b64_tr_b16 a[76:77], v64 offset:17152
    v_mfma_f32_16x16x32_bf16 v[208:211], a[16:19], a[40:43], v[208:211]
    ds_read_b64_tr_b16 a[78:79], v64 offset:18176
    v_mfma_f32_16x16x32_bf16 v[240:243], a[16:19], a[44:47], v[240:243]
    ds_read_b64_tr_b16 a[80:81], v65 offset:17152
    v_mfma_f32_16x16x32_bf16 v[120:123], a[16:19], a[48:51], v[120:123]
    ds_read_b64_tr_b16 a[82:83], v65 offset:18176
    v_mfma_f32_16x16x32_bf16 v[148:151], a[20:23], a[32:35], v[148:151]
    v_add_u32 v64, -102400, v64
    v_mfma_f32_16x16x32_bf16 v[180:183], a[20:23], a[36:39], v[180:183]
    v_add_u32 v65, -102400, v65
    v_mfma_f32_16x16x32_bf16 v[212:215], a[20:23], a[40:43], v[212:215]
    v_add_u32 v66, -102400, v66
    v_mfma_f32_16x16x32_bf16 v[244:247], a[20:23], a[44:47], v[244:247]
    v_add_u32 v67, -102400, v67
    v_mfma_f32_16x16x32_bf16 v[152:155], a[24:27], a[32:35], v[152:155]
    v_mfma_f32_16x16x32_bf16 v[184:187], a[24:27], a[36:39], v[184:187]
    v_mfma_f32_16x16x32_bf16 v[216:219], a[24:27], a[40:43], v[216:219]
    v_mfma_f32_16x16x32_bf16 v[248:251], a[24:27], a[44:47], v[248:251]
    v_mfma_f32_16x16x32_bf16 v[124:127], a[24:27], a[48:51], v[124:127]
    v_mfma_f32_16x16x32_bf16 v[156:159], a[28:31], a[32:35], v[156:159]
    v_mfma_f32_16x16x32_bf16 v[188:191], a[28:31], a[36:39], v[188:191]
    v_mfma_f32_16x16x32_bf16 v[220:223], a[28:31], a[40:43], v[220:223]
    v_mfma_f32_16x16x32_bf16 v[252:255], a[28:31], a[44:47], v[252:255]
    s_waitcnt lgkmcnt(0)
    v_mfma_f32_16x16x32_bf16 v[128:131], a[52:55], a[84:87], v[128:131]
    v_mfma_f32_16x16x32_bf16 v[160:163], a[52:55], a[88:91], v[160:163]
    s_waitcnt vmcnt(21) lgkmcnt(0)
    s_barrier
    s_add_u32 m0, s81, 135168
    v_mfma_f32_16x16x32_bf16 v[192:195], a[52:55], a[92:95], v[192:195]
    buffer_load_dwordx4 v84, s[20:23], s90 offen offset:0 lds
    v_mfma_f32_16x16x32_bf16 v[224:227], a[52:55], a[96:99], v[224:227]
    ds_read_b64_tr_b16 a[0:1], v64 offset:0
    ds_read_b64_tr_b16 a[2:3], v64 offset:1024
    v_mfma_f32_16x16x32_bf16 v[112:115], a[52:55], a[100:103], v[112:115]
    ds_read_b128 a[32:35], v66 offset:0
    v_mfma_f32_16x16x32_bf16 v[132:135], a[56:59], a[84:87], v[132:135]
    ds_read_b128 a[36:39], v66 offset:2048
    v_mfma_f32_16x16x32_bf16 v[164:167], a[56:59], a[88:91], v[164:167]
    buffer_load_dwordx4 v85, s[20:23], s90 offen offset:1024 lds
    v_mfma_f32_16x16x32_bf16 v[196:199], a[56:59], a[92:95], v[196:199]
    ds_read_b128 a[40:43], v66 offset:4096
    ds_read_b128 a[44:47], v66 offset:6144
    v_mfma_f32_16x16x32_bf16 v[228:231], a[56:59], a[96:99], v[228:231]
    ds_read_b128 a[48:51], v67 offset:0
    v_mfma_f32_16x16x32_bf16 v[136:139], a[60:63], a[84:87], v[136:139]
    ds_read_b64_tr_b16 a[4:5], v65 offset:0
    v_mfma_f32_16x16x32_bf16 v[168:171], a[60:63], a[88:91], v[168:171]
    buffer_load_dwordx4 v86, s[20:23], s90 offen offset:2048 lds
    v_mfma_f32_16x16x32_bf16 v[200:203], a[60:63], a[92:95], v[200:203]
    ds_read_b64_tr_b16 a[6:7], v65 offset:1024
    ds_read_b64_tr_b16 a[8:9], v64 offset:256
    v_mfma_f32_16x16x32_bf16 v[232:235], a[60:63], a[96:99], v[232:235]
    ds_read_b64_tr_b16 a[10:11], v64 offset:1280
    v_mfma_f32_16x16x32_bf16 v[116:119], a[60:63], a[100:103], v[116:119]
    ds_read_b64_tr_b16 a[12:13], v65 offset:256
    v_mfma_f32_16x16x32_bf16 v[140:143], a[64:67], a[84:87], v[140:143]
    buffer_load_dwordx4 v87, s[20:23], s90 offen offset:3072 lds
    v_mfma_f32_16x16x32_bf16 v[172:175], a[64:67], a[88:91], v[172:175]
    ds_read_b64_tr_b16 a[14:15], v65 offset:1280
    ds_read_b64_tr_b16 a[16:17], v64 offset:512
    v_mfma_f32_16x16x32_bf16 v[204:207], a[64:67], a[92:95], v[204:207]
    ds_read_b64_tr_b16 a[18:19], v64 offset:1536
    v_mfma_f32_16x16x32_bf16 v[236:239], a[64:67], a[96:99], v[236:239]
    s_mov_b32 m0, s62
    ds_read_b64_tr_b16 a[20:21], v65 offset:512
    v_mfma_f32_16x16x32_bf16 v[144:147], a[68:71], a[84:87], v[144:147]
    buffer_load_dwordx4 v88, s[20:23], s90 offen lds
    v_mfma_f32_16x16x32_bf16 v[176:179], a[68:71], a[88:91], v[176:179]
    ds_read_b64_tr_b16 a[22:23], v65 offset:1536
    ds_read_b64_tr_b16 a[24:25], v64 offset:768
    v_mfma_f32_16x16x32_bf16 v[208:211], a[68:71], a[92:95], v[208:211]
    ds_read_b64_tr_b16 a[26:27], v64 offset:1792
    v_mfma_f32_16x16x32_bf16 v[240:243], a[68:71], a[96:99], v[240:243]
    s_add_u32 m0, s81, 118784
    s_add_u32 s91, s91, 262144
    ds_read_b64_tr_b16 a[28:29], v65 offset:768
    v_mfma_f32_16x16x32_bf16 v[120:123], a[68:71], a[100:103], v[120:123]
    buffer_load_dwordx4 v80, s[24:27], s91 offen offset:0 lds
    v_mfma_f32_16x16x32_bf16 v[148:151], a[72:75], a[84:87], v[148:151]
    ds_read_b64_tr_b16 a[30:31], v65 offset:1792
    v_mfma_f32_16x16x32_bf16 v[180:183], a[72:75], a[88:91], v[180:183]
    v_mfma_f32_16x16x32_bf16 v[212:215], a[72:75], a[92:95], v[212:215]
    v_mfma_f32_16x16x32_bf16 v[244:247], a[72:75], a[96:99], v[244:247]
    buffer_load_dwordx4 v81, s[24:27], s91 offen offset:1024 lds
    v_mfma_f32_16x16x32_bf16 v[152:155], a[76:79], a[84:87], v[152:155]
    v_mfma_f32_16x16x32_bf16 v[184:187], a[76:79], a[88:91], v[184:187]
    v_mfma_f32_16x16x32_bf16 v[216:219], a[76:79], a[92:95], v[216:219]
    v_mfma_f32_16x16x32_bf16 v[248:251], a[76:79], a[96:99], v[248:251]
    buffer_load_dwordx4 v82, s[24:27], s91 offen offset:2048 lds
    v_mfma_f32_16x16x32_bf16 v[124:127], a[76:79], a[100:103], v[124:127]
    v_mfma_f32_16x16x32_bf16 v[156:159], a[80:83], a[84:87], v[156:159]
    v_mfma_f32_16x16x32_bf16 v[188:191], a[80:83], a[88:91], v[188:191]
    v_mfma_f32_16x16x32_bf16 v[220:223], a[80:83], a[92:95], v[220:223]
    buffer_load_dwordx4 v83, s[24:27], s91 offen offset:3072 lds
    v_mfma_f32_16x16x32_bf16 v[252:255], a[80:83], a[96:99], v[252:255]
    s_waitcnt lgkmcnt(0)
    v_mfma_f32_16x16x32_bf16 v[128:131], a[0:3], a[32:35], v[128:131]
    v_mfma_f32_16x16x32_bf16 v[160:163], a[0:3], a[36:39], v[160:163]
    s_waitcnt vmcnt(26) lgkmcnt(0)
    s_barrier
    s_add_u32 m0, s81, 0
    v_mfma_f32_16x16x32_bf16 v[192:195], a[0:3], a[40:43], v[192:195]
    s_add_u32 s63, s81, 0
    buffer_load_dwordx4 v6, s[28:31], s63 offen offset:0 lds
    v_mfma_f32_16x16x32_bf16 v[224:227], a[0:3], a[44:47], v[224:227]
    ds_read_b64_tr_b16 a[52:53], v64 offset:16384
    ds_read_b64_tr_b16 a[54:55], v64 offset:17408
    v_mfma_f32_16x16x32_bf16 v[112:115], a[0:3], a[48:51], v[112:115]
    ds_read_b128 a[84:87], v66 offset:512
    v_mfma_f32_16x16x32_bf16 v[132:135], a[4:7], a[32:35], v[132:135]
    ds_read_b128 a[88:91], v66 offset:2560
    v_mfma_f32_16x16x32_bf16 v[164:167], a[4:7], a[36:39], v[164:167]
    buffer_load_dwordx4 v7, s[28:31], s63 offen offset:1024 lds
    v_mfma_f32_16x16x32_bf16 v[196:199], a[4:7], a[40:43], v[196:199]
    ds_read_b128 a[92:95], v66 offset:4608
    ds_read_b128 a[96:99], v66 offset:6656
    v_mfma_f32_16x16x32_bf16 v[228:231], a[4:7], a[44:47], v[228:231]
    ds_read_b128 a[100:103], v67 offset:512
    v_mfma_f32_16x16x32_bf16 v[136:139], a[8:11], a[32:35], v[136:139]
    ds_read_b64_tr_b16 a[56:57], v65 offset:16384
    v_mfma_f32_16x16x32_bf16 v[168:171], a[8:11], a[36:39], v[168:171]
    buffer_load_dwordx4 v6, s[28:31], s63 offen offset:2048 lds
    v_mfma_f32_16x16x32_bf16 v[200:203], a[8:11], a[40:43], v[200:203]
    ds_read_b64_tr_b16 a[58:59], v65 offset:17408
    ds_read_b64_tr_b16 a[60:61], v64 offset:16640
    v_mfma_f32_16x16x32_bf16 v[232:235], a[8:11], a[44:47], v[232:235]
    ds_read_b64_tr_b16 a[62:63], v64 offset:17664
    v_mfma_f32_16x16x32_bf16 v[116:119], a[8:11], a[48:51], v[116:119]
    ds_read_b64_tr_b16 a[64:65], v65 offset:16640
    v_mfma_f32_16x16x32_bf16 v[140:143], a[12:15], a[32:35], v[140:143]
    buffer_load_dwordx4 v7, s[28:31], s63 offen offset:3072 lds
    v_mfma_f32_16x16x32_bf16 v[172:175], a[12:15], a[36:39], v[172:175]
    ds_read_b64_tr_b16 a[66:67], v65 offset:17664
    ds_read_b64_tr_b16 a[68:69], v64 offset:16896
    v_mfma_f32_16x16x32_bf16 v[204:207], a[12:15], a[40:43], v[204:207]
    ds_read_b64_tr_b16 a[70:71], v64 offset:17920
    v_mfma_f32_16x16x32_bf16 v[236:239], a[12:15], a[44:47], v[236:239]
    ds_read_b64_tr_b16 a[72:73], v65 offset:16896
    v_mfma_f32_16x16x32_bf16 v[144:147], a[16:19], a[32:35], v[144:147]
    ds_read_b64_tr_b16 a[74:75], v65 offset:17920
    v_mfma_f32_16x16x32_bf16 v[176:179], a[16:19], a[36:39], v[176:179]
    ds_read_b64_tr_b16 a[76:77], v64 offset:17152
    v_mfma_f32_16x16x32_bf16 v[208:211], a[16:19], a[40:43], v[208:211]
    ds_read_b64_tr_b16 a[78:79], v64 offset:18176
    v_mfma_f32_16x16x32_bf16 v[240:243], a[16:19], a[44:47], v[240:243]
    ds_read_b64_tr_b16 a[80:81], v65 offset:17152
    v_mfma_f32_16x16x32_bf16 v[120:123], a[16:19], a[48:51], v[120:123]
    ds_read_b64_tr_b16 a[82:83], v65 offset:18176
    v_mfma_f32_16x16x32_bf16 v[148:151], a[20:23], a[32:35], v[148:151]
    v_add_u32 v64, 51200, v64
    v_mfma_f32_16x16x32_bf16 v[180:183], a[20:23], a[36:39], v[180:183]
    v_add_u32 v65, 51200, v65
    v_mfma_f32_16x16x32_bf16 v[212:215], a[20:23], a[40:43], v[212:215]
    v_add_u32 v66, 51200, v66
    v_mfma_f32_16x16x32_bf16 v[244:247], a[20:23], a[44:47], v[244:247]
    v_add_u32 v67, 51200, v67
    v_mfma_f32_16x16x32_bf16 v[152:155], a[24:27], a[32:35], v[152:155]
    v_mfma_f32_16x16x32_bf16 v[184:187], a[24:27], a[36:39], v[184:187]
    v_mfma_f32_16x16x32_bf16 v[216:219], a[24:27], a[40:43], v[216:219]
    v_mfma_f32_16x16x32_bf16 v[248:251], a[24:27], a[44:47], v[248:251]
    v_mfma_f32_16x16x32_bf16 v[124:127], a[24:27], a[48:51], v[124:127]
    v_mfma_f32_16x16x32_bf16 v[156:159], a[28:31], a[32:35], v[156:159]
    v_mfma_f32_16x16x32_bf16 v[188:191], a[28:31], a[36:39], v[188:191]
    v_mfma_f32_16x16x32_bf16 v[220:223], a[28:31], a[40:43], v[220:223]
    v_mfma_f32_16x16x32_bf16 v[252:255], a[28:31], a[44:47], v[252:255]
    s_waitcnt lgkmcnt(0)
    v_mfma_f32_16x16x32_bf16 v[128:131], a[52:55], a[84:87], v[128:131]
    v_mfma_f32_16x16x32_bf16 v[160:163], a[52:55], a[88:91], v[160:163]
    s_waitcnt vmcnt(21) lgkmcnt(0)
    s_barrier
    s_add_u32 s63, s81, 0
    v_mfma_f32_16x16x32_bf16 v[192:195], a[52:55], a[92:95], v[192:195]
    buffer_load_dwordx4 a[156:159], v6, s[32:35], s63 offen offset:0
    v_mfma_f32_16x16x32_bf16 v[224:227], a[52:55], a[96:99], v[224:227]
    ds_read_b64_tr_b16 a[0:1], v64 offset:0
    ds_read_b64_tr_b16 a[2:3], v64 offset:1024
    v_mfma_f32_16x16x32_bf16 v[112:115], a[52:55], a[100:103], v[112:115]
    ds_read_b128 a[32:35], v66 offset:0
    v_mfma_f32_16x16x32_bf16 v[132:135], a[56:59], a[84:87], v[132:135]
    ds_read_b128 a[36:39], v66 offset:2048
    v_mfma_f32_16x16x32_bf16 v[164:167], a[56:59], a[88:91], v[164:167]
    buffer_load_dwordx4 a[160:163], v7, s[32:35], s63 offen offset:1024
    v_mfma_f32_16x16x32_bf16 v[196:199], a[56:59], a[92:95], v[196:199]
    ds_read_b128 a[40:43], v66 offset:4096
    ds_read_b128 a[44:47], v66 offset:6144
    v_mfma_f32_16x16x32_bf16 v[228:231], a[56:59], a[96:99], v[228:231]
    ds_read_b128 a[48:51], v67 offset:0
    v_mfma_f32_16x16x32_bf16 v[136:139], a[60:63], a[84:87], v[136:139]
    ds_read_b64_tr_b16 a[4:5], v65 offset:0
    v_mfma_f32_16x16x32_bf16 v[168:171], a[60:63], a[88:91], v[168:171]
    buffer_load_dwordx4 a[164:167], v6, s[32:35], s63 offen offset:2048
    v_mfma_f32_16x16x32_bf16 v[200:203], a[60:63], a[92:95], v[200:203]
    ds_read_b64_tr_b16 a[6:7], v65 offset:1024
    ds_read_b64_tr_b16 a[8:9], v64 offset:256
    v_mfma_f32_16x16x32_bf16 v[232:235], a[60:63], a[96:99], v[232:235]
    ds_read_b64_tr_b16 a[10:11], v64 offset:1280
    v_mfma_f32_16x16x32_bf16 v[116:119], a[60:63], a[100:103], v[116:119]
    ds_read_b64_tr_b16 a[12:13], v65 offset:256
    v_mfma_f32_16x16x32_bf16 v[140:143], a[64:67], a[84:87], v[140:143]
    buffer_load_dwordx4 a[168:171], v7, s[32:35], s63 offen offset:3072
    v_mfma_f32_16x16x32_bf16 v[172:175], a[64:67], a[88:91], v[172:175]
    ds_read_b64_tr_b16 a[14:15], v65 offset:1280
    ds_read_b64_tr_b16 a[16:17], v64 offset:512
    v_mfma_f32_16x16x32_bf16 v[204:207], a[64:67], a[92:95], v[204:207]
    ds_read_b64_tr_b16 a[18:19], v64 offset:1536
    v_mfma_f32_16x16x32_bf16 v[236:239], a[64:67], a[96:99], v[236:239]
    ds_read_b64_tr_b16 a[20:21], v65 offset:512
    v_mfma_f32_16x16x32_bf16 v[144:147], a[68:71], a[84:87], v[144:147]
    ds_read_b64_tr_b16 a[22:23], v65 offset:1536
    v_mfma_f32_16x16x32_bf16 v[176:179], a[68:71], a[88:91], v[176:179]
    ds_read_b64_tr_b16 a[24:25], v64 offset:768
    v_mfma_f32_16x16x32_bf16 v[208:211], a[68:71], a[92:95], v[208:211]
    ds_read_b64_tr_b16 a[26:27], v64 offset:1792
    v_mfma_f32_16x16x32_bf16 v[240:243], a[68:71], a[96:99], v[240:243]
    ds_read_b64_tr_b16 a[28:29], v65 offset:768
    v_mfma_f32_16x16x32_bf16 v[120:123], a[68:71], a[100:103], v[120:123]
    ds_read_b64_tr_b16 a[30:31], v65 offset:1792
    v_mfma_f32_16x16x32_bf16 v[148:151], a[72:75], a[84:87], v[148:151]
    v_mfma_f32_16x16x32_bf16 v[180:183], a[72:75], a[88:91], v[180:183]
    v_mfma_f32_16x16x32_bf16 v[212:215], a[72:75], a[92:95], v[212:215]
    v_mfma_f32_16x16x32_bf16 v[244:247], a[72:75], a[96:99], v[244:247]
    v_mfma_f32_16x16x32_bf16 v[152:155], a[76:79], a[84:87], v[152:155]
    v_mfma_f32_16x16x32_bf16 v[184:187], a[76:79], a[88:91], v[184:187]
    v_mfma_f32_16x16x32_bf16 v[216:219], a[76:79], a[92:95], v[216:219]
    v_mfma_f32_16x16x32_bf16 v[248:251], a[76:79], a[96:99], v[248:251]
    v_mfma_f32_16x16x32_bf16 v[124:127], a[76:79], a[100:103], v[124:127]
    v_mfma_f32_16x16x32_bf16 v[156:159], a[80:83], a[84:87], v[156:159]
    v_mfma_f32_16x16x32_bf16 v[188:191], a[80:83], a[88:91], v[188:191]
    v_mfma_f32_16x16x32_bf16 v[220:223], a[80:83], a[92:95], v[220:223]
    v_mfma_f32_16x16x32_bf16 v[252:255], a[80:83], a[96:99], v[252:255]
    s_waitcnt lgkmcnt(0)
    v_mfma_f32_16x16x32_bf16 v[128:131], a[0:3], a[32:35], v[128:131]
    v_mfma_f32_16x16x32_bf16 v[160:163], a[0:3], a[36:39], v[160:163]
    s_waitcnt vmcnt(21) lgkmcnt(0)
    s_barrier
    s_add_u32 m0, s81, 16384
    v_mfma_f32_16x16x32_bf16 v[192:195], a[0:3], a[40:43], v[192:195]
    s_add_u32 s63, s81, 16384
    buffer_load_dwordx4 v6, s[28:31], s63 offen offset:0 lds
    v_mfma_f32_16x16x32_bf16 v[224:227], a[0:3], a[44:47], v[224:227]
    ds_read_b64_tr_b16 a[52:53], v64 offset:16384
    ds_read_b64_tr_b16 a[54:55], v64 offset:17408
    v_mfma_f32_16x16x32_bf16 v[112:115], a[0:3], a[48:51], v[112:115]
    ds_read_b128 a[84:87], v66 offset:512
    v_mfma_f32_16x16x32_bf16 v[132:135], a[4:7], a[32:35], v[132:135]
    ds_read_b128 a[88:91], v66 offset:2560
    v_mfma_f32_16x16x32_bf16 v[164:167], a[4:7], a[36:39], v[164:167]
    buffer_load_dwordx4 v7, s[28:31], s63 offen offset:1024 lds
    v_mfma_f32_16x16x32_bf16 v[196:199], a[4:7], a[40:43], v[196:199]
    ds_read_b128 a[92:95], v66 offset:4608
    ds_read_b128 a[96:99], v66 offset:6656
    v_mfma_f32_16x16x32_bf16 v[228:231], a[4:7], a[44:47], v[228:231]
    ds_read_b128 a[100:103], v67 offset:512
    v_mfma_f32_16x16x32_bf16 v[136:139], a[8:11], a[32:35], v[136:139]
    ds_read_b64_tr_b16 a[56:57], v65 offset:16384
    v_mfma_f32_16x16x32_bf16 v[168:171], a[8:11], a[36:39], v[168:171]
    buffer_load_dwordx4 v6, s[28:31], s63 offen offset:2048 lds
    v_mfma_f32_16x16x32_bf16 v[200:203], a[8:11], a[40:43], v[200:203]
    ds_read_b64_tr_b16 a[58:59], v65 offset:17408
    ds_read_b64_tr_b16 a[60:61], v64 offset:16640
    v_mfma_f32_16x16x32_bf16 v[232:235], a[8:11], a[44:47], v[232:235]
    ds_read_b64_tr_b16 a[62:63], v64 offset:17664
    v_mfma_f32_16x16x32_bf16 v[116:119], a[8:11], a[48:51], v[116:119]
    ds_read_b64_tr_b16 a[64:65], v65 offset:16640
    v_mfma_f32_16x16x32_bf16 v[140:143], a[12:15], a[32:35], v[140:143]
    buffer_load_dwordx4 v7, s[28:31], s63 offen offset:3072 lds
    v_mfma_f32_16x16x32_bf16 v[172:175], a[12:15], a[36:39], v[172:175]
    ds_read_b64_tr_b16 a[66:67], v65 offset:17664
    ds_read_b64_tr_b16 a[68:69], v64 offset:16896
    v_mfma_f32_16x16x32_bf16 v[204:207], a[12:15], a[40:43], v[204:207]
    ds_read_b64_tr_b16 a[70:71], v64 offset:17920
    v_mfma_f32_16x16x32_bf16 v[236:239], a[12:15], a[44:47], v[236:239]
    ds_read_b64_tr_b16 a[72:73], v65 offset:16896
    v_mfma_f32_16x16x32_bf16 v[144:147], a[16:19], a[32:35], v[144:147]
    ds_read_b64_tr_b16 a[74:75], v65 offset:17920
    v_mfma_f32_16x16x32_bf16 v[176:179], a[16:19], a[36:39], v[176:179]
    ds_read_b64_tr_b16 a[76:77], v64 offset:17152
    v_mfma_f32_16x16x32_bf16 v[208:211], a[16:19], a[40:43], v[208:211]
    ds_read_b64_tr_b16 a[78:79], v64 offset:18176
    v_mfma_f32_16x16x32_bf16 v[240:243], a[16:19], a[44:47], v[240:243]
    ds_read_b64_tr_b16 a[80:81], v65 offset:17152
    v_mfma_f32_16x16x32_bf16 v[120:123], a[16:19], a[48:51], v[120:123]
    ds_read_b64_tr_b16 a[82:83], v65 offset:18176
    v_mfma_f32_16x16x32_bf16 v[148:151], a[20:23], a[32:35], v[148:151]
    v_add_u32 v64, 51200, v64
    v_mfma_f32_16x16x32_bf16 v[180:183], a[20:23], a[36:39], v[180:183]
    v_add_u32 v65, 51200, v65
    v_mfma_f32_16x16x32_bf16 v[212:215], a[20:23], a[40:43], v[212:215]
    v_add_u32 v66, 51200, v66
    v_mfma_f32_16x16x32_bf16 v[244:247], a[20:23], a[44:47], v[244:247]
    v_add_u32 v67, 51200, v67
    v_mfma_f32_16x16x32_bf16 v[152:155], a[24:27], a[32:35], v[152:155]
    v_mfma_f32_16x16x32_bf16 v[184:187], a[24:27], a[36:39], v[184:187]
    v_mfma_f32_16x16x32_bf16 v[216:219], a[24:27], a[40:43], v[216:219]
    v_mfma_f32_16x16x32_bf16 v[248:251], a[24:27], a[44:47], v[248:251]
    v_mfma_f32_16x16x32_bf16 v[124:127], a[24:27], a[48:51], v[124:127]
    v_mfma_f32_16x16x32_bf16 v[156:159], a[28:31], a[32:35], v[156:159]
    v_mfma_f32_16x16x32_bf16 v[188:191], a[28:31], a[36:39], v[188:191]
    v_mfma_f32_16x16x32_bf16 v[220:223], a[28:31], a[40:43], v[220:223]
    v_mfma_f32_16x16x32_bf16 v[252:255], a[28:31], a[44:47], v[252:255]
    s_waitcnt lgkmcnt(0)
    v_mfma_f32_16x16x32_bf16 v[128:131], a[52:55], a[84:87], v[128:131]
    v_mfma_f32_16x16x32_bf16 v[160:163], a[52:55], a[88:91], v[160:163]
    s_waitcnt vmcnt(16) lgkmcnt(0)
    s_barrier
    s_add_u32 m0, s81, 81920
    v_mfma_f32_16x16x32_bf16 v[192:195], a[52:55], a[92:95], v[192:195]
    s_add_u32 s63, s81, 16384
    buffer_load_dwordx4 v6, s[32:35], s63 offen offset:0 lds
    v_mfma_f32_16x16x32_bf16 v[224:227], a[52:55], a[96:99], v[224:227]
    ds_read_b64_tr_b16 a[0:1], v64 offset:0
    ds_read_b64_tr_b16 a[2:3], v64 offset:1024
    v_mfma_f32_16x16x32_bf16 v[112:115], a[52:55], a[100:103], v[112:115]
    ds_read_b128 a[32:35], v66 offset:0
    v_mfma_f32_16x16x32_bf16 v[132:135], a[56:59], a[84:87], v[132:135]
    ds_read_b128 a[36:39], v66 offset:2048
    v_mfma_f32_16x16x32_bf16 v[164:167], a[56:59], a[88:91], v[164:167]
    buffer_load_dwordx4 v7, s[32:35], s63 offen offset:1024 lds
    v_mfma_f32_16x16x32_bf16 v[196:199], a[56:59], a[92:95], v[196:199]
    ds_read_b128 a[40:43], v66 offset:4096
    ds_read_b128 a[44:47], v66 offset:6144
    v_mfma_f32_16x16x32_bf16 v[228:231], a[56:59], a[96:99], v[228:231]
    ds_read_b128 a[48:51], v67 offset:0
    v_mfma_f32_16x16x32_bf16 v[136:139], a[60:63], a[84:87], v[136:139]
    ds_read_b64_tr_b16 a[4:5], v65 offset:0
    v_mfma_f32_16x16x32_bf16 v[168:171], a[60:63], a[88:91], v[168:171]
    buffer_load_dwordx4 v6, s[32:35], s63 offen offset:2048 lds
    v_mfma_f32_16x16x32_bf16 v[200:203], a[60:63], a[92:95], v[200:203]
    ds_read_b64_tr_b16 a[6:7], v65 offset:1024
    ds_read_b64_tr_b16 a[8:9], v64 offset:256
    v_mfma_f32_16x16x32_bf16 v[232:235], a[60:63], a[96:99], v[232:235]
    ds_read_b64_tr_b16 a[10:11], v64 offset:1280
    v_mfma_f32_16x16x32_bf16 v[116:119], a[60:63], a[100:103], v[116:119]
    ds_read_b64_tr_b16 a[12:13], v65 offset:256
    v_mfma_f32_16x16x32_bf16 v[140:143], a[64:67], a[84:87], v[140:143]
    buffer_load_dwordx4 v7, s[32:35], s63 offen offset:3072 lds
    v_mfma_f32_16x16x32_bf16 v[172:175], a[64:67], a[88:91], v[172:175]
    ds_read_b64_tr_b16 a[14:15], v65 offset:1280
    ds_read_b64_tr_b16 a[16:17], v64 offset:512
    v_mfma_f32_16x16x32_bf16 v[204:207], a[64:67], a[92:95], v[204:207]
    ds_read_b64_tr_b16 a[18:19], v64 offset:1536
    v_mfma_f32_16x16x32_bf16 v[236:239], a[64:67], a[96:99], v[236:239]
    ds_read_b64_tr_b16 a[20:21], v65 offset:512
    v_mfma_f32_16x16x32_bf16 v[144:147], a[68:71], a[84:87], v[144:147]
    ds_read_b64_tr_b16 a[22:23], v65 offset:1536
    v_mfma_f32_16x16x32_bf16 v[176:179], a[68:71], a[88:91], v[176:179]
    ds_read_b64_tr_b16 a[24:25], v64 offset:768
    v_mfma_f32_16x16x32_bf16 v[208:211], a[68:71], a[92:95], v[208:211]
    ds_read_b64_tr_b16 a[26:27], v64 offset:1792
    v_mfma_f32_16x16x32_bf16 v[240:243], a[68:71], a[96:99], v[240:243]
    ds_read_b64_tr_b16 a[28:29], v65 offset:768
    v_mfma_f32_16x16x32_bf16 v[120:123], a[68:71], a[100:103], v[120:123]
    ds_read_b64_tr_b16 a[30:31], v65 offset:1792
    v_mfma_f32_16x16x32_bf16 v[148:151], a[72:75], a[84:87], v[148:151]
    v_mfma_f32_16x16x32_bf16 v[180:183], a[72:75], a[88:91], v[180:183]
    v_mfma_f32_16x16x32_bf16 v[212:215], a[72:75], a[92:95], v[212:215]
    v_mfma_f32_16x16x32_bf16 v[244:247], a[72:75], a[96:99], v[244:247]
    v_mfma_f32_16x16x32_bf16 v[152:155], a[76:79], a[84:87], v[152:155]
    v_mfma_f32_16x16x32_bf16 v[184:187], a[76:79], a[88:91], v[184:187]
    v_mfma_f32_16x16x32_bf16 v[216:219], a[76:79], a[92:95], v[216:219]
    v_mfma_f32_16x16x32_bf16 v[248:251], a[76:79], a[96:99], v[248:251]
    v_mfma_f32_16x16x32_bf16 v[124:127], a[76:79], a[100:103], v[124:127]
    v_mfma_f32_16x16x32_bf16 v[156:159], a[80:83], a[84:87], v[156:159]
    v_mfma_f32_16x16x32_bf16 v[188:191], a[80:83], a[88:91], v[188:191]
    v_mfma_f32_16x16x32_bf16 v[220:223], a[80:83], a[92:95], v[220:223]
    v_mfma_f32_16x16x32_bf16 v[252:255], a[80:83], a[96:99], v[252:255]
    s_waitcnt lgkmcnt(0)
    v_mfma_f32_16x16x32_bf16 v[112:115], a[0:3], a[48:51], v[112:115]
    v_mfma_f32_16x16x32_bf16 v[116:119], a[8:11], a[48:51], v[116:119]
    s_waitcnt vmcnt(16) lgkmcnt(0)
    s_barrier
    s_add_u32 m0, s81, 32768
    v_mfma_f32_16x16x32_bf16 v[120:123], a[16:19], a[48:51], v[120:123]
    s_add_u32 s63, s81, 32768
    buffer_load_dwordx4 v6, s[28:31], s63 offen offset:0 lds
    v_mfma_f32_16x16x32_bf16 v[124:127], a[24:27], a[48:51], v[124:127]
    ds_read_b64_tr_b16 a[52:53], v64 offset:16384
    ds_read_b64_tr_b16 a[54:55], v64 offset:17408
    v_mfma_f32_16x16x32_bf16 v[128:131], a[0:3], a[32:35], v[128:131]
    ds_read_b128 a[84:87], v66 offset:512
    ds_read_b128 a[88:91], v66 offset:2560
    v_mfma_f32_16x16x32_bf16 v[132:135], a[4:7], a[32:35], v[132:135]
    ds_read_b128 a[92:95], v66 offset:4608
    ds_read_b128 a[96:99], v66 offset:6656
    v_mfma_f32_16x16x32_bf16 v[136:139], a[8:11], a[32:35], v[136:139]
    buffer_load_dwordx4 v7, s[28:31], s63 offen offset:1024 lds
    v_mfma_f32_16x16x32_bf16 v[140:143], a[12:15], a[32:35], v[140:143]
    ds_read_b128 a[100:103], v67 offset:512
    ds_read_b64_tr_b16 a[56:57], v65 offset:16384
    v_mfma_f32_16x16x32_bf16 v[144:147], a[16:19], a[32:35], v[144:147]
    ds_read_b64_tr_b16 a[58:59], v65 offset:17408
    ds_read_b64_tr_b16 a[60:61], v64 offset:16640
    v_mfma_f32_16x16x32_bf16 v[148:151], a[20:23], a[32:35], v[148:151]
    ds_read_b64_tr_b16 a[62:63], v64 offset:17664
    ds_read_b64_tr_b16 a[64:65], v65 offset:16640
    v_mfma_f32_16x16x32_bf16 v[152:155], a[24:27], a[32:35], v[152:155]
    buffer_load_dwordx4 v6, s[28:31], s63 offen offset:2048 lds
    v_mfma_f32_16x16x32_bf16 v[156:159], a[28:31], a[32:35], v[156:159]
    ds_read_b64_tr_b16 a[66:67], v65 offset:17664
    ds_read_b64_tr_b16 a[68:69], v64 offset:16896
    v_mfma_f32_16x16x32_bf16 v[160:163], a[0:3], a[36:39], v[160:163]
    ds_read_b64_tr_b16 a[70:71], v64 offset:17920
    ds_read_b64_tr_b16 a[72:73], v65 offset:16896
    v_mfma_f32_16x16x32_bf16 v[164:167], a[4:7], a[36:39], v[164:167]
    ds_read_b64_tr_b16 a[74:75], v65 offset:17920
    ds_read_b64_tr_b16 a[76:77], v64 offset:17152
    v_mfma_f32_16x16x32_bf16 v[168:171], a[8:11], a[36:39], v[168:171]
    buffer_load_dwordx4 v7, s[28:31], s63 offen offset:3072 lds
    v_mfma_f32_16x16x32_bf16 v[172:175], a[12:15], a[36:39], v[172:175]
    ds_read_b64_tr_b16 a[78:79], v64 offset:18176
    ds_read_b64_tr_b16 a[80:81], v65 offset:17152
    v_mfma_f32_16x16x32_bf16 v[176:179], a[16:19], a[36:39], v[176:179]
    ds_read_b64_tr_b16 a[82:83], v65 offset:18176
    v_mfma_f32_16x16x32_bf16 v[180:183], a[20:23], a[36:39], v[180:183]
    v_mfma_f32_16x16x32_bf16 v[184:187], a[24:27], a[36:39], v[184:187]
    v_mfma_f32_16x16x32_bf16 v[188:191], a[28:31], a[36:39], v[188:191]
    s_waitcnt lgkmcnt(0)
    v_mfma_f32_16x16x32_bf16 v[112:115], a[52:55], a[100:103], v[112:115]
    v_mfma_f32_16x16x32_bf16 v[116:119], a[60:63], a[100:103], v[116:119]
    v_mfma_f32_16x16x32_bf16 v[120:123], a[68:71], a[100:103], v[120:123]
    v_mfma_f32_16x16x32_bf16 v[124:127], a[76:79], a[100:103], v[124:127]
    v_mfma_f32_16x16x32_bf16 v[128:131], a[52:55], a[84:87], v[128:131]
    v_mfma_f32_16x16x32_bf16 v[132:135], a[56:59], a[84:87], v[132:135]
    v_mfma_f32_16x16x32_bf16 v[136:139], a[60:63], a[84:87], v[136:139]
    v_mfma_f32_16x16x32_bf16 v[140:143], a[64:67], a[84:87], v[140:143]
    v_mfma_f32_16x16x32_bf16 v[144:147], a[68:71], a[84:87], v[144:147]
    v_mul_f32 v112, s50, v112
    v_mul_f32 v113, s50, v113
    v_mfma_f32_16x16x32_bf16 v[148:151], a[72:75], a[84:87], v[148:151]
    v_mul_f32 v114, s50, v114
    v_mul_f32 v115, s50, v115
    v_mfma_f32_16x16x32_bf16 v[152:155], a[76:79], a[84:87], v[152:155]
    v_mul_f32 v116, s50, v116
    v_mul_f32 v117, s50, v117
    v_mfma_f32_16x16x32_bf16 v[156:159], a[80:83], a[84:87], v[156:159]
    v_mul_f32 v118, s50, v118
    v_mul_f32 v119, s50, v119
    v_mfma_f32_16x16x32_bf16 v[192:195], a[0:3], a[40:43], v[192:195]
    v_mul_f32 v120, s50, v120
    v_mul_f32 v121, s50, v121
    v_mfma_f32_16x16x32_bf16 v[196:199], a[4:7], a[40:43], v[196:199]
    v_mul_f32 v122, s50, v122
    v_mul_f32 v123, s50, v123
    v_mfma_f32_16x16x32_bf16 v[200:203], a[8:11], a[40:43], v[200:203]
    v_mul_f32 v124, s50, v124
    v_mul_f32 v125, s50, v125
    v_mfma_f32_16x16x32_bf16 v[204:207], a[12:15], a[40:43], v[204:207]
    v_mul_f32 v126, s50, v126
    v_mul_f32 v127, s50, v127
    v_mfma_f32_16x16x32_bf16 v[208:211], a[16:19], a[40:43], v[208:211]
    v_cvt_pk_bf16_f32 v112, v112, v113
    v_cvt_pk_bf16_f32 v113, v114, v115
    v_mfma_f32_16x16x32_bf16 v[212:215], a[20:23], a[40:43], v[212:215]
    ds_write_b64 v68, v[112:113] offset:0
    v_mfma_f32_16x16x32_bf16 v[216:219], a[24:27], a[40:43], v[216:219]
    v_cvt_pk_bf16_f32 v114, v116, v117
    v_cvt_pk_bf16_f32 v115, v118, v119
    v_mfma_f32_16x16x32_bf16 v[220:223], a[28:31], a[40:43], v[220:223]
    ds_write_b64 v68, v[114:115] offset:1024
    v_mfma_f32_16x16x32_bf16 v[160:163], a[52:55], a[88:91], v[160:163]
    v_cvt_pk_bf16_f32 v116, v120, v121
    v_cvt_pk_bf16_f32 v117, v122, v123
    v_mfma_f32_16x16x32_bf16 v[164:167], a[56:59], a[88:91], v[164:167]
    ds_write_b64 v68, v[116:117] offset:2048
    v_mfma_f32_16x16x32_bf16 v[168:171], a[60:63], a[88:91], v[168:171]
    v_cvt_pk_bf16_f32 v118, v124, v125
    v_cvt_pk_bf16_f32 v119, v126, v127
    v_mfma_f32_16x16x32_bf16 v[172:175], a[64:67], a[88:91], v[172:175]
    ds_write_b64 v68, v[118:119] offset:3072
    v_mfma_f32_16x16x32_bf16 v[176:179], a[68:71], a[88:91], v[176:179]
    v_mul_f32 v128, s50, v128
    v_mul_f32 v129, s50, v129
    v_mfma_f32_16x16x32_bf16 v[180:183], a[72:75], a[88:91], v[180:183]
    v_mul_f32 v130, s50, v130
    v_mul_f32 v131, s50, v131
    v_mfma_f32_16x16x32_bf16 v[184:187], a[76:79], a[88:91], v[184:187]
    s_add_u32 m0, s81, 98304
    s_add_u32 s63, s81, 32768
    v_mul_f32 v132, s50, v132
    v_mfma_f32_16x16x32_bf16 v[188:191], a[80:83], a[88:91], v[188:191]
    v_mul_f32 v133, s50, v133
    v_mul_f32 v134, s50, v134
    v_mfma_f32_16x16x32_bf16 v[224:227], a[0:3], a[44:47], v[224:227]
    s_waitcnt vmcnt(16) lgkmcnt(0)
    s_barrier
    ds_read_b128 a[192:195], v0 offset:0
    v_mfma_f32_16x16x32_bf16 v[228:231], a[4:7], a[44:47], v[228:231]
    buffer_load_dwordx4 v6, s[32:35], s63 offen offset:0 lds
    v_mfma_f32_16x16x32_bf16 v[232:235], a[8:11], a[44:47], v[232:235]
    ds_read_b128 a[196:199], v0 offset:256
    ds_read_b128 a[200:203], v0 offset:512
    v_mfma_f32_16x16x32_bf16 v[236:239], a[12:15], a[44:47], v[236:239]
    ds_read_b128 a[204:207], v0 offset:768
    ds_read_b128 a[208:211], v0 offset:4096
    v_mfma_f32_16x16x32_bf16 v[240:243], a[16:19], a[44:47], v[240:243]
    ds_read_b128 a[212:215], v0 offset:4352
    ds_read_b128 a[216:219], v0 offset:4608
    v_mfma_f32_16x16x32_bf16 v[244:247], a[20:23], a[44:47], v[244:247]
    ds_read_b128 a[220:223], v0 offset:4864
    ds_read_b128 v[96:99], v69 offset:0
    v_mfma_f32_16x16x32_bf16 v[248:251], a[24:27], a[44:47], v[248:251]
    ds_read_b128 v[100:103], v69 offset:1024
    ds_read_b128 v[104:107], v69 offset:2048
    v_mfma_f32_16x16x32_bf16 v[252:255], a[28:31], a[44:47], v[252:255]
    ds_read_b128 v[108:111], v69 offset:3072
    ds_read_b128 a[104:107], v1 offset:0
    v_mfma_f32_16x16x32_bf16 v[192:195], a[52:55], a[92:95], v[192:195]
    ds_read_b128 a[108:111], v1 offset:256
    ds_read_b128 a[112:115], v1 offset:512
    v_mfma_f32_16x16x32_bf16 v[196:199], a[56:59], a[92:95], v[196:199]
    ds_read_b128 a[116:119], v1 offset:768
    ds_read_b128 a[120:123], v1 offset:4096
    v_mfma_f32_16x16x32_bf16 v[200:203], a[60:63], a[92:95], v[200:203]
    ds_read_b128 a[124:127], v1 offset:4352
    ds_read_b128 a[128:131], v1 offset:4608
    v_mfma_f32_16x16x32_bf16 v[204:207], a[64:67], a[92:95], v[204:207]
    ds_read_b128 a[132:135], v1 offset:4864
    v_mul_f32 v135, s50, v135
    v_mfma_f32_16x16x32_bf16 v[208:211], a[68:71], a[92:95], v[208:211]
    v_cvt_pk_bf16_f32 v32, v128, v129
    v_cvt_pk_bf16_f32 v34, v132, v133
    v_mfma_f32_16x16x32_bf16 v[212:215], a[72:75], a[92:95], v[212:215]
    v_cvt_pk_bf16_f32 v33, v130, v131
    v_cvt_pk_bf16_f32 v35, v134, v135
    v_mfma_f32_16x16x32_bf16 v[216:219], a[76:79], a[92:95], v[216:219]
    v_mul_f32 v136, s50, v136
    v_mul_f32 v137, s50, v137
    v_mfma_f32_16x16x32_bf16 v[220:223], a[80:83], a[92:95], v[220:223]
    s_waitcnt lgkmcnt(0)
    v_mul_f32 v138, s50, v138
    v_mul_f32 v139, s50, v139
    v_permlane32_swap_b32 v32, v34
    v_permlane32_swap_b32 v33, v35
    s_nop 0
    s_nop 0
    v_mfma_f32_16x16x32_bf16 v[132:135], a[192:195], v[32:35], 0
    v_mul_f32 v140, s50, v140
    v_mul_f32 v141, s50, v141
    v_mul_f32 v142, s50, v142
    v_mul_f32 v143, s50, v143
    v_cvt_pk_bf16_f32 v36, v136, v137
    v_cvt_pk_bf16_f32 v38, v140, v141
    v_cvt_pk_bf16_f32 v37, v138, v139
    v_cvt_pk_bf16_f32 v39, v142, v143
    v_permlane32_swap_b32 v36, v38
    s_nop 0
    v_permlane32_swap_b32 v37, v39
    s_nop 1
    v_mfma_f32_16x16x32_bf16 v[132:135], a[196:199], v[36:39], v[132:135]
    buffer_load_dwordx4 v7, s[32:35], s63 offen offset:1024 lds
    v_mul_f32 v144, s50, v144
    v_mul_f32 v145, s50, v145
    v_mul_f32 v146, s50, v146
    v_mul_f32 v147, s50, v147
    v_mul_f32 v148, s50, v148
    v_mul_f32 v149, s50, v149
    v_mul_f32 v150, s50, v150
    v_mul_f32 v151, s50, v151
    v_cvt_pk_bf16_f32 v40, v144, v145
    v_cvt_pk_bf16_f32 v42, v148, v149
    v_cvt_pk_bf16_f32 v41, v146, v147
    v_cvt_pk_bf16_f32 v43, v150, v151
    v_permlane32_swap_b32 v40, v42
    s_nop 0
    v_permlane32_swap_b32 v41, v43
    s_nop 1
    v_mfma_f32_16x16x32_bf16 v[132:135], a[200:203], v[40:43], v[132:135]
    v_mul_f32 v152, s50, v152
    v_mul_f32 v153, s50, v153
    v_mul_f32 v154, s50, v154
    v_mul_f32 v155, s50, v155
    v_mul_f32 v156, s50, v156
    v_mul_f32 v157, s50, v157
    v_mul_f32 v158, s50, v158
    v_mul_f32 v159, s50, v159
    v_cvt_pk_bf16_f32 v44, v152, v153
    v_cvt_pk_bf16_f32 v46, v156, v157
    v_cvt_pk_bf16_f32 v45, v154, v155
    v_cvt_pk_bf16_f32 v47, v158, v159
    v_permlane32_swap_b32 v44, v46
    s_nop 0
    v_permlane32_swap_b32 v45, v47
    s_nop 1
    v_mfma_f32_16x16x32_bf16 v[132:135], a[204:207], v[44:47], v[132:135]
    v_mul_f32 v160, s50, v160
    v_mul_f32 v161, s50, v161
    v_mfma_f32_16x16x32_bf16 v[136:139], a[208:211], v[32:35], 0
    v_mul_f32 v162, s50, v162
    v_mul_f32 v163, s50, v163
    v_mfma_f32_16x16x32_bf16 v[136:139], a[212:215], v[36:39], v[136:139]
    v_mul_f32 v164, s50, v164
    v_mul_f32 v165, s50, v165
    v_mfma_f32_16x16x32_bf16 v[136:139], a[216:219], v[40:43], v[136:139]
    v_mul_f32 v166, s50, v166
    v_mul_f32 v167, s50, v167
    v_mfma_f32_16x16x32_bf16 v[136:139], a[220:223], v[44:47], v[136:139]
    v_cvt_pk_bf16_f32 v48, v160, v161
    v_cvt_pk_bf16_f32 v50, v164, v165
    v_mfma_f32_16x16x32_bf16 v[224:227], a[52:55], a[96:99], v[224:227]
    v_cvt_pk_bf16_f32 v49, v162, v163
    v_cvt_pk_bf16_f32 v51, v166, v167
    v_mfma_f32_16x16x32_bf16 v[228:231], a[56:59], a[96:99], v[228:231]
    v_mul_f32 v168, s50, v168
    v_mul_f32 v169, s50, v169
    v_mfma_f32_16x16x32_bf16 v[232:235], a[60:63], a[96:99], v[232:235]
    v_mul_f32 v170, s50, v170
    v_mul_f32 v171, s50, v171
    v_mfma_f32_16x16x32_bf16 v[236:239], a[64:67], a[96:99], v[236:239]
    v_mul_f32 v172, s50, v172
    v_mul_f32 v173, s50, v173
    v_mfma_f32_16x16x32_bf16 v[240:243], a[68:71], a[96:99], v[240:243]
    v_mul_f32 v174, s50, v174
    v_mul_f32 v175, s50, v175
    v_mfma_f32_16x16x32_bf16 v[244:247], a[72:75], a[96:99], v[244:247]
    v_permlane32_swap_b32 v48, v50
    v_permlane32_swap_b32 v49, v51
    v_mfma_f32_16x16x32_bf16 v[248:251], a[76:79], a[96:99], v[248:251]
    v_cvt_pk_bf16_f32 v52, v168, v169
    v_cvt_pk_bf16_f32 v54, v172, v173
    v_mfma_f32_16x16x32_bf16 v[252:255], a[80:83], a[96:99], v[252:255]
    v_cvt_pk_bf16_f32 v53, v170, v171
    v_cvt_pk_bf16_f32 v55, v174, v175
    v_mfma_f32_16x16x32_bf16 v[140:143], a[192:195], v[48:51], 0
    v_mul_f32 v176, s50, v176
    v_mul_f32 v177, s50, v177
    v_permlane32_swap_b32 v52, v54
    v_permlane32_swap_b32 v53, v55
    s_nop 0
    s_nop 0
    v_mfma_f32_16x16x32_bf16 v[140:143], a[196:199], v[52:55], v[140:143]
    v_mul_f32 v178, s50, v178
    v_mul_f32 v179, s50, v179
    v_mul_f32 v180, s50, v180
    v_mul_f32 v181, s50, v181
    v_mul_f32 v182, s50, v182
    v_mul_f32 v183, s50, v183
    v_cvt_pk_bf16_f32 v56, v176, v177
    v_cvt_pk_bf16_f32 v58, v180, v181
    v_cvt_pk_bf16_f32 v57, v178, v179
    v_cvt_pk_bf16_f32 v59, v182, v183
    v_permlane32_swap_b32 v56, v58
    s_nop 0
    v_permlane32_swap_b32 v57, v59
    s_nop 1
    v_mfma_f32_16x16x32_bf16 v[140:143], a[200:203], v[56:59], v[140:143]
    v_mul_f32 v184, s50, v184
    v_mul_f32 v185, s50, v185
    v_mul_f32 v186, s50, v186
    v_mul_f32 v187, s50, v187
    v_mul_f32 v188, s50, v188
    v_mul_f32 v189, s50, v189
    v_mul_f32 v190, s50, v190
    v_mul_f32 v191, s50, v191
    v_cvt_pk_bf16_f32 v60, v184, v185
    v_cvt_pk_bf16_f32 v62, v188, v189
    v_cvt_pk_bf16_f32 v61, v186, v187
    v_cvt_pk_bf16_f32 v63, v190, v191
    v_permlane32_swap_b32 v60, v62
    s_nop 0
    v_permlane32_swap_b32 v61, v63
    s_nop 1
    v_mfma_f32_16x16x32_bf16 v[140:143], a[204:207], v[60:63], v[140:143]
    buffer_load_dwordx4 v6, s[32:35], s63 offen offset:2048 lds
    v_mfma_f32_16x16x32_bf16 v[144:147], a[208:211], v[48:51], 0
    v_mul_f32 v192, s50, v192
    v_mul_f32 v193, s50, v193
    v_mfma_f32_16x16x32_bf16 v[144:147], a[212:215], v[52:55], v[144:147]
    v_mul_f32 v194, s50, v194
    v_mul_f32 v195, s50, v195
    v_mfma_f32_16x16x32_bf16 v[144:147], a[216:219], v[56:59], v[144:147]
    v_mul_f32 v196, s50, v196
    v_mul_f32 v197, s50, v197
    v_mfma_f32_16x16x32_bf16 v[144:147], a[220:223], v[60:63], v[144:147]
    v_mul_f32 v198, s50, v198
    v_mul_f32 v199, s50, v199
    v_mfma_f32_16x16x32_bf16 v[164:167], a[192:195], v[96:99], 0
    v_cvt_pk_bf16_f32 v64, v192, v193
    v_cvt_pk_bf16_f32 v66, v196, v197
    v_mfma_f32_16x16x32_bf16 v[164:167], a[196:199], v[100:103], v[164:167]
    v_cvt_pk_bf16_f32 v65, v194, v195
    v_cvt_pk_bf16_f32 v67, v198, v199
    v_mfma_f32_16x16x32_bf16 v[164:167], a[200:203], v[104:107], v[164:167]
    v_mul_f32 v200, s50, v200
    v_mul_f32 v201, s50, v201
    v_mfma_f32_16x16x32_bf16 v[164:167], a[204:207], v[108:111], v[164:167]
    v_mul_f32 v202, s50, v202
    v_mul_f32 v203, s50, v203
    v_mfma_f32_16x16x32_bf16 v[168:171], a[208:211], v[96:99], 0
    v_mul_f32 v204, s50, v204
    v_mul_f32 v205, s50, v205
    v_mfma_f32_16x16x32_bf16 v[168:171], a[212:215], v[100:103], v[168:171]
    v_mul_f32 v206, s50, v206
    v_mul_f32 v207, s50, v207
    v_mfma_f32_16x16x32_bf16 v[168:171], a[216:219], v[104:107], v[168:171]
    v_permlane32_swap_b32 v64, v66
    v_permlane32_swap_b32 v65, v67
    v_mfma_f32_16x16x32_bf16 v[168:171], a[220:223], v[108:111], v[168:171]
    v_cvt_pk_bf16_f32 v68, v200, v201
    v_cvt_pk_bf16_f32 v70, v204, v205
    v_mfma_f32_16x16x32_bf16 v[148:151], a[192:195], v[64:67], 0
    v_cvt_pk_bf16_f32 v69, v202, v203
    v_cvt_pk_bf16_f32 v71, v206, v207
    v_permlane32_swap_b32 v68, v70
    s_nop 0
    v_permlane32_swap_b32 v69, v71
    s_nop 1
    v_mfma_f32_16x16x32_bf16 v[148:151], a[196:199], v[68:71], v[148:151]
    v_mul_f32 v208, s50, v208
    v_mul_f32 v209, s50, v209
    v_mul_f32 v210, s50, v210
    v_mul_f32 v211, s50, v211
    v_mul_f32 v212, s50, v212
    v_mul_f32 v213, s50, v213
    v_mul_f32 v214, s50, v214
    v_mul_f32 v215, s50, v215
    v_cvt_pk_bf16_f32 v72, v208, v209
    v_cvt_pk_bf16_f32 v74, v212, v213
    v_cvt_pk_bf16_f32 v73, v210, v211
    v_cvt_pk_bf16_f32 v75, v214, v215
    v_permlane32_swap_b32 v72, v74
    s_nop 0
    v_permlane32_swap_b32 v73, v75
    s_nop 1
    v_mfma_f32_16x16x32_bf16 v[148:151], a[200:203], v[72:75], v[148:151]
    v_mul_f32 v216, s50, v216
    v_mul_f32 v217, s50, v217
    v_mul_f32 v218, s50, v218
    v_mul_f32 v219, s50, v219
    v_mul_f32 v220, s50, v220
    v_mul_f32 v221, s50, v221
    v_mul_f32 v222, s50, v222
    v_mul_f32 v223, s50, v223
    v_cvt_pk_bf16_f32 v76, v216, v217
    v_cvt_pk_bf16_f32 v78, v220, v221
    v_cvt_pk_bf16_f32 v77, v218, v219
    v_cvt_pk_bf16_f32 v79, v222, v223
    v_permlane32_swap_b32 v76, v78
    s_nop 0
    v_permlane32_swap_b32 v77, v79
    s_nop 1
    v_mfma_f32_16x16x32_bf16 v[148:151], a[204:207], v[76:79], v[148:151]
    v_max3_f32 v216, v132, v133, v134
    v_max3_f32 v217, v135, v136, v137
    v_mfma_f32_16x16x32_bf16 v[152:155], a[208:211], v[64:67], 0
    v_max3_f32 v216, v216, v138, v139
    v_max_f32 v216, v216, v217
    v_mfma_f32_16x16x32_bf16 v[152:155], a[212:215], v[68:71], v[152:155]
    buffer_load_dwordx4 v7, s[32:35], s63 offen offset:3072 lds
    v_mfma_f32_16x16x32_bf16 v[152:155], a[216:219], v[72:75], v[152:155]
    v_mov_b32 v217, v216
    v_mul_f32 v224, s50, v224
    v_mfma_f32_16x16x32_bf16 v[152:155], a[220:223], v[76:79], v[152:155]
    v_permlane32_swap_b32 v216, v217
    v_max_f32 v216, v216, v217
    v_mov_b32 v217, v216
    s_nop 0
    s_nop 0
    v_permlane16_swap_b32 v216, v217
    v_min_f32_e64 v112, -v216, -v217
    v_min_f32_e64 v113, -v216, -v217
    v_min_f32_e64 v114, -v216, -v217
    v_min_f32_e64 v115, -v216, -v217
    s_nop 0
    s_nop 0
    v_mfma_f32_16x16x32_bf16 v[172:175], a[104:107], v[32:35], v[112:115]
    v_add_f32 v132, v132, v112
    v_add_f32 v133, v133, v112
    v_mfma_f32_16x16x32_bf16 v[172:175], a[108:111], v[36:39], v[172:175]
    v_add_f32 v134, v134, v112
    v_add_f32 v135, v135, v112
    v_mfma_f32_16x16x32_bf16 v[172:175], a[112:115], v[40:43], v[172:175]
    v_add_f32 v136, v136, v112
    v_add_f32 v137, v137, v112
    v_mfma_f32_16x16x32_bf16 v[172:175], a[116:119], v[44:47], v[172:175]
    v_add_f32 v138, v138, v112
    v_add_f32 v139, v139, v112
    v_mfma_f32_16x16x32_bf16 v[176:179], a[120:123], v[32:35], v[112:115]
    v_mul_f32 v225, s50, v225
    v_mul_f32 v226, s50, v226
    v_mfma_f32_16x16x32_bf16 v[176:179], a[124:127], v[36:39], v[176:179]
    v_mul_f32 v227, s50, v227
    v_mul_f32 v228, s50, v228
    v_mfma_f32_16x16x32_bf16 v[176:179], a[128:131], v[40:43], v[176:179]
    v_mul_f32 v229, s50, v229
    v_mul_f32 v230, s50, v230
    v_mfma_f32_16x16x32_bf16 v[176:179], a[132:135], v[44:47], v[176:179]
    v_mul_f32 v231, s50, v231
    v_cvt_pk_bf16_f32 v80, v224, v225
    v_cvt_pk_bf16_f32 v82, v228, v229
    v_cvt_pk_bf16_f32 v81, v226, v227
    v_cvt_pk_bf16_f32 v83, v230, v231
    v_permlane32_swap_b32 v80, v82
    s_nop 0
    v_permlane32_swap_b32 v81, v83
    s_nop 1
    v_mfma_f32_16x16x32_bf16 v[156:159], a[192:195], v[80:83], 0
    v_mul_f32 v232, s50, v232
    v_mul_f32 v233, s50, v233
    v_mul_f32 v234, s50, v234
    v_mul_f32 v235, s50, v235
    v_mul_f32 v236, s50, v236
    v_mul_f32 v237, s50, v237
    v_mul_f32 v238, s50, v238
    v_mul_f32 v239, s50, v239
    v_cvt_pk_bf16_f32 v84, v232, v233
    v_cvt_pk_bf16_f32 v86, v236, v237
    v_cvt_pk_bf16_f32 v85, v234, v235
    v_cvt_pk_bf16_f32 v87, v238, v239
    v_permlane32_swap_b32 v84, v86
    s_nop 0
    v_permlane32_swap_b32 v85, v87
    s_nop 1
    v_mfma_f32_16x16x32_bf16 v[156:159], a[196:199], v[84:87], v[156:159]
    v_mul_f32 v240, s50, v240
    v_mul_f32 v241, s50, v241
    v_mul_f32 v242, s50, v242
    v_mul_f32 v243, s50, v243
    v_mul_f32 v244, s50, v244
    v_mul_f32 v245, s50, v245
    v_mul_f32 v246, s50, v246
    v_mul_f32 v247, s50, v247
    v_cvt_pk_bf16_f32 v88, v240, v241
    v_cvt_pk_bf16_f32 v90, v244, v245
    v_cvt_pk_bf16_f32 v89, v242, v243
    v_cvt_pk_bf16_f32 v91, v246, v247
    v_permlane32_swap_b32 v88, v90
    s_nop 0
    v_permlane32_swap_b32 v89, v91
    s_nop 1
    v_mfma_f32_16x16x32_bf16 v[156:159], a[200:203], v[88:91], v[156:159]
    v_mul_f32 v248, s50, v248
    v_mul_f32 v249, s50, v249
    v_mul_f32 v250, s50, v250
    v_mul_f32 v251, s50, v251
    v_mul_f32 v252, s50, v252
    v_mul_f32 v253, s50, v253
    v_mul_f32 v254, s50, v254
    v_mul_f32 v255, s50, v255
    v_cvt_pk_bf16_f32 v92, v248, v249
    v_cvt_pk_bf16_f32 v94, v252, v253
    v_cvt_pk_bf16_f32 v93, v250, v251
    v_cvt_pk_bf16_f32 v95, v254, v255
    v_permlane32_swap_b32 v92, v94
    s_nop 0
    v_permlane32_swap_b32 v93, v95
    s_nop 1
    v_mfma_f32_16x16x32_bf16 v[156:159], a[204:207], v[92:95], v[156:159]
    v_max3_f32 v218, v140, v141, v142
    v_max3_f32 v219, v143, v144, v145
    v_mfma_f32_16x16x32_bf16 v[160:163], a[208:211], v[80:83], 0
    v_max3_f32 v218, v218, v146, v147
    v_max_f32 v218, v218, v219
    v_mfma_f32_16x16x32_bf16 v[160:163], a[212:215], v[84:87], v[160:163]
    v_mov_b32 v219, v218
    v_max3_f32 v216, v148, v149, v150
    v_mfma_f32_16x16x32_bf16 v[160:163], a[216:219], v[88:91], v[160:163]
    s_add_u32 m0, s81, 49152
    s_add_u32 s63, s81, 49152
    v_permlane32_swap_b32 v218, v219
    v_mfma_f32_16x16x32_bf16 v[160:163], a[220:223], v[92:95], v[160:163]
    buffer_load_dwordx4 v6, s[28:31], s63 offen offset:0 lds
    v_max_f32 v218, v218, v219
    v_mov_b32 v219, v218
    s_nop 0
    s_nop 0
    v_permlane16_swap_b32 v218, v219
    v_min_f32_e64 v116, -v218, -v219
    v_min_f32_e64 v117, -v218, -v219
    v_min_f32_e64 v118, -v218, -v219
    v_min_f32_e64 v119, -v218, -v219
    s_nop 0
    s_nop 0
    v_mfma_f32_16x16x32_bf16 v[180:183], a[104:107], v[48:51], v[116:119]
    s_waitcnt vmcnt(17)
    ds_write_b128 v26, a[156:159] offset:0
    v_mfma_f32_16x16x32_bf16 v[180:183], a[108:111], v[52:55], v[180:183]
    ds_write_b128 v26, a[160:163] offset:1024
    v_mfma_f32_16x16x32_bf16 v[180:183], a[112:115], v[56:59], v[180:183]
    ds_write_b128 v26, a[164:167] offset:2048
    v_mfma_f32_16x16x32_bf16 v[180:183], a[116:119], v[60:63], v[180:183]
    ds_write_b128 v26, a[168:171] offset:3072
    v_mfma_f32_16x16x32_bf16 v[184:187], a[120:123], v[48:51], v[116:119]
    v_add_f32 v140, v140, v116
    v_add_f32 v141, v141, v116
    v_mfma_f32_16x16x32_bf16 v[184:187], a[124:127], v[52:55], v[184:187]
    v_add_f32 v142, v142, v116
    v_add_f32 v143, v143, v116
    v_mfma_f32_16x16x32_bf16 v[184:187], a[128:131], v[56:59], v[184:187]
    v_add_f32 v144, v144, v116
    v_add_f32 v145, v145, v116
    v_mfma_f32_16x16x32_bf16 v[184:187], a[132:135], v[60:63], v[184:187]
    v_add_f32 v146, v146, v116
    v_add_f32 v147, v147, v116
    v_max3_f32 v217, v151, v152, v153
    v_max3_f32 v216, v216, v154, v155
    v_max_f32 v216, v216, v217
    v_mov_b32 v217, v216
    s_nop 0
    s_nop 0
    v_permlane32_swap_b32 v216, v217
    v_max_f32 v216, v216, v217
    v_mov_b32 v217, v216
    s_nop 0
    s_nop 0
    v_permlane16_swap_b32 v216, v217
    v_min_f32_e64 v120, -v216, -v217
    v_min_f32_e64 v121, -v216, -v217
    v_min_f32_e64 v122, -v216, -v217
    v_min_f32_e64 v123, -v216, -v217
    s_nop 0
    s_nop 0
    v_mfma_f32_16x16x32_bf16 v[188:191], a[104:107], v[64:67], v[120:123]
    s_waitcnt vmcnt(13) lgkmcnt(0)
    s_barrier
    ds_read_b64_tr_b16 a[224:225], v2 offset:0
    v_mfma_f32_16x16x32_bf16 v[188:191], a[108:111], v[68:71], v[188:191]
    ds_read_b64_tr_b16 a[226:227], v2 offset:4096
    ds_read_b64_tr_b16 a[228:229], v3 offset:0
    v_mfma_f32_16x16x32_bf16 v[188:191], a[112:115], v[72:75], v[188:191]
    ds_read_b64_tr_b16 a[230:231], v3 offset:4096
    ds_read_b64_tr_b16 a[232:233], v2 offset:256
    v_mfma_f32_16x16x32_bf16 v[188:191], a[116:119], v[76:79], v[188:191]
    ds_read_b64_tr_b16 a[234:235], v2 offset:4352
    ds_read_b64_tr_b16 a[236:237], v3 offset:256
    v_mfma_f32_16x16x32_bf16 v[192:195], a[120:123], v[64:67], v[120:123]
    ds_read_b64_tr_b16 a[238:239], v3 offset:4352
    ds_read_b64_tr_b16 a[240:241], v2 offset:512
    v_mfma_f32_16x16x32_bf16 v[192:195], a[124:127], v[68:71], v[192:195]
    ds_read_b64_tr_b16 a[242:243], v2 offset:4608
    ds_read_b64_tr_b16 a[244:245], v3 offset:512
    v_mfma_f32_16x16x32_bf16 v[192:195], a[128:131], v[72:75], v[192:195]
    ds_read_b64_tr_b16 a[246:247], v3 offset:4608
    ds_read_b64_tr_b16 a[248:249], v2 offset:768
    v_mfma_f32_16x16x32_bf16 v[192:195], a[132:135], v[76:79], v[192:195]
    ds_read_b64_tr_b16 a[250:251], v2 offset:4864
    ds_read_b64_tr_b16 a[252:253], v3 offset:768
    v_max3_f32 v218, v156, v157, v158
    v_max3_f32 v219, v159, v160, v161
    v_max3_f32 v218, v218, v162, v163
    v_max_f32 v218, v218, v219
    v_mov_b32 v219, v218
    s_nop 0
    s_nop 0
    v_permlane32_swap_b32 v218, v219
    v_max_f32 v218, v218, v219
    v_mov_b32 v219, v218
    s_nop 0
    s_nop 0
    v_permlane16_swap_b32 v218, v219
    v_min_f32_e64 v124, -v218, -v219
    v_min_f32_e64 v125, -v218, -v219
    v_min_f32_e64 v126, -v218, -v219
    v_min_f32_e64 v127, -v218, -v219
    s_nop 0
    s_nop 0
    v_mfma_f32_16x16x32_bf16 v[196:199], a[104:107], v[80:83], v[124:127]
    ds_read_b64_tr_b16 a[254:255], v3 offset:4864
    ds_read_b128 a[192:195], v0 offset:16384
    v_mfma_f32_16x16x32_bf16 v[196:199], a[108:111], v[84:87], v[196:199]
    buffer_load_dwordx4 v7, s[28:31], s63 offen offset:1024 lds
    v_mfma_f32_16x16x32_bf16 v[196:199], a[112:115], v[88:91], v[196:199]
    ds_read_b128 a[196:199], v0 offset:16640
    ds_read_b128 a[200:203], v0 offset:16896
    v_mfma_f32_16x16x32_bf16 v[196:199], a[116:119], v[92:95], v[196:199]
    ds_read_b128 a[204:207], v0 offset:17152
    ds_read_b128 a[208:211], v0 offset:20480
    v_mfma_f32_16x16x32_bf16 v[200:203], a[120:123], v[80:83], v[124:127]
    ds_read_b128 a[212:215], v0 offset:20736
    ds_read_b128 a[216:219], v0 offset:20992
    v_mfma_f32_16x16x32_bf16 v[200:203], a[124:127], v[84:87], v[200:203]
    ds_read_b128 a[220:223], v0 offset:21248
    v_add_f32 v148, v148, v120
    v_mfma_f32_16x16x32_bf16 v[200:203], a[128:131], v[88:91], v[200:203]
    v_add_f32 v149, v149, v120
    v_add_f32 v150, v150, v120
    v_mfma_f32_16x16x32_bf16 v[200:203], a[132:135], v[92:95], v[200:203]
    s_waitcnt lgkmcnt(3)
    v_add_f32 v151, v151, v120
    v_add_f32 v152, v152, v120
    v_exp_f32 v132, v132
    v_exp_f32 v133, v133
    v_exp_f32 v134, v134
    v_cvt_pk_bf16_f32 v132, v132, v133
    v_exp_f32 v135, v135
    v_exp_f32 v136, v136
    v_cvt_pk_bf16_f32 v133, v134, v135
    v_exp_f32 v137, v137
    v_exp_f32 v138, v138
    v_cvt_pk_bf16_f32 v134, v136, v137
    v_exp_f32 v139, v139
    s_nop 0
    v_cvt_pk_bf16_f32 v135, v138, v139
    s_nop 1
    v_mfma_f32_16x16x32_bf16 a[0:3], a[224:227], v[132:135], 0
    v_add_f32 v153, v153, v120
    v_add_f32 v154, v154, v120
    v_mfma_f32_16x16x32_bf16 a[4:7], a[228:231], v[132:135], 0
    v_add_f32 v155, v155, v120
    v_add_f32 v156, v156, v124
    v_mfma_f32_16x16x32_bf16 a[8:11], a[232:235], v[132:135], 0
    v_add_f32 v157, v157, v124
    v_add_f32 v158, v158, v124
    v_mfma_f32_16x16x32_bf16 a[12:15], a[236:239], v[132:135], 0
    buffer_load_dwordx4 v6, s[28:31], s63 offen offset:2048 lds
    v_mfma_f32_16x16x32_bf16 a[16:19], a[240:243], v[132:135], 0
    v_add_f32 v159, v159, v124
    v_add_f32 v160, v160, v124
    v_mfma_f32_16x16x32_bf16 a[20:23], a[244:247], v[132:135], 0
    v_add_f32 v161, v161, v124
    v_add_f32 v162, v162, v124
    v_mfma_f32_16x16x32_bf16 a[24:27], a[248:251], v[132:135], 0
    v_add_f32 v163, v163, v124
    v_max3_f32 v216, v164, v165, v166
    v_mfma_f32_16x16x32_bf16 a[28:31], a[252:255], v[132:135], 0
    v_exp_f32 v140, v140
    v_mfma_f32_16x16x32_bf16 a[160:163], a[180:183], v[132:135], 0
    v_exp_f32 v141, v141
    v_exp_f32 v142, v142
    v_cvt_pk_bf16_f32 v140, v140, v141
    v_exp_f32 v143, v143
    v_exp_f32 v144, v144
    v_cvt_pk_bf16_f32 v141, v142, v143
    v_exp_f32 v145, v145
    v_exp_f32 v146, v146
    v_cvt_pk_bf16_f32 v142, v144, v145
    v_exp_f32 v147, v147
    s_nop 0
    v_cvt_pk_bf16_f32 v143, v146, v147
    s_nop 1
    v_mfma_f32_16x16x32_bf16 a[32:35], a[224:227], v[140:143], 0
    v_exp_f32 v148, v148
    v_mfma_f32_16x16x32_bf16 a[36:39], a[228:231], v[140:143], 0
    v_exp_f32 v149, v149
    v_mfma_f32_16x16x32_bf16 a[40:43], a[232:235], v[140:143], 0
    v_exp_f32 v150, v150
    v_mfma_f32_16x16x32_bf16 a[44:47], a[236:239], v[140:143], 0
    v_cvt_pk_bf16_f32 v148, v148, v149
    v_max3_f32 v217, v167, v168, v169
    v_mfma_f32_16x16x32_bf16 a[48:51], a[240:243], v[140:143], 0
    buffer_load_dwordx4 v7, s[28:31], s63 offen offset:3072 lds
    v_mfma_f32_16x16x32_bf16 a[52:55], a[244:247], v[140:143], 0
    v_exp_f32 v151, v151
    v_mfma_f32_16x16x32_bf16 a[56:59], a[248:251], v[140:143], 0
    v_exp_f32 v152, v152
    v_mfma_f32_16x16x32_bf16 a[60:63], a[252:255], v[140:143], 0
    v_cvt_pk_bf16_f32 v149, v150, v151
    v_max3_f32 v216, v216, v170, v171
    v_mfma_f32_16x16x32_bf16 a[164:167], a[180:183], v[140:143], 0
    v_exp_f32 v153, v153
    v_exp_f32 v154, v154
    v_cvt_pk_bf16_f32 v150, v152, v153
    v_exp_f32 v155, v155
    s_nop 0
    v_cvt_pk_bf16_f32 v151, v154, v155
    s_nop 1
    v_mfma_f32_16x16x32_bf16 a[64:67], a[224:227], v[148:151], 0
    v_exp_f32 v156, v156
    v_mfma_f32_16x16x32_bf16 a[68:71], a[228:231], v[148:151], 0
    v_exp_f32 v157, v157
    v_mfma_f32_16x16x32_bf16 a[72:75], a[232:235], v[148:151], 0
    v_exp_f32 v158, v158
    v_mfma_f32_16x16x32_bf16 a[76:79], a[236:239], v[148:151], 0
    v_cvt_pk_bf16_f32 v156, v156, v157
    v_max_f32 v216, v216, v217
    v_mfma_f32_16x16x32_bf16 a[80:83], a[240:243], v[148:151], 0
    s_add_u32 m0, s81, 114688
    s_add_u32 s63, s81, 49152
    v_mov_b32 v217, v216
    v_mfma_f32_16x16x32_bf16 a[84:87], a[244:247], v[148:151], 0
    buffer_load_dwordx4 v6, s[32:35], s63 offen offset:0 lds
    v_mfma_f32_16x16x32_bf16 a[88:91], a[248:251], v[148:151], 0
    v_exp_f32 v159, v159
    v_mfma_f32_16x16x32_bf16 a[92:95], a[252:255], v[148:151], 0
    v_exp_f32 v160, v160
    v_mfma_f32_16x16x32_bf16 a[168:171], a[180:183], v[148:151], 0
    v_cvt_pk_bf16_f32 v157, v158, v159
    v_permlane32_swap_b32 v216, v217
    v_exp_f32 v161, v161
    v_exp_f32 v162, v162
    v_cvt_pk_bf16_f32 v158, v160, v161
    v_exp_f32 v163, v163
    s_nop 0
    v_cvt_pk_bf16_f32 v159, v162, v163
    s_nop 1
    v_mfma_f32_16x16x32_bf16 a[96:99], a[224:227], v[156:159], 0
    v_max_f32 v216, v216, v217
    v_mov_b32 v217, v216
    v_mfma_f32_16x16x32_bf16 a[100:103], a[228:231], v[156:159], 0
    v_xor_b32 v0, 0x8000, v0
    v_permlane16_swap_b32 v216, v217
    v_mfma_f32_16x16x32_bf16 a[104:107], a[232:235], v[156:159], 0
    v_min_f32_e64 v128, -v216, -v217
    v_min_f32_e64 v129, -v216, -v217
    v_mfma_f32_16x16x32_bf16 a[108:111], a[236:239], v[156:159], 0
    v_min_f32_e64 v130, -v216, -v217
    v_min_f32_e64 v131, -v216, -v217
    v_mfma_f32_16x16x32_bf16 a[112:115], a[240:243], v[156:159], 0
    v_add_f32 v164, v164, v128
    v_add_f32 v165, v165, v128
    v_mfma_f32_16x16x32_bf16 a[116:119], a[244:247], v[156:159], 0
    v_add_f32 v166, v166, v128
    v_add_f32 v167, v167, v128
    v_mfma_f32_16x16x32_bf16 a[120:123], a[248:251], v[156:159], 0
    buffer_load_dwordx4 v7, s[32:35], s63 offen offset:1024 lds
    v_mfma_f32_16x16x32_bf16 a[124:127], a[252:255], v[156:159], 0
    v_add_f32 v168, v168, v128
    v_add_f32 v169, v169, v128
    v_mfma_f32_16x16x32_bf16 a[172:175], a[180:183], v[156:159], 0
    v_add_f32 v170, v170, v128
    v_add_f32 v171, v171, v128
    v_exp_f32 v164, v164
    v_exp_f32 v165, v165
    v_exp_f32 v166, v166
    v_cvt_pk_bf16_f32 v164, v164, v165
    v_exp_f32 v167, v167
    v_exp_f32 v168, v168
    v_cvt_pk_bf16_f32 v165, v166, v167
    v_exp_f32 v169, v169
    v_exp_f32 v170, v170
    v_cvt_pk_bf16_f32 v166, v168, v169
    v_exp_f32 v171, v171
    s_nop 0
    v_cvt_pk_bf16_f32 v167, v170, v171
    s_nop 1
    v_mfma_f32_16x16x32_bf16 a[128:131], a[224:227], v[164:167], 0
    ds_read_b64_tr_b16 a[224:225], v4 offset:0
    ds_read_b64_tr_b16 a[226:227], v4 offset:4096
    v_mfma_f32_16x16x32_bf16 a[132:135], a[228:231], v[164:167], 0
    ds_read_b64_tr_b16 a[228:229], v5 offset:0
    ds_read_b64_tr_b16 a[230:231], v5 offset:4096
    v_mfma_f32_16x16x32_bf16 a[136:139], a[232:235], v[164:167], 0
    ds_read_b64_tr_b16 a[232:233], v4 offset:256
    ds_read_b64_tr_b16 a[234:235], v4 offset:4352
    v_mfma_f32_16x16x32_bf16 a[140:143], a[236:239], v[164:167], 0
    ds_read_b64_tr_b16 a[236:237], v5 offset:256
    ds_read_b64_tr_b16 a[238:239], v5 offset:4352
    v_mfma_f32_16x16x32_bf16 a[144:147], a[240:243], v[164:167], 0
    ds_read_b64_tr_b16 a[240:241], v4 offset:512
    ds_read_b64_tr_b16 a[242:243], v4 offset:4608
    v_mfma_f32_16x16x32_bf16 a[148:151], a[244:247], v[164:167], 0
    ds_read_b64_tr_b16 a[244:245], v5 offset:512
    ds_read_b64_tr_b16 a[246:247], v5 offset:4608
    v_mfma_f32_16x16x32_bf16 a[152:155], a[248:251], v[164:167], 0
    ds_read_b64_tr_b16 a[248:249], v4 offset:768
    ds_read_b64_tr_b16 a[250:251], v4 offset:4864
    v_mfma_f32_16x16x32_bf16 a[156:159], a[252:255], v[164:167], 0
    buffer_load_dwordx4 v6, s[32:35], s63 offen offset:2048 lds
    v_mfma_f32_16x16x32_bf16 a[176:179], a[180:183], v[164:167], 0
    ds_read_b64_tr_b16 a[252:253], v5 offset:768
    ds_read_b64_tr_b16 a[254:255], v5 offset:4864
    v_mfma_f32_16x16x32_bf16 v[132:135], a[192:195], v[32:35], v[112:115]
    v_exp_f32 v172, v172
    v_mfma_f32_16x16x32_bf16 v[140:143], a[192:195], v[48:51], v[116:119]
    v_exp_f32 v173, v173
    v_mfma_f32_16x16x32_bf16 v[148:151], a[192:195], v[64:67], v[120:123]
    v_add_f32 v10, v10, v172
    v_add_f32 v10, v10, v173
    v_mfma_f32_16x16x32_bf16 v[156:159], a[192:195], v[80:83], v[124:127]
    v_exp_f32 v174, v174
    v_mfma_f32_16x16x32_bf16 v[132:135], a[196:199], v[36:39], v[132:135]
    v_cvt_pk_bf16_f32 v172, v172, v173
    v_add_f32 v10, v10, v174
    v_mfma_f32_16x16x32_bf16 v[140:143], a[196:199], v[52:55], v[140:143]
    v_exp_f32 v175, v175
    v_mfma_f32_16x16x32_bf16 v[148:151], a[196:199], v[68:71], v[148:151]
    v_exp_f32 v176, v176
    v_mfma_f32_16x16x32_bf16 v[156:159], a[196:199], v[84:87], v[156:159]
    v_add_f32 v10, v10, v175
    v_cvt_pk_bf16_f32 v173, v174, v175
    v_mfma_f32_16x16x32_bf16 v[132:135], a[200:203], v[40:43], v[132:135]
    buffer_load_dwordx4 v7, s[32:35], s63 offen offset:3072 lds
    v_mfma_f32_16x16x32_bf16 v[140:143], a[200:203], v[56:59], v[140:143]
    v_exp_f32 v177, v177
    v_mfma_f32_16x16x32_bf16 v[148:151], a[200:203], v[72:75], v[148:151]
    v_add_f32 v10, v10, v176
    v_add_f32 v10, v10, v177
    v_mfma_f32_16x16x32_bf16 v[156:159], a[200:203], v[88:91], v[156:159]
    v_exp_f32 v178, v178
    v_mfma_f32_16x16x32_bf16 v[132:135], a[204:207], v[44:47], v[132:135]
    v_cvt_pk_bf16_f32 v174, v176, v177
    v_add_f32 v10, v10, v178
    v_mfma_f32_16x16x32_bf16 v[140:143], a[204:207], v[60:63], v[140:143]
    v_exp_f32 v179, v179
    v_mfma_f32_16x16x32_bf16 v[148:151], a[204:207], v[76:79], v[148:151]
    v_add_f32 v10, v10, v179
    v_cvt_pk_bf16_f32 v175, v178, v179
    v_mfma_f32_16x16x32_bf16 v[156:159], a[204:207], v[92:95], v[156:159]
    v_exp_f32 v180, v180
    v_mfma_f32_16x16x32_bf16 v[136:139], a[208:211], v[32:35], v[112:115]
    v_exp_f32 v181, v181
    v_mfma_f32_16x16x32_bf16 v[144:147], a[208:211], v[48:51], v[116:119]
    s_add_u32 m0, s81, 0
    s_add_u32 s63, s81, 65536
    s_lshr_b32 s83, s2, 3
    v_mfma_f32_16x16x32_bf16 v[152:155], a[208:211], v[64:67], v[120:123]
    buffer_load_dwordx4 v6, s[28:31], s63 offen offset:0 lds
    v_mfma_f32_16x16x32_bf16 v[160:163], a[208:211], v[80:83], v[124:127]
    s_waitcnt lgkmcnt(0)
    s_mul_i32 s52, s83, 43
    s_and_b32 s52, s52, 0xff80
    s_mul_i32 s94, s52, 0
    v_mfma_f32_16x16x32_bf16 v[136:139], a[212:215], v[36:39], v[136:139]
    s_mul_i32 s95, s83, 0
    s_add_u32 s94, s94, s95
    s_and_b32 s95, s52, 1920
    v_mfma_f32_16x16x32_bf16 v[144:147], a[212:215], v[52:55], v[144:147]
    s_mul_i32 s95, s95, 0
    s_add_u32 s94, s94, s95
    s_and_b32 s94, s94, 32767
    v_mfma_f32_16x16x32_bf16 v[152:155], a[212:215], v[68:71], v[152:155]
    s_mul_i32 s95, s94, 36
    s_add_u32 s20, s18, s52
    s_addc_u32 s21, s19, 0
    v_mfma_f32_16x16x32_bf16 v[160:163], a[212:215], v[84:87], v[160:163]
    s_sub_u32 s22, 4718592, s52
    s_cmp_lt_u32 s83, 27
    s_cselect_b32 s22, s22, 0
    v_mfma_f32_16x16x32_bf16 v[136:139], a[216:219], v[40:43], v[136:139]
    s_lshl_b32 s52, s3, 12
    s_add_u32 s52, s52, 131072
    s_lshl_b32 s53, s3, 9
    v_mfma_f32_16x16x32_bf16 v[144:147], a[216:219], v[56:59], v[144:147]
    s_and_b32 s54, s3, 2
    s_lshl_b32 s55, s54, 12
    s_lshl_b32 s57, s7, 14
    v_mfma_f32_16x16x32_bf16 v[152:155], a[216:219], v[72:75], v[152:155]
    s_add_u32 s55, s55, s57
    s_add_u32 s55, s55, 131072
    s_lshl_b32 s54, s54, 9
    v_mfma_f32_16x16x32_bf16 v[160:163], a[216:219], v[88:91], v[160:163]
    s_mul_i32 s58, s4, 72
    s_mul_i32 s59, s6, 9
    s_add_u32 s58, s58, s59
    v_mfma_f32_16x16x32_bf16 v[136:139], a[220:223], v[44:47], v[136:139]
    buffer_load_dwordx4 v7, s[28:31], s63 offen offset:1024 lds
    v_mfma_f32_16x16x32_bf16 v[144:147], a[220:223], v[60:63], v[144:147]
    s_lshl_b32 s58, s58, 17
    s_add_u32 s36, s16, s58
    s_addc_u32 s37, s17, 0
    v_mfma_f32_16x16x32_bf16 v[152:155], a[220:223], v[76:79], v[152:155]
    s_mov_b32 s38, 1179648
    s_mov_b32 s39, 0x00020000
    s_lshl_b32 s58, s5, 1
    v_mfma_f32_16x16x32_bf16 v[160:163], a[220:223], v[92:95], v[160:163]
    s_lshr_b32 s59, s3, 1
    s_add_u32 s58, s58, s59
    s_lshl_b32 s58, s58, 12
    v_mfma_f32_16x16x32_bf16 v[164:167], a[192:195], v[96:99], v[128:131]
    ds_read_b128 a[192:195], v1 offset:16384
    s_lshl_b32 s59, s7, 11
    v_mfma_f32_16x16x32_bf16 v[164:167], a[196:199], v[100:103], v[164:167]
    ds_read_b128 a[196:199], v1 offset:16640
    s_add_u32 s92, s58, s59
    v_mfma_f32_16x16x32_bf16 v[164:167], a[200:203], v[104:107], v[164:167]
    ds_read_b128 a[200:203], v1 offset:16896
    s_add_u32 s92, s92, 1048576
    v_mfma_f32_16x16x32_bf16 v[164:167], a[204:207], v[108:111], v[164:167]
    ds_read_b128 a[204:207], v1 offset:17152
    s_lshl_b32 s59, s7, 19
    v_mfma_f32_16x16x32_bf16 v[168:171], a[208:211], v[96:99], v[128:131]
    ds_read_b128 a[208:211], v1 offset:20480
    s_add_u32 s88, s58, s59
    v_mfma_f32_16x16x32_bf16 v[168:171], a[212:215], v[100:103], v[168:171]
    ds_read_b128 a[212:215], v1 offset:20736
    s_add_u32 s89, s88, 131072
    v_mfma_f32_16x16x32_bf16 v[168:171], a[216:219], v[104:107], v[168:171]
    buffer_load_dwordx4 v6, s[28:31], s63 offen offset:2048 lds
    v_mfma_f32_16x16x32_bf16 v[168:171], a[220:223], v[108:111], v[168:171]
    ds_read_b128 a[216:219], v1 offset:20992
    ds_read_b128 a[220:223], v1 offset:21248
    v_mfma_f32_16x16x32_bf16 a[0:3], a[224:227], v[172:175], a[0:3]
    s_add_u32 s90, s88, 262144
    s_add_u32 s91, s88, 393216
    s_add_u32 s45, s81, 65536
    v_add_f32 v11, v11, v180
    v_exp_f32 v182, v182
    v_add_f32 v11, v11, v181
    v_cvt_pk_bf16_f32 v180, v180, v181
    v_exp_f32 v183, v183
    v_add_f32 v11, v11, v182
    v_exp_f32 v184, v184
    v_add_f32 v11, v11, v183
    v_cvt_pk_bf16_f32 v181, v182, v183
    v_exp_f32 v185, v185
    v_exp_f32 v186, v186
    v_cvt_pk_bf16_f32 v182, v184, v185
    v_exp_f32 v187, v187
    s_nop 0
    v_cvt_pk_bf16_f32 v183, v186, v187
    s_nop 1
    v_mfma_f32_16x16x32_bf16 a[32:35], a[224:227], v[180:183], a[32:35]
    s_add_u32 s44, s81, 16384
    s_mov_b32 s48, 0
    s_add_u32 s47, s81, 65536
    v_exp_f32 v188, v188
    v_exp_f32 v189, v189
    v_exp_f32 v190, v190
    v_cvt_pk_bf16_f32 v188, v188, v189
    v_exp_f32 v191, v191
    v_exp_f32 v192, v192
    v_cvt_pk_bf16_f32 v189, v190, v191
    v_exp_f32 v193, v193
    v_exp_f32 v194, v194
    v_cvt_pk_bf16_f32 v190, v192, v193
    v_exp_f32 v195, v195
    s_nop 0
    v_cvt_pk_bf16_f32 v191, v194, v195
    s_nop 1
    v_mfma_f32_16x16x32_bf16 a[64:67], a[224:227], v[188:191], a[64:67]
    s_add_u32 s46, s81, 81920
    v_add_f32 v11, v11, v184
    v_add_f32 v11, v11, v185
    v_exp_f32 v196, v196
    v_exp_f32 v197, v197
    v_exp_f32 v198, v198
    v_cvt_pk_bf16_f32 v196, v196, v197
    v_exp_f32 v199, v199
    v_exp_f32 v200, v200
    v_cvt_pk_bf16_f32 v197, v198, v199
    v_exp_f32 v201, v201
    v_exp_f32 v202, v202
    v_cvt_pk_bf16_f32 v198, v200, v201
    v_exp_f32 v203, v203
    s_nop 0
    v_cvt_pk_bf16_f32 v199, v202, v203
    s_nop 1
    v_mfma_f32_16x16x32_bf16 a[96:99], a[224:227], v[196:199], a[96:99]
    v_add_f32 v11, v11, v186
    v_add_f32 v11, v11, v187
    v_mfma_f32_16x16x32_bf16 a[4:7], a[228:231], v[172:175], a[4:7]
    v_exp_f32 v132, v132
    v_mfma_f32_16x16x32_bf16 a[36:39], a[228:231], v[180:183], a[36:39]
    v_exp_f32 v133, v133
    v_mfma_f32_16x16x32_bf16 a[68:71], a[228:231], v[188:191], a[68:71]
    v_exp_f32 v134, v134
    v_mfma_f32_16x16x32_bf16 a[100:103], a[228:231], v[196:199], a[100:103]
    v_cvt_pk_bf16_f32 v132, v132, v133
    v_mbcnt_lo_u32_b32 v210, -1, 0
    v_mfma_f32_16x16x32_bf16 a[8:11], a[232:235], v[172:175], a[8:11]
    buffer_load_dwordx4 v7, s[28:31], s63 offen offset:3072 lds
    v_mfma_f32_16x16x32_bf16 a[40:43], a[232:235], v[180:183], a[40:43]
    v_exp_f32 v135, v135
    v_mfma_f32_16x16x32_bf16 a[72:75], a[232:235], v[188:191], a[72:75]
    v_exp_f32 v140, v140
    v_mfma_f32_16x16x32_bf16 a[104:107], a[232:235], v[196:199], a[104:107]
    v_cvt_pk_bf16_f32 v133, v134, v135
    v_mbcnt_hi_u32_b32 v210, -1, v210
    v_mfma_f32_16x16x32_bf16 a[12:15], a[236:239], v[172:175], a[12:15]
    v_exp_f32 v141, v141
    v_mfma_f32_16x16x32_bf16 a[44:47], a[236:239], v[180:183], a[44:47]
    v_exp_f32 v142, v142
    v_mfma_f32_16x16x32_bf16 a[76:79], a[236:239], v[188:191], a[76:79]
    v_cvt_pk_bf16_f32 v140, v140, v141
    v_lshlrev_b32 v204, 4, v210
    v_mfma_f32_16x16x32_bf16 a[108:111], a[236:239], v[196:199], a[108:111]
    v_exp_f32 v143, v143
    v_mfma_f32_16x16x32_bf16 a[16:19], a[240:243], v[172:175], a[16:19]
    v_exp_f32 v148, v148
    v_mfma_f32_16x16x32_bf16 a[48:51], a[240:243], v[180:183], a[48:51]
    v_cvt_pk_bf16_f32 v141, v142, v143
    v_lshlrev_b32 v205, 2, v210
    v_mfma_f32_16x16x32_bf16 a[80:83], a[240:243], v[188:191], a[80:83]
    v_exp_f32 v149, v149
    v_mfma_f32_16x16x32_bf16 a[112:115], a[240:243], v[196:199], a[112:115]
    v_exp_f32 v150, v150
    v_mfma_f32_16x16x32_bf16 a[20:23], a[244:247], v[172:175], a[20:23]
    v_cvt_pk_bf16_f32 v148, v148, v149
    v_add_u32 v206, s52, v204
    v_mfma_f32_16x16x32_bf16 a[52:55], a[244:247], v[180:183], a[52:55]
    v_exp_f32 v151, v151
    v_mfma_f32_16x16x32_bf16 a[84:87], a[244:247], v[188:191], a[84:87]
    v_exp_f32 v156, v156
    v_mfma_f32_16x16x32_bf16 a[116:119], a[244:247], v[196:199], a[116:119]
    v_cvt_pk_bf16_f32 v149, v150, v151
    v_add_u32 v207, s53, v205
    v_mfma_f32_16x16x32_bf16 a[24:27], a[248:251], v[172:175], a[24:27]
    v_exp_f32 v157, v157
    v_mfma_f32_16x16x32_bf16 a[56:59], a[248:251], v[180:183], a[56:59]
    v_exp_f32 v158, v158
    v_mfma_f32_16x16x32_bf16 a[88:91], a[248:251], v[188:191], a[88:91]
    v_cvt_pk_bf16_f32 v156, v156, v157
    v_add_u32 v208, s55, v204
    v_mfma_f32_16x16x32_bf16 a[120:123], a[248:251], v[196:199], a[120:123]
    v_exp_f32 v159, v159
    v_mfma_f32_16x16x32_bf16 a[28:31], a[252:255], v[172:175], a[28:31]
    v_exp_f32 v136, v136
    v_mfma_f32_16x16x32_bf16 a[60:63], a[252:255], v[180:183], a[60:63]
    v_cvt_pk_bf16_f32 v157, v158, v159
    v_add_u32 v209, s54, v205
    v_mfma_f32_16x16x32_bf16 a[92:95], a[252:255], v[188:191], a[92:95]
    v_exp_f32 v137, v137
    v_mfma_f32_16x16x32_bf16 a[124:127], a[252:255], v[196:199], a[124:127]
    v_exp_f32 v138, v138
    v_mfma_f32_16x16x32_bf16 a[168:171], a[180:183], v[188:191], a[168:171]
    v_cvt_pk_bf16_f32 v134, v136, v137
    v_mfma_f32_16x16x32_bf16 a[172:175], a[180:183], v[196:199], a[172:175]
    v_exp_f32 v139, v139
    v_exp_f32 v144, v144
    v_cvt_pk_bf16_f32 v135, v138, v139
    v_exp_f32 v145, v145
    s_nop 0
    v_cvt_pk_bf16_f32 v142, v144, v145
    s_waitcnt lgkmcnt(0)
    s_cmp_lg_u32 s49, 0
    s_cbranch_scc1 L_fallback
    .p2align 6
L_loop:
    s_waitcnt lgkmcnt(0)
    v_mfma_f32_16x16x32_bf16 v[172:175], a[192:195], v[32:35], v[112:115]
    v_exp_f32 v146, v146
    v_mfma_f32_16x16x32_bf16 v[180:183], a[192:195], v[48:51], v[116:119]
    v_mfma_f32_16x16x32_bf16 v[188:191], a[192:195], v[64:67], v[120:123]
    v_exp_f32 v147, v147
    v_mfma_f32_16x16x32_bf16 v[196:199], a[192:195], v[80:83], v[124:127]
    v_cvt_pk_bf16_f32 v143, v146, v147
    v_mfma_f32_16x16x32_bf16 v[172:175], a[196:199], v[36:39], v[172:175]
    v_exp_f32 v152, v152
    v_mfma_f32_16x16x32_bf16 v[180:183], a[196:199], v[52:55], v[180:183]
    v_mfma_f32_16x16x32_bf16 v[188:191], a[196:199], v[68:71], v[188:191]
    v_exp_f32 v153, v153
    v_mfma_f32_16x16x32_bf16 v[196:199], a[196:199], v[84:87], v[196:199]
    s_waitcnt vmcnt(16) lgkmcnt(0)
    s_barrier
    v_cvt_pk_bf16_f32 v150, v152, v153
    v_mfma_f32_16x16x32_bf16 v[172:175], a[200:203], v[40:43], v[172:175]
    v_exp_f32 v154, v154
    v_mfma_f32_16x16x32_bf16 v[180:183], a[200:203], v[56:59], v[180:183]
    ds_read_b64_tr_b16 a[224:225], v2 offset:16384
    ds_read_b64_tr_b16 a[226:227], v2 offset:20480
    v_mfma_f32_16x16x32_bf16 v[188:191], a[200:203], v[72:75], v[188:191]
    s_mov_b32 m0, s45
    v_exp_f32 v155, v155
    v_mfma_f32_16x16x32_bf16 v[196:199], a[200:203], v[88:91], v[196:199]
    buffer_load_dwordx4 v6, s[32:35], s47 offen offset:0 lds
    v_mfma_f32_16x16x32_bf16 v[172:175], a[204:207], v[44:47], v[172:175]
    v_exp_f32 v160, v160
    v_mfma_f32_16x16x32_bf16 v[180:183], a[204:207], v[60:63], v[180:183]
    ds_read_b64_tr_b16 a[228:229], v3 offset:16384
    ds_read_b64_tr_b16 a[230:231], v3 offset:20480
    v_mfma_f32_16x16x32_bf16 v[188:191], a[204:207], v[76:79], v[188:191]
    v_exp_f32 v161, v161
    v_mfma_f32_16x16x32_bf16 v[196:199], a[204:207], v[92:95], v[196:199]
    ds_read_b64_tr_b16 a[232:233], v2 offset:16640
    v_cvt_pk_bf16_f32 v151, v154, v155
    v_mfma_f32_16x16x32_bf16 v[176:179], a[208:211], v[32:35], v[112:115]
    v_cvt_pk_bf16_f32 v158, v160, v161
    v_mfma_f32_16x16x32_bf16 v[184:187], a[208:211], v[48:51], v[116:119]
    v_exp_f32 v162, v162
    v_mfma_f32_16x16x32_bf16 v[192:195], a[208:211], v[64:67], v[120:123]
    ds_read_b64_tr_b16 a[234:235], v2 offset:20736
    v_mfma_f32_16x16x32_bf16 v[200:203], a[208:211], v[80:83], v[124:127]
    v_exp_f32 v163, v163
    v_mfma_f32_16x16x32_bf16 v[176:179], a[212:215], v[36:39], v[176:179]
    ds_read_b64_tr_b16 a[236:237], v3 offset:16640
    v_cvt_pk_bf16_f32 v159, v162, v163
    v_mfma_f32_16x16x32_bf16 v[184:187], a[212:215], v[52:55], v[184:187]
    v_exp_f32 v164, v164
    v_mfma_f32_16x16x32_bf16 v[192:195], a[212:215], v[68:71], v[192:195]
    ds_read_b64_tr_b16 a[238:239], v3 offset:20736
    v_mfma_f32_16x16x32_bf16 v[200:203], a[212:215], v[84:87], v[200:203]
    v_exp_f32 v165, v165
    v_mfma_f32_16x16x32_bf16 v[176:179], a[216:219], v[40:43], v[176:179]
    ds_read_b64_tr_b16 a[240:241], v2 offset:16896
    ds_read_b64_tr_b16 a[242:243], v2 offset:20992
    v_mfma_f32_16x16x32_bf16 v[184:187], a[216:219], v[56:59], v[184:187]
    v_exp_f32 v166, v166
    v_mfma_f32_16x16x32_bf16 v[192:195], a[216:219], v[72:75], v[192:195]
    ds_read_b64_tr_b16 a[244:245], v3 offset:16896
    v_cvt_pk_bf16_f32 v164, v164, v165
    v_mfma_f32_16x16x32_bf16 v[200:203], a[216:219], v[88:91], v[200:203]
    v_exp_f32 v167, v167
    v_mfma_f32_16x16x32_bf16 v[176:179], a[220:223], v[44:47], v[176:179]
    buffer_load_dwordx4 v7, s[32:35], s47 offen offset:1024 lds
    v_mfma_f32_16x16x32_bf16 v[184:187], a[220:223], v[60:63], v[184:187]
    v_exp_f32 v168, v168
    v_mfma_f32_16x16x32_bf16 v[192:195], a[220:223], v[76:79], v[192:195]
    ds_read_b64_tr_b16 a[246:247], v3 offset:20992
    ds_read_b64_tr_b16 a[248:249], v2 offset:17152
    v_mfma_f32_16x16x32_bf16 v[200:203], a[220:223], v[92:95], v[200:203]
    s_waitcnt lgkmcnt(2)
    v_exp_f32 v169, v169
    v_mfma_f32_16x16x32_bf16 a[0:3], a[224:227], v[132:135], a[0:3]
    ds_read_b64_tr_b16 a[250:251], v2 offset:21248
    v_cvt_pk_bf16_f32 v165, v166, v167
    v_mfma_f32_16x16x32_bf16 a[32:35], a[224:227], v[140:143], a[32:35]
    v_exp_f32 v170, v170
    v_mfma_f32_16x16x32_bf16 a[64:67], a[224:227], v[148:151], a[64:67]
    ds_read_b64_tr_b16 a[252:253], v3 offset:17152
    v_cvt_pk_bf16_f32 v166, v168, v169
    v_mfma_f32_16x16x32_bf16 a[96:99], a[224:227], v[156:159], a[96:99]
    v_exp_f32 v171, v171
    v_mfma_f32_16x16x32_bf16 a[4:7], a[228:231], v[132:135], a[4:7]
    ds_read_b64_tr_b16 a[254:255], v3 offset:21248
    v_cvt_pk_bf16_f32 v167, v170, v171
    v_mfma_f32_16x16x32_bf16 a[36:39], a[228:231], v[140:143], a[36:39]
    v_xor_b32 v2, 0x8000, v2
    v_xor_b32 v3, 0x8000, v3
    v_mfma_f32_16x16x32_bf16 a[68:71], a[228:231], v[148:151], a[68:71]
    v_exp_f32 v172, v172
    v_mfma_f32_16x16x32_bf16 a[100:103], a[228:231], v[156:159], a[100:103]
    v_add_f32 v10, v10, v172
    v_mfma_f32_16x16x32_bf16 a[8:11], a[232:235], v[132:135], a[8:11]
    v_exp_f32 v173, v173
    v_mfma_f32_16x16x32_bf16 a[40:43], a[232:235], v[140:143], a[40:43]
    ds_read_b128 a[192:195], v0 offset:0
    v_add_f32 v10, v10, v173
    v_mfma_f32_16x16x32_bf16 a[72:75], a[232:235], v[148:151], a[72:75]
    v_exp_f32 v174, v174
    v_mfma_f32_16x16x32_bf16 a[104:107], a[232:235], v[156:159], a[104:107]
    v_cvt_pk_bf16_f32 v172, v172, v173
    v_add_f32 v10, v10, v174
    v_mfma_f32_16x16x32_bf16 a[12:15], a[236:239], v[132:135], a[12:15]
    v_exp_f32 v175, v175
    v_mfma_f32_16x16x32_bf16 a[44:47], a[236:239], v[140:143], a[44:47]
    buffer_load_dwordx4 v8, s[32:35], s47 offen offset:2048 lds
    v_mfma_f32_16x16x32_bf16 a[76:79], a[236:239], v[148:151], a[76:79]
    v_exp_f32 v180, v180
    v_mfma_f32_16x16x32_bf16 a[108:111], a[236:239], v[156:159], a[108:111]
    ds_read_b128 a[196:199], v0 offset:256
    v_add_f32 v10, v10, v175
    v_mfma_f32_16x16x32_bf16 a[16:19], a[240:243], v[132:135], a[16:19]
    v_exp_f32 v181, v181
    v_mfma_f32_16x16x32_bf16 a[48:51], a[240:243], v[140:143], a[48:51]
    ds_read_b128 a[200:203], v0 offset:512
    v_cvt_pk_bf16_f32 v173, v174, v175
    v_mfma_f32_16x16x32_bf16 a[80:83], a[240:243], v[148:151], a[80:83]
    v_exp_f32 v182, v182
    v_mfma_f32_16x16x32_bf16 a[112:115], a[240:243], v[156:159], a[112:115]
    s_waitcnt lgkmcnt(1)
    v_add_f32 v11, v11, v180
    v_add_f32 v11, v11, v181
    v_mfma_f32_16x16x32_bf16 a[20:23], a[244:247], v[132:135], a[20:23]
    v_exp_f32 v183, v183
    v_mfma_f32_16x16x32_bf16 a[52:55], a[244:247], v[140:143], a[52:55]
    ds_read_b128 a[204:207], v0 offset:768
    v_cvt_pk_bf16_f32 v180, v180, v181
    v_mfma_f32_16x16x32_bf16 a[84:87], a[244:247], v[148:151], a[84:87]
    v_exp_f32 v188, v188
    v_mfma_f32_16x16x32_bf16 a[116:119], a[244:247], v[156:159], a[116:119]
    v_add_f32 v11, v11, v182
    v_add_f32 v11, v11, v183
    v_mfma_f32_16x16x32_bf16 a[24:27], a[248:251], v[132:135], a[24:27]
    v_exp_f32 v189, v189
    v_mfma_f32_16x16x32_bf16 a[56:59], a[248:251], v[140:143], a[56:59]
    ds_read_b128 a[208:211], v0 offset:4096
    v_cvt_pk_bf16_f32 v181, v182, v183
    v_mfma_f32_16x16x32_bf16 a[88:91], a[248:251], v[148:151], a[88:91]
    v_exp_f32 v190, v190
    v_mfma_f32_16x16x32_bf16 a[120:123], a[248:251], v[156:159], a[120:123]
    v_cvt_pk_bf16_f32 v188, v188, v189
    v_xor_b32 v1, 0x8000, v1
    v_mfma_f32_16x16x32_bf16 a[28:31], a[252:255], v[132:135], a[28:31]
    v_mfma_f32_16x16x32_bf16 a[60:63], a[252:255], v[140:143], a[60:63]
    v_exp_f32 v191, v191
    v_mfma_f32_16x16x32_bf16 a[92:95], a[252:255], v[148:151], a[92:95]
    buffer_load_dwordx4 v9, s[32:35], s47 offen offset:3072 lds
    v_mfma_f32_16x16x32_bf16 a[124:127], a[252:255], v[156:159], a[124:127]
    s_add_u32 s47, s47, s51
    v_exp_f32 v196, v196
    v_mfma_f32_16x16x32_bf16 a[160:163], a[180:183], v[132:135], a[160:163]
    s_xor_b32 s45, s45, 16384
    ds_read_b128 a[212:215], v0 offset:4352
    v_cvt_pk_bf16_f32 v189, v190, v191
    v_mfma_f32_16x16x32_bf16 a[164:167], a[180:183], v[140:143], a[164:167]
    v_exp_f32 v197, v197
    v_mfma_f32_16x16x32_bf16 a[168:171], a[180:183], v[148:151], a[168:171]
    ds_read_b128 a[216:219], v0 offset:4608
    v_cvt_pk_bf16_f32 v196, v196, v197
    v_mfma_f32_16x16x32_bf16 a[172:175], a[180:183], v[156:159], a[172:175]
    v_exp_f32 v198, v198
    v_mfma_f32_16x16x32_bf16 a[128:131], a[224:227], v[164:167], a[128:131]
    v_mfma_f32_16x16x32_bf16 a[132:135], a[228:231], v[164:167], a[132:135]
    v_exp_f32 v199, v199
    v_mfma_f32_16x16x32_bf16 a[136:139], a[232:235], v[164:167], a[136:139]
    ds_read_b128 a[220:223], v0 offset:4864
    v_cvt_pk_bf16_f32 v197, v198, v199
    v_mfma_f32_16x16x32_bf16 a[140:143], a[236:239], v[164:167], a[140:143]
    v_exp_f32 v176, v176
    v_mfma_f32_16x16x32_bf16 a[144:147], a[240:243], v[164:167], a[144:147]
    v_add_f32 v10, v10, v176
    v_mfma_f32_16x16x32_bf16 a[148:151], a[244:247], v[164:167], a[148:151]
    v_exp_f32 v177, v177
    v_mfma_f32_16x16x32_bf16 a[152:155], a[248:251], v[164:167], a[152:155]
    v_add_f32 v10, v10, v177
    v_cvt_pk_bf16_f32 v174, v176, v177
    v_mfma_f32_16x16x32_bf16 a[156:159], a[252:255], v[164:167], a[156:159]
    v_exp_f32 v178, v178
    v_mfma_f32_16x16x32_bf16 a[176:179], a[180:183], v[164:167], a[176:179]
    v_add_f32 v10, v10, v178
    v_mfma_f32_16x16x32_bf16 v[132:135], a[192:195], v[32:35], v[112:115]
    v_exp_f32 v179, v179
    v_mfma_f32_16x16x32_bf16 v[140:143], a[192:195], v[48:51], v[116:119]
    ds_read_b64_tr_b16 a[224:225], v4 offset:16384
    v_add_f32 v10, v10, v179
    v_mfma_f32_16x16x32_bf16 v[148:151], a[192:195], v[64:67], v[120:123]
    s_mov_b32 m0, s44
    v_exp_f32 v184, v184
    v_mfma_f32_16x16x32_bf16 v[156:159], a[192:195], v[80:83], v[124:127]
    buffer_load_dwordx4 v6, s[28:31], s46 offen offset:0 lds
    v_mfma_f32_16x16x32_bf16 v[132:135], a[196:199], v[36:39], v[132:135]
    ds_read_b64_tr_b16 a[226:227], v4 offset:20480
    ds_read_b64_tr_b16 a[228:229], v5 offset:16384
    v_mfma_f32_16x16x32_bf16 v[140:143], a[196:199], v[52:55], v[140:143]
    v_exp_f32 v185, v185
    v_mfma_f32_16x16x32_bf16 v[148:151], a[196:199], v[68:71], v[148:151]
    ds_read_b64_tr_b16 a[230:231], v5 offset:20480
    v_cvt_pk_bf16_f32 v175, v178, v179
    v_mfma_f32_16x16x32_bf16 v[156:159], a[196:199], v[84:87], v[156:159]
    s_waitcnt lgkmcnt(3)
    v_exp_f32 v186, v186
    v_mfma_f32_16x16x32_bf16 v[132:135], a[200:203], v[40:43], v[132:135]
    ds_read_b64_tr_b16 a[232:233], v4 offset:16640
    v_add_f32 v11, v11, v184
    v_mfma_f32_16x16x32_bf16 v[140:143], a[200:203], v[56:59], v[140:143]
    v_exp_f32 v187, v187
    v_mfma_f32_16x16x32_bf16 v[148:151], a[200:203], v[72:75], v[148:151]
    ds_read_b64_tr_b16 a[234:235], v4 offset:20736
    v_add_f32 v11, v11, v185
    v_mfma_f32_16x16x32_bf16 v[156:159], a[200:203], v[88:91], v[156:159]
    v_exp_f32 v192, v192
    v_mfma_f32_16x16x32_bf16 v[132:135], a[204:207], v[44:47], v[132:135]
    ds_read_b64_tr_b16 a[236:237], v5 offset:16640
    v_cvt_pk_bf16_f32 v182, v184, v185
    v_mfma_f32_16x16x32_bf16 v[140:143], a[204:207], v[60:63], v[140:143]
    v_exp_f32 v193, v193
    v_mfma_f32_16x16x32_bf16 v[148:151], a[204:207], v[76:79], v[148:151]
    ds_read_b64_tr_b16 a[238:239], v5 offset:20736
    v_add_f32 v11, v11, v186
    v_mfma_f32_16x16x32_bf16 v[156:159], a[204:207], v[92:95], v[156:159]
    v_exp_f32 v194, v194
    v_mfma_f32_16x16x32_bf16 v[136:139], a[208:211], v[32:35], v[112:115]
    v_add_f32 v11, v11, v187
    v_cvt_pk_bf16_f32 v183, v186, v187
    v_mfma_f32_16x16x32_bf16 v[144:147], a[208:211], v[48:51], v[116:119]
    v_exp_f32 v195, v195
    v_mfma_f32_16x16x32_bf16 v[152:155], a[208:211], v[64:67], v[120:123]
    ds_read_b64_tr_b16 a[240:241], v4 offset:16896
    v_cvt_pk_bf16_f32 v190, v192, v193
    v_mfma_f32_16x16x32_bf16 v[160:163], a[208:211], v[80:83], v[124:127]
    v_exp_f32 v200, v200
    v_mfma_f32_16x16x32_bf16 v[136:139], a[212:215], v[36:39], v[136:139]
    ds_read_b64_tr_b16 a[242:243], v4 offset:20992
    v_cvt_pk_bf16_f32 v191, v194, v195
    v_mfma_f32_16x16x32_bf16 v[144:147], a[212:215], v[52:55], v[144:147]
    v_exp_f32 v201, v201
    v_mfma_f32_16x16x32_bf16 v[152:155], a[212:215], v[68:71], v[152:155]
    buffer_load_dwordx4 v7, s[28:31], s46 offen offset:1024 lds
    v_mfma_f32_16x16x32_bf16 v[160:163], a[212:215], v[84:87], v[160:163]
    v_exp_f32 v202, v202
    v_mfma_f32_16x16x32_bf16 v[136:139], a[216:219], v[40:43], v[136:139]
    ds_read_b64_tr_b16 a[244:245], v5 offset:16896
    ds_read_b64_tr_b16 a[246:247], v5 offset:20992
    v_mfma_f32_16x16x32_bf16 v[144:147], a[216:219], v[56:59], v[144:147]
    ds_read_b64_tr_b16 a[248:249], v4 offset:17152
    v_cvt_pk_bf16_f32 v198, v200, v201
    v_mfma_f32_16x16x32_bf16 v[152:155], a[216:219], v[72:75], v[152:155]
    v_exp_f32 v203, v203
    v_mfma_f32_16x16x32_bf16 v[160:163], a[216:219], v[88:91], v[160:163]
    ds_read_b64_tr_b16 a[250:251], v4 offset:21248
    v_cvt_pk_bf16_f32 v199, v202, v203
    v_mfma_f32_16x16x32_bf16 v[136:139], a[220:223], v[44:47], v[136:139]
    v_exp_f32 v132, v132
    v_mfma_f32_16x16x32_bf16 v[144:147], a[220:223], v[60:63], v[144:147]
    ds_read_b64_tr_b16 a[252:253], v5 offset:17152
    v_mfma_f32_16x16x32_bf16 v[152:155], a[220:223], v[76:79], v[152:155]
    v_exp_f32 v133, v133
    v_mfma_f32_16x16x32_bf16 v[160:163], a[220:223], v[92:95], v[160:163]
    ds_read_b64_tr_b16 a[254:255], v5 offset:21248
    v_cvt_pk_bf16_f32 v132, v132, v133
    v_mfma_f32_16x16x32_bf16 v[164:167], a[192:195], v[96:99], v[128:131]
    v_exp_f32 v134, v134
    v_mfma_f32_16x16x32_bf16 v[164:167], a[196:199], v[100:103], v[164:167]
    v_xor_b32 v4, 0x8000, v4
    v_xor_b32 v5, 0x8000, v5
    v_mfma_f32_16x16x32_bf16 v[164:167], a[200:203], v[104:107], v[164:167]
    v_exp_f32 v135, v135
    v_mfma_f32_16x16x32_bf16 v[164:167], a[204:207], v[108:111], v[164:167]
    v_cvt_pk_bf16_f32 v133, v134, v135
    v_mfma_f32_16x16x32_bf16 v[168:171], a[208:211], v[96:99], v[128:131]
    v_exp_f32 v140, v140
    v_mfma_f32_16x16x32_bf16 v[168:171], a[212:215], v[100:103], v[168:171]
    v_mfma_f32_16x16x32_bf16 v[168:171], a[216:219], v[104:107], v[168:171]
    v_exp_f32 v141, v141
    v_mfma_f32_16x16x32_bf16 v[168:171], a[220:223], v[108:111], v[168:171]
    s_waitcnt lgkmcnt(0)
    buffer_load_dwordx4 v8, s[28:31], s46 offen offset:2048 lds
    v_mfma_f32_16x16x32_bf16 a[0:3], a[224:227], v[172:175], a[0:3]
    v_exp_f32 v142, v142
    v_mfma_f32_16x16x32_bf16 a[32:35], a[224:227], v[180:183], a[32:35]
    ds_read_b128 a[192:195], v1 offset:0
    v_cvt_pk_bf16_f32 v140, v140, v141
    v_mfma_f32_16x16x32_bf16 a[64:67], a[224:227], v[188:191], a[64:67]
    v_exp_f32 v143, v143
    v_mfma_f32_16x16x32_bf16 a[96:99], a[224:227], v[196:199], a[96:99]
    v_cvt_pk_bf16_f32 v141, v142, v143
    v_mfma_f32_16x16x32_bf16 a[4:7], a[228:231], v[172:175], a[4:7]
    v_exp_f32 v148, v148
    v_mfma_f32_16x16x32_bf16 a[36:39], a[228:231], v[180:183], a[36:39]
    ds_read_b128 a[196:199], v1 offset:256
    v_mfma_f32_16x16x32_bf16 a[68:71], a[228:231], v[188:191], a[68:71]
    v_exp_f32 v149, v149
    v_mfma_f32_16x16x32_bf16 a[100:103], a[228:231], v[196:199], a[100:103]
    v_cvt_pk_bf16_f32 v148, v148, v149
    v_mfma_f32_16x16x32_bf16 a[8:11], a[232:235], v[172:175], a[8:11]
    v_mfma_f32_16x16x32_bf16 a[40:43], a[232:235], v[180:183], a[40:43]
    v_exp_f32 v150, v150
    v_mfma_f32_16x16x32_bf16 a[72:75], a[232:235], v[188:191], a[72:75]
    ds_read_b128 a[200:203], v1 offset:512
    v_mfma_f32_16x16x32_bf16 a[104:107], a[232:235], v[196:199], a[104:107]
    v_exp_f32 v151, v151
    v_mfma_f32_16x16x32_bf16 a[12:15], a[236:239], v[172:175], a[12:15]
    v_cvt_pk_bf16_f32 v149, v150, v151
    v_mfma_f32_16x16x32_bf16 a[44:47], a[236:239], v[180:183], a[44:47]
    v_exp_f32 v156, v156
    v_mfma_f32_16x16x32_bf16 a[76:79], a[236:239], v[188:191], a[76:79]
    ds_read_b128 a[204:207], v1 offset:768
    v_mfma_f32_16x16x32_bf16 a[108:111], a[236:239], v[196:199], a[108:111]
    v_exp_f32 v157, v157
    v_mfma_f32_16x16x32_bf16 a[16:19], a[240:243], v[172:175], a[16:19]
    buffer_load_dwordx4 v9, s[28:31], s46 offen offset:3072 lds
    v_mfma_f32_16x16x32_bf16 a[48:51], a[240:243], v[180:183], a[48:51]
    s_add_u32 s46, s46, s51
    v_exp_f32 v158, v158
    v_mfma_f32_16x16x32_bf16 a[80:83], a[240:243], v[188:191], a[80:83]
    s_xor_b32 s44, s44, 49152
    ds_read_b128 a[208:211], v1 offset:4096
    v_cvt_pk_bf16_f32 v156, v156, v157
    v_mfma_f32_16x16x32_bf16 a[112:115], a[240:243], v[196:199], a[112:115]
    v_exp_f32 v159, v159
    v_mfma_f32_16x16x32_bf16 a[20:23], a[244:247], v[172:175], a[20:23]
    v_cvt_pk_bf16_f32 v157, v158, v159
    v_mfma_f32_16x16x32_bf16 a[52:55], a[244:247], v[180:183], a[52:55]
    v_exp_f32 v136, v136
    v_mfma_f32_16x16x32_bf16 a[84:87], a[244:247], v[188:191], a[84:87]
    ds_read_b128 a[212:215], v1 offset:4352
    v_mfma_f32_16x16x32_bf16 a[116:119], a[244:247], v[196:199], a[116:119]
    v_exp_f32 v137, v137
    v_mfma_f32_16x16x32_bf16 a[24:27], a[248:251], v[172:175], a[24:27]
    v_cvt_pk_bf16_f32 v134, v136, v137
    v_mfma_f32_16x16x32_bf16 a[56:59], a[248:251], v[180:183], a[56:59]
    v_exp_f32 v138, v138
    v_mfma_f32_16x16x32_bf16 a[88:91], a[248:251], v[188:191], a[88:91]
    ds_read_b128 a[216:219], v1 offset:4608
    v_mfma_f32_16x16x32_bf16 a[120:123], a[248:251], v[196:199], a[120:123]
    v_exp_f32 v139, v139
    v_mfma_f32_16x16x32_bf16 a[28:31], a[252:255], v[172:175], a[28:31]
    v_cvt_pk_bf16_f32 v135, v138, v139
    v_mfma_f32_16x16x32_bf16 a[60:63], a[252:255], v[180:183], a[60:63]
    ds_read_b128 a[220:223], v1 offset:4864
    v_mfma_f32_16x16x32_bf16 a[92:95], a[252:255], v[188:191], a[92:95]
    v_exp_f32 v144, v144
    v_mfma_f32_16x16x32_bf16 a[124:127], a[252:255], v[196:199], a[124:127]
    v_mfma_f32_16x16x32_bf16 a[168:171], a[180:183], v[188:191], a[168:171]
    v_exp_f32 v145, v145
    v_mfma_f32_16x16x32_bf16 a[172:175], a[180:183], v[196:199], a[172:175]
    v_cvt_pk_bf16_f32 v142, v144, v145
L_loop_mid:
    s_waitcnt lgkmcnt(0)
    v_mfma_f32_16x16x32_bf16 v[172:175], a[192:195], v[32:35], v[112:115]
    v_exp_f32 v146, v146
    v_mfma_f32_16x16x32_bf16 v[180:183], a[192:195], v[48:51], v[116:119]
    v_mfma_f32_16x16x32_bf16 v[188:191], a[192:195], v[64:67], v[120:123]
    v_exp_f32 v147, v147
    v_mfma_f32_16x16x32_bf16 v[196:199], a[192:195], v[80:83], v[124:127]
    v_cvt_pk_bf16_f32 v143, v146, v147
    v_mfma_f32_16x16x32_bf16 v[172:175], a[196:199], v[36:39], v[172:175]
    v_exp_f32 v152, v152
    v_mfma_f32_16x16x32_bf16 v[180:183], a[196:199], v[52:55], v[180:183]
    v_mfma_f32_16x16x32_bf16 v[188:191], a[196:199], v[68:71], v[188:191]
    v_exp_f32 v153, v153
    v_mfma_f32_16x16x32_bf16 v[196:199], a[196:199], v[84:87], v[196:199]
    s_waitcnt vmcnt(16) lgkmcnt(0)
    s_barrier
    v_cvt_pk_bf16_f32 v150, v152, v153
    v_mfma_f32_16x16x32_bf16 v[172:175], a[200:203], v[40:43], v[172:175]
    v_exp_f32 v154, v154
    v_mfma_f32_16x16x32_bf16 v[180:183], a[200:203], v[56:59], v[180:183]
    ds_read_b64_tr_b16 a[224:225], v2 offset:0
    ds_read_b64_tr_b16 a[226:227], v2 offset:4096
    v_mfma_f32_16x16x32_bf16 v[188:191], a[200:203], v[72:75], v[188:191]
    s_mov_b32 m0, s45
    v_exp_f32 v155, v155
    v_mfma_f32_16x16x32_bf16 v[196:199], a[200:203], v[88:91], v[196:199]
    buffer_load_dwordx4 v6, s[32:35], s47 offen offset:0 lds
    v_mfma_f32_16x16x32_bf16 v[172:175], a[204:207], v[44:47], v[172:175]
    v_exp_f32 v160, v160
    v_mfma_f32_16x16x32_bf16 v[180:183], a[204:207], v[60:63], v[180:183]
    ds_read_b64_tr_b16 a[228:229], v3 offset:0
    ds_read_b64_tr_b16 a[230:231], v3 offset:4096
    v_mfma_f32_16x16x32_bf16 v[188:191], a[204:207], v[76:79], v[188:191]
    v_exp_f32 v161, v161
    v_mfma_f32_16x16x32_bf16 v[196:199], a[204:207], v[92:95], v[196:199]
    ds_read_b64_tr_b16 a[232:233], v2 offset:256
    v_cvt_pk_bf16_f32 v151, v154, v155
    v_mfma_f32_16x16x32_bf16 v[176:179], a[208:211], v[32:35], v[112:115]
    v_cvt_pk_bf16_f32 v158, v160, v161
    v_mfma_f32_16x16x32_bf16 v[184:187], a[208:211], v[48:51], v[116:119]
    v_exp_f32 v162, v162
    v_mfma_f32_16x16x32_bf16 v[192:195], a[208:211], v[64:67], v[120:123]
    ds_read_b64_tr_b16 a[234:235], v2 offset:4352
    v_mfma_f32_16x16x32_bf16 v[200:203], a[208:211], v[80:83], v[124:127]
    v_exp_f32 v163, v163
    v_mfma_f32_16x16x32_bf16 v[176:179], a[212:215], v[36:39], v[176:179]
    ds_read_b64_tr_b16 a[236:237], v3 offset:256
    v_cvt_pk_bf16_f32 v159, v162, v163
    v_mfma_f32_16x16x32_bf16 v[184:187], a[212:215], v[52:55], v[184:187]
    v_exp_f32 v164, v164
    v_mfma_f32_16x16x32_bf16 v[192:195], a[212:215], v[68:71], v[192:195]
    ds_read_b64_tr_b16 a[238:239], v3 offset:4352
    v_mfma_f32_16x16x32_bf16 v[200:203], a[212:215], v[84:87], v[200:203]
    v_exp_f32 v165, v165
    v_mfma_f32_16x16x32_bf16 v[176:179], a[216:219], v[40:43], v[176:179]
    ds_read_b64_tr_b16 a[240:241], v2 offset:512
    ds_read_b64_tr_b16 a[242:243], v2 offset:4608
    v_mfma_f32_16x16x32_bf16 v[184:187], a[216:219], v[56:59], v[184:187]
    v_exp_f32 v166, v166
    v_mfma_f32_16x16x32_bf16 v[192:195], a[216:219], v[72:75], v[192:195]
    ds_read_b64_tr_b16 a[244:245], v3 offset:512
    v_cvt_pk_bf16_f32 v164, v164, v165
    v_mfma_f32_16x16x32_bf16 v[200:203], a[216:219], v[88:91], v[200:203]
    v_exp_f32 v167, v167
    v_mfma_f32_16x16x32_bf16 v[176:179], a[220:223], v[44:47], v[176:179]
    buffer_load_dwordx4 v7, s[32:35], s47 offen offset:1024 lds
    v_mfma_f32_16x16x32_bf16 v[184:187], a[220:223], v[60:63], v[184:187]
    v_exp_f32 v168, v168
    v_mfma_f32_16x16x32_bf16 v[192:195], a[220:223], v[76:79], v[192:195]
    ds_read_b64_tr_b16 a[246:247], v3 offset:4608
    ds_read_b64_tr_b16 a[248:249], v2 offset:768
    v_mfma_f32_16x16x32_bf16 v[200:203], a[220:223], v[92:95], v[200:203]
    s_waitcnt lgkmcnt(2)
    v_exp_f32 v169, v169
    v_mfma_f32_16x16x32_bf16 a[0:3], a[224:227], v[132:135], a[0:3]
    ds_read_b64_tr_b16 a[250:251], v2 offset:4864
    v_cvt_pk_bf16_f32 v165, v166, v167
    v_mfma_f32_16x16x32_bf16 a[32:35], a[224:227], v[140:143], a[32:35]
    v_exp_f32 v170, v170
    v_mfma_f32_16x16x32_bf16 a[64:67], a[224:227], v[148:151], a[64:67]
    ds_read_b64_tr_b16 a[252:253], v3 offset:768
    v_cvt_pk_bf16_f32 v166, v168, v169
    v_mfma_f32_16x16x32_bf16 a[96:99], a[224:227], v[156:159], a[96:99]
    v_exp_f32 v171, v171
    v_mfma_f32_16x16x32_bf16 a[4:7], a[228:231], v[132:135], a[4:7]
    ds_read_b64_tr_b16 a[254:255], v3 offset:4864
    v_cvt_pk_bf16_f32 v167, v170, v171
    v_mfma_f32_16x16x32_bf16 a[36:39], a[228:231], v[140:143], a[36:39]
    v_mfma_f32_16x16x32_bf16 a[68:71], a[228:231], v[148:151], a[68:71]
    v_exp_f32 v172, v172
    v_mfma_f32_16x16x32_bf16 a[100:103], a[228:231], v[156:159], a[100:103]
    v_add_f32 v10, v10, v172
    v_mfma_f32_16x16x32_bf16 a[8:11], a[232:235], v[132:135], a[8:11]
    v_exp_f32 v173, v173
    v_mfma_f32_16x16x32_bf16 a[40:43], a[232:235], v[140:143], a[40:43]
    ds_read_b128 a[192:195], v0 offset:16384
    v_add_f32 v10, v10, v173
    v_mfma_f32_16x16x32_bf16 a[72:75], a[232:235], v[148:151], a[72:75]
    v_exp_f32 v174, v174
    v_mfma_f32_16x16x32_bf16 a[104:107], a[232:235], v[156:159], a[104:107]
    v_cvt_pk_bf16_f32 v172, v172, v173
    v_add_f32 v10, v10, v174
    v_mfma_f32_16x16x32_bf16 a[12:15], a[236:239], v[132:135], a[12:15]
    v_exp_f32 v175, v175
    v_mfma_f32_16x16x32_bf16 a[44:47], a[236:239], v[140:143], a[44:47]
    buffer_load_dwordx4 v8, s[32:35], s47 offen offset:2048 lds
    v_mfma_f32_16x16x32_bf16 a[76:79], a[236:239], v[148:151], a[76:79]
    v_exp_f32 v180, v180
    v_mfma_f32_16x16x32_bf16 a[108:111], a[236:239], v[156:159], a[108:111]
    ds_read_b128 a[196:199], v0 offset:16640
    v_add_f32 v10, v10, v175
    v_mfma_f32_16x16x32_bf16 a[16:19], a[240:243], v[132:135], a[16:19]
    v_exp_f32 v181, v181
    v_mfma_f32_16x16x32_bf16 a[48:51], a[240:243], v[140:143], a[48:51]
    ds_read_b128 a[200:203], v0 offset:16896
    v_cvt_pk_bf16_f32 v173, v174, v175
    v_mfma_f32_16x16x32_bf16 a[80:83], a[240:243], v[148:151], a[80:83]
    v_exp_f32 v182, v182
    v_mfma_f32_16x16x32_bf16 a[112:115], a[240:243], v[156:159], a[112:115]
    s_waitcnt lgkmcnt(1)
    v_add_f32 v11, v11, v180
    v_add_f32 v11, v11, v181
    v_mfma_f32_16x16x32_bf16 a[20:23], a[244:247], v[132:135], a[20:23]
    v_exp_f32 v183, v183
    v_mfma_f32_16x16x32_bf16 a[52:55], a[244:247], v[140:143], a[52:55]
    ds_read_b128 a[204:207], v0 offset:17152
    v_cvt_pk_bf16_f32 v180, v180, v181
    v_mfma_f32_16x16x32_bf16 a[84:87], a[244:247], v[148:151], a[84:87]
    v_exp_f32 v188, v188
    v_mfma_f32_16x16x32_bf16 a[116:119], a[244:247], v[156:159], a[116:119]
    v_add_f32 v11, v11, v182
    v_add_f32 v11, v11, v183
    v_mfma_f32_16x16x32_bf16 a[24:27], a[248:251], v[132:135], a[24:27]
    v_exp_f32 v189, v189
    v_mfma_f32_16x16x32_bf16 a[56:59], a[248:251], v[140:143], a[56:59]
    ds_read_b128 a[208:211], v0 offset:20480
    v_cvt_pk_bf16_f32 v181, v182, v183
    v_mfma_f32_16x16x32_bf16 a[88:91], a[248:251], v[148:151], a[88:91]
    v_exp_f32 v190, v190
    v_mfma_f32_16x16x32_bf16 a[120:123], a[248:251], v[156:159], a[120:123]
    v_cvt_pk_bf16_f32 v188, v188, v189
    v_mfma_f32_16x16x32_bf16 a[28:31], a[252:255], v[132:135], a[28:31]
    v_mfma_f32_16x16x32_bf16 a[60:63], a[252:255], v[140:143], a[60:63]
    v_exp_f32 v191, v191
    v_mfma_f32_16x16x32_bf16 a[92:95], a[252:255], v[148:151], a[92:95]
    buffer_load_dwordx4 v9, s[32:35], s47 offen offset:3072 lds
    v_mfma_f32_16x16x32_bf16 a[124:127], a[252:255], v[156:159], a[124:127]
    s_add_u32 s47, s47, s51
    v_exp_f32 v196, v196
    v_mfma_f32_16x16x32_bf16 a[160:163], a[180:183], v[132:135], a[160:163]
    s_xor_b32 s45, s45, 49152
    ds_read_b128 a[212:215], v0 offset:20736
    v_cvt_pk_bf16_f32 v189, v190, v191
    v_mfma_f32_16x16x32_bf16 a[164:167], a[180:183], v[140:143], a[164:167]
    v_exp_f32 v197, v197
    v_mfma_f32_16x16x32_bf16 a[168:171], a[180:183], v[148:151], a[168:171]
    ds_read_b128 a[216:219], v0 offset:20992
    v_cvt_pk_bf16_f32 v196, v196, v197
    v_mfma_f32_16x16x32_bf16 a[172:175], a[180:183], v[156:159], a[172:175]
    v_exp_f32 v198, v198
    v_mfma_f32_16x16x32_bf16 a[128:131], a[224:227], v[164:167], a[128:131]
    s_cmp_eq_u32 s48, 5
    s_cbranch_scc0 L_nosw
    s_mov_b64 s[28:29], s[20:21]
    s_mov_b32 s30, s22
    s_mov_b64 s[32:33], s[20:21]
    s_mov_b32 s34, s22
    s_add_u32 s46, s95, 73728
    s_add_u32 s47, s95, 110592
    s_mov_b32 s51, 73728
    v_mov_b32 v6, v28
    v_mov_b32 v7, v29
    v_mov_b32 v8, v30
    v_mov_b32 v9, v31
    buffer_load_dwordx2 a[184:185], v27, s[40:43], 0 offen offset:124
    v_add_u32 v27, 16384, v27
L_nosw:
    v_mfma_f32_16x16x32_bf16 a[132:135], a[228:231], v[164:167], a[132:135]
    v_exp_f32 v199, v199
    v_mfma_f32_16x16x32_bf16 a[136:139], a[232:235], v[164:167], a[136:139]
    ds_read_b128 a[220:223], v0 offset:21248
    v_cvt_pk_bf16_f32 v197, v198, v199
    v_mfma_f32_16x16x32_bf16 a[140:143], a[236:239], v[164:167], a[140:143]
    v_exp_f32 v176, v176
    v_mfma_f32_16x16x32_bf16 a[144:147], a[240:243], v[164:167], a[144:147]
    v_add_f32 v10, v10, v176
    v_xor_b32 v0, 0x8000, v0
    v_mfma_f32_16x16x32_bf16 a[148:151], a[244:247], v[164:167], a[148:151]
    v_exp_f32 v177, v177
    v_mfma_f32_16x16x32_bf16 a[152:155], a[248:251], v[164:167], a[152:155]
    v_add_f32 v10, v10, v177
    v_cvt_pk_bf16_f32 v174, v176, v177
    v_mfma_f32_16x16x32_bf16 a[156:159], a[252:255], v[164:167], a[156:159]
    v_exp_f32 v178, v178
    v_mfma_f32_16x16x32_bf16 a[176:179], a[180:183], v[164:167], a[176:179]
    v_add_f32 v10, v10, v178
    s_cmp_eq_u32 s48, 2
    s_cbranch_scc0 L_nolw
    s_add_u32 m0, s81, 131072
    s_mov_b32 s63, 0
    buffer_load_dwordx4 v28, s[20:23], s63 offen offset:0 lds
    buffer_load_dwordx4 v29, s[20:23], s63 offen offset:1024 lds
    buffer_load_dwordx4 v30, s[20:23], s63 offen offset:2048 lds
    buffer_load_dwordx4 v31, s[20:23], s63 offen offset:3072 lds
    s_add_u32 m0, s81, 147456
    s_mov_b32 s63, 36864
    buffer_load_dwordx4 v28, s[20:23], s63 offen offset:0 lds
    buffer_load_dwordx4 v29, s[20:23], s63 offen offset:1024 lds
    buffer_load_dwordx4 v30, s[20:23], s63 offen offset:2048 lds
    buffer_load_dwordx4 v31, s[20:23], s63 offen offset:3072 lds
L_nolw:
    v_mfma_f32_16x16x32_bf16 v[132:135], a[192:195], v[32:35], v[112:115]
    v_exp_f32 v179, v179
    v_mfma_f32_16x16x32_bf16 v[140:143], a[192:195], v[48:51], v[116:119]
    ds_read_b64_tr_b16 a[224:225], v4 offset:0
    v_add_f32 v10, v10, v179
    v_mfma_f32_16x16x32_bf16 v[148:151], a[192:195], v[64:67], v[120:123]
    s_mov_b32 m0, s44
    v_exp_f32 v184, v184
    v_mfma_f32_16x16x32_bf16 v[156:159], a[192:195], v[80:83], v[124:127]
    buffer_load_dwordx4 v6, s[28:31], s46 offen offset:0 lds
    v_mfma_f32_16x16x32_bf16 v[132:135], a[196:199], v[36:39], v[132:135]
    ds_read_b64_tr_b16 a[226:227], v4 offset:4096
    ds_read_b64_tr_b16 a[228:229], v5 offset:0
    v_mfma_f32_16x16x32_bf16 v[140:143], a[196:199], v[52:55], v[140:143]
    v_exp_f32 v185, v185
    v_mfma_f32_16x16x32_bf16 v[148:151], a[196:199], v[68:71], v[148:151]
    ds_read_b64_tr_b16 a[230:231], v5 offset:4096
    v_cvt_pk_bf16_f32 v175, v178, v179
    v_mfma_f32_16x16x32_bf16 v[156:159], a[196:199], v[84:87], v[156:159]
    s_waitcnt lgkmcnt(3)
    v_exp_f32 v186, v186
    v_mfma_f32_16x16x32_bf16 v[132:135], a[200:203], v[40:43], v[132:135]
    ds_read_b64_tr_b16 a[232:233], v4 offset:256
    v_add_f32 v11, v11, v184
    v_mfma_f32_16x16x32_bf16 v[140:143], a[200:203], v[56:59], v[140:143]
    v_exp_f32 v187, v187
    v_mfma_f32_16x16x32_bf16 v[148:151], a[200:203], v[72:75], v[148:151]
    ds_read_b64_tr_b16 a[234:235], v4 offset:4352
    v_add_f32 v11, v11, v185
    v_mfma_f32_16x16x32_bf16 v[156:159], a[200:203], v[88:91], v[156:159]
    v_exp_f32 v192, v192
    v_mfma_f32_16x16x32_bf16 v[132:135], a[204:207], v[44:47], v[132:135]
    ds_read_b64_tr_b16 a[236:237], v5 offset:256
    v_cvt_pk_bf16_f32 v182, v184, v185
    v_mfma_f32_16x16x32_bf16 v[140:143], a[204:207], v[60:63], v[140:143]
    v_exp_f32 v193, v193
    v_mfma_f32_16x16x32_bf16 v[148:151], a[204:207], v[76:79], v[148:151]
    ds_read_b64_tr_b16 a[238:239], v5 offset:4352
    v_add_f32 v11, v11, v186
    v_mfma_f32_16x16x32_bf16 v[156:159], a[204:207], v[92:95], v[156:159]
    v_exp_f32 v194, v194
    v_mfma_f32_16x16x32_bf16 v[136:139], a[208:211], v[32:35], v[112:115]
    v_add_f32 v11, v11, v187
    v_cvt_pk_bf16_f32 v183, v186, v187
    v_mfma_f32_16x16x32_bf16 v[144:147], a[208:211], v[48:51], v[116:119]
    v_exp_f32 v195, v195
    v_mfma_f32_16x16x32_bf16 v[152:155], a[208:211], v[64:67], v[120:123]
    ds_read_b64_tr_b16 a[240:241], v4 offset:512
    v_cvt_pk_bf16_f32 v190, v192, v193
    v_mfma_f32_16x16x32_bf16 v[160:163], a[208:211], v[80:83], v[124:127]
    v_exp_f32 v200, v200
    v_mfma_f32_16x16x32_bf16 v[136:139], a[212:215], v[36:39], v[136:139]
    ds_read_b64_tr_b16 a[242:243], v4 offset:4608
    v_cvt_pk_bf16_f32 v191, v194, v195
    v_mfma_f32_16x16x32_bf16 v[144:147], a[212:215], v[52:55], v[144:147]
    v_exp_f32 v201, v201
    v_mfma_f32_16x16x32_bf16 v[152:155], a[212:215], v[68:71], v[152:155]
    buffer_load_dwordx4 v7, s[28:31], s46 offen offset:1024 lds
    v_mfma_f32_16x16x32_bf16 v[160:163], a[212:215], v[84:87], v[160:163]
    v_exp_f32 v202, v202
    v_mfma_f32_16x16x32_bf16 v[136:139], a[216:219], v[40:43], v[136:139]
    ds_read_b64_tr_b16 a[244:245], v5 offset:512
    ds_read_b64_tr_b16 a[246:247], v5 offset:4608
    v_mfma_f32_16x16x32_bf16 v[144:147], a[216:219], v[56:59], v[144:147]
    ds_read_b64_tr_b16 a[248:249], v4 offset:768
    v_cvt_pk_bf16_f32 v198, v200, v201
    v_mfma_f32_16x16x32_bf16 v[152:155], a[216:219], v[72:75], v[152:155]
    v_exp_f32 v203, v203
    v_mfma_f32_16x16x32_bf16 v[160:163], a[216:219], v[88:91], v[160:163]
    ds_read_b64_tr_b16 a[250:251], v4 offset:4864
    v_cvt_pk_bf16_f32 v199, v202, v203
    v_mfma_f32_16x16x32_bf16 v[136:139], a[220:223], v[44:47], v[136:139]
    v_exp_f32 v132, v132
    v_mfma_f32_16x16x32_bf16 v[144:147], a[220:223], v[60:63], v[144:147]
    ds_read_b64_tr_b16 a[252:253], v5 offset:768
    v_mfma_f32_16x16x32_bf16 v[152:155], a[220:223], v[76:79], v[152:155]
    v_exp_f32 v133, v133
    v_mfma_f32_16x16x32_bf16 v[160:163], a[220:223], v[92:95], v[160:163]
    ds_read_b64_tr_b16 a[254:255], v5 offset:4864
    v_cvt_pk_bf16_f32 v132, v132, v133
    v_mfma_f32_16x16x32_bf16 v[164:167], a[192:195], v[96:99], v[128:131]
    v_exp_f32 v134, v134
    v_mfma_f32_16x16x32_bf16 v[164:167], a[196:199], v[100:103], v[164:167]
    v_mfma_f32_16x16x32_bf16 v[164:167], a[200:203], v[104:107], v[164:167]
    v_exp_f32 v135, v135
    v_mfma_f32_16x16x32_bf16 v[164:167], a[204:207], v[108:111], v[164:167]
    v_cvt_pk_bf16_f32 v133, v134, v135
    v_mfma_f32_16x16x32_bf16 v[168:171], a[208:211], v[96:99], v[128:131]
    v_exp_f32 v140, v140
    v_mfma_f32_16x16x32_bf16 v[168:171], a[212:215], v[100:103], v[168:171]
    v_mfma_f32_16x16x32_bf16 v[168:171], a[216:219], v[104:107], v[168:171]
    v_exp_f32 v141, v141
    v_mfma_f32_16x16x32_bf16 v[168:171], a[220:223], v[108:111], v[168:171]
    s_waitcnt lgkmcnt(0)
    buffer_load_dwordx4 v8, s[28:31], s46 offen offset:2048 lds
    v_mfma_f32_16x16x32_bf16 a[0:3], a[224:227], v[172:175], a[0:3]
    v_exp_f32 v142, v142
    v_mfma_f32_16x16x32_bf16 a[32:35], a[224:227], v[180:183], a[32:35]
    ds_read_b128 a[192:195], v1 offset:16384
    v_cvt_pk_bf16_f32 v140, v140, v141
    v_mfma_f32_16x16x32_bf16 a[64:67], a[224:227], v[188:191], a[64:67]
    v_exp_f32 v143, v143
    v_mfma_f32_16x16x32_bf16 a[96:99], a[224:227], v[196:199], a[96:99]
    v_cvt_pk_bf16_f32 v141, v142, v143
    v_mfma_f32_16x16x32_bf16 a[4:7], a[228:231], v[172:175], a[4:7]
    v_exp_f32 v148, v148
    v_mfma_f32_16x16x32_bf16 a[36:39], a[228:231], v[180:183], a[36:39]
    ds_read_b128 a[196:199], v1 offset:16640
    v_mfma_f32_16x16x32_bf16 a[68:71], a[228:231], v[188:191], a[68:71]
    v_exp_f32 v149, v149
    v_mfma_f32_16x16x32_bf16 a[100:103], a[228:231], v[196:199], a[100:103]
    v_cvt_pk_bf16_f32 v148, v148, v149
    v_mfma_f32_16x16x32_bf16 a[8:11], a[232:235], v[172:175], a[8:11]
    v_mfma_f32_16x16x32_bf16 a[40:43], a[232:235], v[180:183], a[40:43]
    v_exp_f32 v150, v150
    v_mfma_f32_16x16x32_bf16 a[72:75], a[232:235], v[188:191], a[72:75]
    ds_read_b128 a[200:203], v1 offset:16896
    v_mfma_f32_16x16x32_bf16 a[104:107], a[232:235], v[196:199], a[104:107]
    v_exp_f32 v151, v151
    v_mfma_f32_16x16x32_bf16 a[12:15], a[236:239], v[172:175], a[12:15]
    v_cvt_pk_bf16_f32 v149, v150, v151
    v_mfma_f32_16x16x32_bf16 a[44:47], a[236:239], v[180:183], a[44:47]
    v_exp_f32 v156, v156
    v_mfma_f32_16x16x32_bf16 a[76:79], a[236:239], v[188:191], a[76:79]
    ds_read_b128 a[204:207], v1 offset:17152
    v_mfma_f32_16x16x32_bf16 a[108:111], a[236:239], v[196:199], a[108:111]
    v_exp_f32 v157, v157
    v_mfma_f32_16x16x32_bf16 a[16:19], a[240:243], v[172:175], a[16:19]
    buffer_load_dwordx4 v9, s[28:31], s46 offen offset:3072 lds
    v_mfma_f32_16x16x32_bf16 a[48:51], a[240:243], v[180:183], a[48:51]
    s_add_u32 s46, s46, s51
    v_exp_f32 v158, v158
    v_mfma_f32_16x16x32_bf16 a[80:83], a[240:243], v[188:191], a[80:83]
    s_xor_b32 s44, s44, 16384
    ds_read_b128 a[208:211], v1 offset:20480
    v_cvt_pk_bf16_f32 v156, v156, v157
    v_mfma_f32_16x16x32_bf16 a[112:115], a[240:243], v[196:199], a[112:115]
    v_exp_f32 v159, v159
    v_mfma_f32_16x16x32_bf16 a[20:23], a[244:247], v[172:175], a[20:23]
    v_cvt_pk_bf16_f32 v157, v158, v159
    v_mfma_f32_16x16x32_bf16 a[52:55], a[244:247], v[180:183], a[52:55]
    v_exp_f32 v136, v136
    v_mfma_f32_16x16x32_bf16 a[84:87], a[244:247], v[188:191], a[84:87]
    ds_read_b128 a[212:215], v1 offset:20736
    v_mfma_f32_16x16x32_bf16 a[116:119], a[244:247], v[196:199], a[116:119]
    v_exp_f32 v137, v137
    v_mfma_f32_16x16x32_bf16 a[24:27], a[248:251], v[172:175], a[24:27]
    v_cvt_pk_bf16_f32 v134, v136, v137
    v_mfma_f32_16x16x32_bf16 a[56:59], a[248:251], v[180:183], a[56:59]
    v_exp_f32 v138, v138
    v_mfma_f32_16x16x32_bf16 a[88:91], a[248:251], v[188:191], a[88:91]
    ds_read_b128 a[216:219], v1 offset:20992
    v_mfma_f32_16x16x32_bf16 a[120:123], a[248:251], v[196:199], a[120:123]
    v_exp_f32 v139, v139
    v_mfma_f32_16x16x32_bf16 a[28:31], a[252:255], v[172:175], a[28:31]
    v_cvt_pk_bf16_f32 v135, v138, v139
    v_mfma_f32_16x16x32_bf16 a[60:63], a[252:255], v[180:183], a[60:63]
    ds_read_b128 a[220:223], v1 offset:21248
    v_mfma_f32_16x16x32_bf16 a[92:95], a[252:255], v[188:191], a[92:95]
    v_exp_f32 v144, v144
    v_mfma_f32_16x16x32_bf16 a[124:127], a[252:255], v[196:199], a[124:127]
    v_mfma_f32_16x16x32_bf16 a[168:171], a[180:183], v[188:191], a[168:171]
    v_exp_f32 v145, v145
    v_mfma_f32_16x16x32_bf16 a[172:175], a[180:183], v[196:199], a[172:175]
    v_cvt_pk_bf16_f32 v142, v144, v145
    s_add_u32 s48, s48, 1
    s_cmp_lt_u32 s48, 7
    s_cbranch_scc1 L_loop
    s_waitcnt lgkmcnt(0)
    v_mfma_f32_16x16x32_bf16 v[172:175], a[192:195], v[32:35], v[112:115]
    v_exp_f32 v146, v146
    v_mfma_f32_16x16x32_bf16 v[176:179], a[208:211], v[32:35], v[112:115]
    v_exp_f32 v147, v147
    v_mfma_f32_16x16x32_bf16 v[172:175], a[196:199], v[36:39], v[172:175]
    v_cvt_pk_bf16_f32 v143, v146, v147
    v_mov_b32 v217, 0x4e800000
    v_mfma_f32_16x16x32_bf16 v[176:179], a[212:215], v[36:39], v[176:179]
    v_exp_f32 v152, v152
    v_mfma_f32_16x16x32_bf16 v[172:175], a[200:203], v[40:43], v[172:175]
    v_exp_f32 v153, v153
    v_mfma_f32_16x16x32_bf16 v[176:179], a[216:219], v[40:43], v[176:179]
    v_exp_f32 v154, v154
    v_mfma_f32_16x16x32_bf16 v[172:175], a[204:207], v[44:47], v[172:175]
    v_cvt_pk_bf16_f32 v150, v152, v153
    v_mfma_f32_16x16x32_bf16 v[176:179], a[220:223], v[44:47], v[176:179]
    v_exp_f32 v155, v155
    v_mfma_f32_16x16x32_bf16 v[180:183], a[192:195], v[48:51], v[116:119]
    s_waitcnt vmcnt(21) lgkmcnt(0)
    s_barrier
    ds_read_b64_tr_b16 a[224:225], v2 offset:16384
    v_mfma_f32_16x16x32_bf16 v[184:187], a[208:211], v[48:51], v[116:119]
    v_exp_f32 v172, v172
    v_mfma_f32_16x16x32_bf16 v[180:183], a[196:199], v[52:55], v[180:183]
    v_exp_f32 v173, v173
    v_mfma_f32_16x16x32_bf16 v[184:187], a[212:215], v[52:55], v[184:187]
    v_add_f32 v10, v10, v172
    v_add_f32 v10, v10, v173
    v_mfma_f32_16x16x32_bf16 v[180:183], a[200:203], v[56:59], v[180:183]
    v_exp_f32 v174, v174
    v_mfma_f32_16x16x32_bf16 v[184:187], a[216:219], v[56:59], v[184:187]
    v_cvt_pk_bf16_f32 v172, v172, v173
    v_add_f32 v10, v10, v174
    v_mfma_f32_16x16x32_bf16 v[180:183], a[204:207], v[60:63], v[180:183]
    v_exp_f32 v175, v175
    v_mfma_f32_16x16x32_bf16 v[184:187], a[220:223], v[60:63], v[184:187]
    v_exp_f32 v176, v176
    v_mfma_f32_16x16x32_bf16 v[188:191], a[192:195], v[64:67], v[120:123]
    v_add_f32 v10, v10, v175
    v_cvt_pk_bf16_f32 v173, v174, v175
    v_mfma_f32_16x16x32_bf16 v[192:195], a[208:211], v[64:67], v[120:123]
    v_exp_f32 v177, v177
    v_mfma_f32_16x16x32_bf16 v[188:191], a[196:199], v[68:71], v[188:191]
    v_add_f32 v10, v10, v176
    v_add_f32 v10, v10, v177
    v_mfma_f32_16x16x32_bf16 v[192:195], a[212:215], v[68:71], v[192:195]
    v_exp_f32 v178, v178
    v_mfma_f32_16x16x32_bf16 v[188:191], a[200:203], v[72:75], v[188:191]
    v_cvt_pk_bf16_f32 v174, v176, v177
    v_add_f32 v10, v10, v178
    v_mfma_f32_16x16x32_bf16 v[192:195], a[216:219], v[72:75], v[192:195]
    v_exp_f32 v179, v179
    v_mfma_f32_16x16x32_bf16 v[188:191], a[204:207], v[76:79], v[188:191]
    v_add_f32 v10, v10, v179
    v_cvt_pk_bf16_f32 v175, v178, v179
    v_mfma_f32_16x16x32_bf16 v[192:195], a[220:223], v[76:79], v[192:195]
    ds_read_b64_tr_b16 a[226:227], v2 offset:20480
    ds_read_b64_tr_b16 a[228:229], v3 offset:16384
    v_mfma_f32_16x16x32_bf16 v[196:199], a[192:195], v[80:83], v[124:127]
    ds_read_b64_tr_b16 a[230:231], v3 offset:20480
    ds_read_b64_tr_b16 a[232:233], v2 offset:16640
    v_mfma_f32_16x16x32_bf16 v[200:203], a[208:211], v[80:83], v[124:127]
    ds_read_b64_tr_b16 a[234:235], v2 offset:20736
    ds_read_b64_tr_b16 a[236:237], v3 offset:16640
    v_mfma_f32_16x16x32_bf16 v[196:199], a[196:199], v[84:87], v[196:199]
    ds_read_b64_tr_b16 a[238:239], v3 offset:20736
    ds_read_b64_tr_b16 a[240:241], v2 offset:16896
    v_mfma_f32_16x16x32_bf16 v[200:203], a[212:215], v[84:87], v[200:203]
    ds_read_b64_tr_b16 a[242:243], v2 offset:20992
    ds_read_b64_tr_b16 a[244:245], v3 offset:16896
    v_mfma_f32_16x16x32_bf16 v[196:199], a[200:203], v[88:91], v[196:199]
    ds_read_b64_tr_b16 a[246:247], v3 offset:20992
    ds_read_b64_tr_b16 a[248:249], v2 offset:17152
    v_mfma_f32_16x16x32_bf16 v[200:203], a[216:219], v[88:91], v[200:203]
    ds_read_b64_tr_b16 a[250:251], v2 offset:21248
    ds_read_b64_tr_b16 a[252:253], v3 offset:17152
    v_mfma_f32_16x16x32_bf16 v[196:199], a[204:207], v[92:95], v[196:199]
    ds_read_b64_tr_b16 a[254:255], v3 offset:21248
    ds_read_b64_tr_b16 v[32:33], v4 offset:16384
    v_mfma_f32_16x16x32_bf16 v[200:203], a[220:223], v[92:95], v[200:203]
    ds_read_b64_tr_b16 v[34:35], v4 offset:20480
    ds_read_b64_tr_b16 v[36:37], v5 offset:16384
    v_mfma_f32_16x16x32_bf16 a[160:163], a[180:183], v[132:135], a[160:163]
    s_waitcnt lgkmcnt(6)
    ds_read_b64_tr_b16 v[38:39], v5 offset:20480
    ds_read_b64_tr_b16 v[40:41], v4 offset:16640
    v_mfma_f32_16x16x32_bf16 a[0:3], a[224:227], v[132:135], a[0:3]
    ds_read_b64_tr_b16 v[42:43], v4 offset:20736
    ds_read_b64_tr_b16 v[44:45], v5 offset:16640
    v_mfma_f32_16x16x32_bf16 a[4:7], a[228:231], v[132:135], a[4:7]
    ds_read_b64_tr_b16 v[46:47], v5 offset:20736
    ds_read_b64_tr_b16 v[48:49], v4 offset:16896
    v_mfma_f32_16x16x32_bf16 a[8:11], a[232:235], v[132:135], a[8:11]
    ds_read_b64_tr_b16 v[50:51], v4 offset:20992
    ds_read_b64_tr_b16 v[52:53], v5 offset:16896
    v_mfma_f32_16x16x32_bf16 a[12:15], a[236:239], v[132:135], a[12:15]
    ds_read_b64_tr_b16 v[54:55], v5 offset:20992
    ds_read_b64_tr_b16 v[56:57], v4 offset:17152
    v_mfma_f32_16x16x32_bf16 a[16:19], a[240:243], v[132:135], a[16:19]
    ds_read_b64_tr_b16 v[58:59], v4 offset:21248
    ds_read_b64_tr_b16 v[60:61], v5 offset:17152
    v_mfma_f32_16x16x32_bf16 a[20:23], a[244:247], v[132:135], a[20:23]
    s_waitcnt lgkmcnt(6)
    ds_read_b64_tr_b16 v[62:63], v5 offset:21248
    s_add_u32 s63, s94, 7168
    v_mfma_f32_16x16x32_bf16 a[24:27], a[248:251], v[132:135], a[24:27]
    s_and_b32 s63, s63, 32767
    s_add_u32 m0, s81, 98304
    s_mul_i32 s63, s63, 36
    v_mfma_f32_16x16x32_bf16 a[28:31], a[252:255], v[132:135], a[28:31]
    buffer_load_dwordx4 v6, s[20:23], s63 offen offset:0 lds
    v_mfma_f32_16x16x32_bf16 a[0:3], v[32:35], v[172:175], a[0:3]
    buffer_load_dwordx4 v7, s[20:23], s63 offen offset:1024 lds
    v_mfma_f32_16x16x32_bf16 a[4:7], v[36:39], v[172:175], a[4:7]
    buffer_load_dwordx4 v8, s[20:23], s63 offen offset:2048 lds
    v_mfma_f32_16x16x32_bf16 a[8:11], v[40:43], v[172:175], a[8:11]
    buffer_load_dwordx4 v9, s[20:23], s63 offen offset:3072 lds
    v_mfma_f32_16x16x32_bf16 a[12:15], v[44:47], v[172:175], a[12:15]
    s_waitcnt lgkmcnt(0)
    v_exp_f32 v180, v180
    v_exp_f32 v181, v181
    v_add_f32 v11, v11, v180
    v_exp_f32 v182, v182
    v_mfma_f32_16x16x32_bf16 a[16:19], v[48:51], v[172:175], a[16:19]
    v_add_f32 v11, v11, v181
    v_cvt_pk_bf16_f32 v180, v180, v181
    v_exp_f32 v183, v183
    v_add_f32 v11, v11, v182
    v_exp_f32 v184, v184
    v_mfma_f32_16x16x32_bf16 a[20:23], v[52:55], v[172:175], a[20:23]
    v_add_f32 v11, v11, v183
    v_cvt_pk_bf16_f32 v181, v182, v183
    v_exp_f32 v185, v185
    v_add_f32 v11, v11, v184
    v_exp_f32 v186, v186
    v_mfma_f32_16x16x32_bf16 a[24:27], v[56:59], v[172:175], a[24:27]
    v_add_f32 v11, v11, v185
    v_cvt_pk_bf16_f32 v182, v184, v185
    v_exp_f32 v187, v187
    v_add_f32 v11, v11, v186
    v_add_f32 v11, v11, v187
    v_cvt_pk_bf16_f32 v183, v186, v187
    v_mfma_f32_16x16x32_bf16 a[28:31], v[60:63], v[172:175], a[28:31]
    v_accvgpr_read_b32 v210, a160
    v_mov_b32 v215, v10
    v_accvgpr_read_b32 v220, a0
    v_accvgpr_read_b32 v221, a1
    v_permlane32_swap_b32 v10, v215
    v_add_f32 v10, v10, v215
    v_mov_b32 v215, v10
    v_mfma_f32_16x16x32_bf16 a[164:167], a[180:183], v[140:143], a[164:167]
    v_accvgpr_read_b32 v222, a2
    v_permlane16_swap_b32 v10, v215
    v_add_f32 v10, v10, v215
    v_add_f32 v210, v210, v10
    v_mov_b32 v216, v210
    v_rcp_f32 v210, v210
    v_mfma_f32_16x16x32_bf16 a[32:35], a[224:227], v[140:143], a[32:35]
    v_accvgpr_read_b32 v223, a3
    v_accvgpr_read_b32 v224, a4
    v_accvgpr_read_b32 v225, a5
    v_accvgpr_read_b32 v226, a6
    v_accvgpr_read_b32 v227, a7
    v_mul_f32 v220, v220, v210
    v_mul_f32 v221, v221, v210
    v_mfma_f32_16x16x32_bf16 a[36:39], a[228:231], v[140:143], a[36:39]
    v_mul_f32 v222, v222, v210
    v_mul_f32 v223, v223, v210
    v_mul_f32 v224, v224, v210
    v_mul_f32 v225, v225, v210
    v_mul_f32 v226, v226, v210
    v_mul_f32 v227, v227, v210
    v_cvt_pk_bf16_f32 v228, v220, v221
    v_mfma_f32_16x16x32_bf16 a[40:43], a[232:235], v[140:143], a[40:43]
    v_cvt_pk_bf16_f32 v229, v222, v223
    v_cvt_pk_bf16_f32 v230, v224, v225
    v_cvt_pk_bf16_f32 v231, v226, v227
    buffer_store_dwordx4 v[228:231], v204, s[36:39], s88 offen offset:0 sc1
    s_waitcnt vmcnt(21)
    ds_read_b64_tr_b16 v[80:81], v14 offset:0
    v_mfma_f32_16x16x32_bf16 a[44:47], a[236:239], v[140:143], a[44:47]
    ds_read_b64_tr_b16 v[82:83], v14 offset:2048
    ds_read_b64_tr_b16 v[84:85], v15 offset:0
    ds_read_b64_tr_b16 v[86:87], v15 offset:2048
    ds_read_b64_tr_b16 v[88:89], v16 offset:0
    ds_read_b64_tr_b16 v[90:91], v16 offset:2048
    ds_read_b64_tr_b16 v[92:93], v17 offset:0
    ds_read_b64_tr_b16 v[94:95], v17 offset:2048
    v_mfma_f32_16x16x32_bf16 a[48:51], a[240:243], v[140:143], a[48:51]
    ds_read_b64_tr_b16 v[96:97], v22 offset:0
    ds_read_b64_tr_b16 v[98:99], v22 offset:2048
    ds_read_b64_tr_b16 v[100:101], v23 offset:0
    ds_read_b64_tr_b16 v[102:103], v23 offset:2048
    ds_read_b64_tr_b16 v[104:105], v24 offset:0
    ds_read_b64_tr_b16 v[106:107], v24 offset:2048
    ds_read_b64_tr_b16 v[108:109], v25 offset:0
    v_mfma_f32_16x16x32_bf16 a[52:55], a[244:247], v[140:143], a[52:55]
    ds_read_b64_tr_b16 v[110:111], v25 offset:2048
    s_waitcnt vmcnt(17)
    ds_read_b64_tr_b16 a[192:193], v18 offset:0
    ds_read_b64_tr_b16 a[194:195], v18 offset:2048
    ds_read_b64_tr_b16 a[196:197], v19 offset:0
    ds_read_b64_tr_b16 a[198:199], v19 offset:2048
    ds_read_b64_tr_b16 a[200:201], v20 offset:0
    v_mfma_f32_16x16x32_bf16 a[56:59], a[248:251], v[140:143], a[56:59]
    ds_read_b64_tr_b16 a[202:203], v20 offset:2048
    ds_read_b64_tr_b16 a[204:205], v21 offset:0
    ds_read_b64_tr_b16 a[206:207], v21 offset:2048
    s_add_u32 s63, s94, 8192
    s_and_b32 s63, s63, 32767
    s_add_u32 m0, s81, 0
    s_mul_i32 s63, s63, 36
    v_mfma_f32_16x16x32_bf16 a[60:63], a[252:255], v[140:143], a[60:63]
    v_accvgpr_read_b32 v232, a8
    v_accvgpr_read_b32 v233, a9
    v_accvgpr_read_b32 v234, a10
    v_accvgpr_read_b32 v235, a11
    v_accvgpr_read_b32 v236, a12
    v_accvgpr_read_b32 v237, a13
    v_accvgpr_read_b32 v238, a14
    v_mfma_f32_16x16x32_bf16 a[32:35], v[32:35], v[180:183], a[32:35]
    s_waitcnt lgkmcnt(3)
    buffer_load_dwordx4 v6, s[20:23], s63 offen offset:0 lds
    buffer_load_dwordx4 v7, s[20:23], s63 offen offset:1024 lds
    v_accvgpr_read_b32 v239, a15
    v_mul_f32 v232, v232, v210
    v_mul_f32 v233, v233, v210
    v_mfma_f32_16x16x32_bf16 a[36:39], v[36:39], v[180:183], a[36:39]
    v_mul_f32 v234, v234, v210
    v_mul_f32 v235, v235, v210
    v_mul_f32 v236, v236, v210
    v_mul_f32 v237, v237, v210
    v_mul_f32 v238, v238, v210
    v_mul_f32 v239, v239, v210
    v_cvt_pk_bf16_f32 v240, v232, v233
    v_mfma_f32_16x16x32_bf16 a[40:43], v[40:43], v[180:183], a[40:43]
    v_cvt_pk_bf16_f32 v241, v234, v235
    v_cvt_pk_bf16_f32 v242, v236, v237
    v_cvt_pk_bf16_f32 v243, v238, v239
    buffer_store_dwordx4 v[240:243], v204, s[36:39], s88 offen offset:1024 sc1
    buffer_load_dwordx4 v8, s[20:23], s63 offen offset:2048 lds
    v_mfma_f32_16x16x32_bf16 a[44:47], v[44:47], v[180:183], a[44:47]
    buffer_load_dwordx4 v9, s[20:23], s63 offen offset:3072 lds
    v_accvgpr_read_b32 v244, a16
    v_accvgpr_read_b32 v245, a17
    v_accvgpr_read_b32 v246, a18
    v_accvgpr_read_b32 v247, a19
    v_accvgpr_read_b32 v248, a20
    v_mfma_f32_16x16x32_bf16 a[48:51], v[48:51], v[180:183], a[48:51]
    v_accvgpr_read_b32 v249, a21
    v_accvgpr_read_b32 v250, a22
    v_accvgpr_read_b32 v251, a23
    v_mul_f32 v244, v244, v210
    v_mul_f32 v245, v245, v210
    v_mul_f32 v246, v246, v210
    v_mul_f32 v247, v247, v210
    v_mfma_f32_16x16x32_bf16 a[52:55], v[52:55], v[180:183], a[52:55]
    v_mul_f32 v248, v248, v210
    v_mul_f32 v249, v249, v210
    v_mul_f32 v250, v250, v210
    v_mul_f32 v251, v251, v210
    v_cvt_pk_bf16_f32 v252, v244, v245
    v_cvt_pk_bf16_f32 v253, v246, v247
    v_cvt_pk_bf16_f32 v254, v248, v249
    v_mfma_f32_16x16x32_bf16 a[56:59], v[56:59], v[180:183], a[56:59]
    v_cvt_pk_bf16_f32 v255, v250, v251
    buffer_store_dwordx4 v[252:255], v204, s[36:39], s88 offen offset:2048 sc1
    s_waitcnt vmcnt(19)
    ds_read_b64_tr_b16 a[208:209], v14 offset:16384
    ds_read_b64_tr_b16 a[210:211], v14 offset:18432
    ds_read_b64_tr_b16 a[212:213], v15 offset:16384
    v_mfma_f32_16x16x32_bf16 a[60:63], v[60:63], v[180:183], a[60:63]
    ds_read_b64_tr_b16 a[214:215], v15 offset:18432
    ds_read_b64_tr_b16 a[216:217], v16 offset:16384
    ds_read_b64_tr_b16 a[218:219], v16 offset:18432
    ds_read_b64_tr_b16 a[220:221], v17 offset:16384
    ds_read_b64_tr_b16 a[222:223], v17 offset:18432
    ds_read_b64_tr_b16 v[64:65], v22 offset:16384
    ds_read_b64_tr_b16 v[66:67], v22 offset:18432
    v_cvt_pk_bf16_f32 v151, v154, v155
    s_nop 1
    v_mfma_f32_16x16x32_bf16 a[168:171], a[180:183], v[148:151], a[168:171]
    ds_read_b64_tr_b16 v[68:69], v23 offset:16384
    ds_read_b64_tr_b16 v[70:71], v23 offset:18432
    ds_read_b64_tr_b16 v[72:73], v24 offset:16384
    ds_read_b64_tr_b16 v[74:75], v24 offset:18432
    ds_read_b64_tr_b16 v[76:77], v25 offset:16384
    ds_read_b64_tr_b16 v[78:79], v25 offset:18432
    s_add_u32 s63, s94, 9216
    v_exp_f32 v188, v188
    v_exp_f32 v189, v189
    v_exp_f32 v190, v190
    v_cvt_pk_bf16_f32 v188, v188, v189
    v_exp_f32 v191, v191
    v_exp_f32 v192, v192
    v_cvt_pk_bf16_f32 v189, v190, v191
    v_exp_f32 v193, v193
    v_exp_f32 v194, v194
    v_cvt_pk_bf16_f32 v190, v192, v193
    v_exp_f32 v195, v195
    s_nop 0
    v_cvt_pk_bf16_f32 v191, v194, v195
    s_nop 1
    v_mfma_f32_16x16x32_bf16 a[168:171], a[180:183], v[188:191], a[168:171]
    s_and_b32 s63, s63, 32767
    s_add_u32 m0, s81, 65536
    s_mul_i32 s63, s63, 36
    s_waitcnt lgkmcnt(13)
    buffer_load_dwordx4 v6, s[20:23], s63 offen offset:0 lds
    buffer_load_dwordx4 v7, s[20:23], s63 offen offset:1024 lds
    v_accvgpr_read_b32 v220, a24
    v_mfma_f32_16x16x32_bf16 a[64:67], a[224:227], v[148:151], a[64:67]
    v_accvgpr_read_b32 v221, a25
    v_accvgpr_read_b32 v222, a26
    v_accvgpr_read_b32 v223, a27
    v_accvgpr_read_b32 v224, a28
    v_accvgpr_read_b32 v225, a29
    v_accvgpr_read_b32 v226, a30
    v_accvgpr_read_b32 v227, a31
    v_mfma_f32_16x16x32_bf16 a[68:71], a[228:231], v[148:151], a[68:71]
    v_mul_f32 v220, v220, v210
    v_mul_f32 v221, v221, v210
    v_mul_f32 v222, v222, v210
    v_mul_f32 v223, v223, v210
    v_mul_f32 v224, v224, v210
    v_mul_f32 v225, v225, v210
    v_mul_f32 v226, v226, v210
    v_mfma_f32_16x16x32_bf16 a[72:75], a[232:235], v[148:151], a[72:75]
    v_mul_f32 v227, v227, v210
    v_cvt_pk_bf16_f32 v228, v220, v221
    v_cvt_pk_bf16_f32 v229, v222, v223
    v_cvt_pk_bf16_f32 v230, v224, v225
    v_cvt_pk_bf16_f32 v231, v226, v227
    buffer_store_dwordx4 v[228:231], v204, s[36:39], s88 offen offset:3072 sc1
    v_mfma_f32_16x16x32_bf16 a[76:79], a[236:239], v[148:151], a[76:79]
    buffer_load_dwordx4 v8, s[20:23], s63 offen offset:2048 lds
    buffer_load_dwordx4 v9, s[20:23], s63 offen offset:3072 lds
    v_accvgpr_read_b32 v211, a164
    v_mov_b32 v215, v11
    v_accvgpr_read_b32 v232, a32
    v_mfma_f32_16x16x32_bf16 a[80:83], a[240:243], v[148:151], a[80:83]
    v_permlane32_swap_b32 v11, v215
    v_add_f32 v11, v11, v215
    v_mov_b32 v215, v11
    v_accvgpr_read_b32 v233, a33
    v_accvgpr_read_b32 v234, a34
    v_permlane16_swap_b32 v11, v215
    v_add_f32 v11, v11, v215
    v_mfma_f32_16x16x32_bf16 a[84:87], a[244:247], v[148:151], a[84:87]
    v_add_f32 v211, v211, v11
    v_add_f32 v216, v216, v211
    v_rcp_f32 v211, v211
    v_accvgpr_read_b32 v235, a35
    v_accvgpr_read_b32 v236, a36
    v_accvgpr_read_b32 v237, a37
    v_mfma_f32_16x16x32_bf16 a[88:91], a[248:251], v[148:151], a[88:91]
    v_accvgpr_read_b32 v238, a38
    v_accvgpr_read_b32 v239, a39
    v_mul_f32 v232, v232, v211
    v_mul_f32 v233, v233, v211
    v_mul_f32 v234, v234, v211
    v_mul_f32 v235, v235, v211
    v_mul_f32 v236, v236, v211
    v_mfma_f32_16x16x32_bf16 a[92:95], a[252:255], v[148:151], a[92:95]
    v_mul_f32 v237, v237, v211
    v_mul_f32 v238, v238, v211
    v_mul_f32 v239, v239, v211
    v_cvt_pk_bf16_f32 v240, v232, v233
    v_cvt_pk_bf16_f32 v241, v234, v235
    v_cvt_pk_bf16_f32 v242, v236, v237
    v_cvt_pk_bf16_f32 v243, v238, v239
    v_mfma_f32_16x16x32_bf16 a[64:67], v[32:35], v[188:191], a[64:67]
    buffer_store_dwordx4 v[240:243], v204, s[36:39], s89 offen offset:0 sc1
    s_add_u32 s63, s94, 10240
    s_and_b32 s63, s63, 32767
    s_add_u32 m0, s81, 16384
    s_mul_i32 s63, s63, 36
    v_accvgpr_read_b32 v244, a40
    v_mfma_f32_16x16x32_bf16 a[68:71], v[36:39], v[188:191], a[68:71]
    s_waitcnt lgkmcnt(0)
    buffer_load_dwordx4 v6, s[20:23], s63 offen offset:0 lds
    buffer_load_dwordx4 v7, s[20:23], s63 offen offset:1024 lds
    v_accvgpr_read_b32 v245, a41
    v_accvgpr_read_b32 v246, a42
    v_accvgpr_read_b32 v247, a43
    v_mfma_f32_16x16x32_bf16 a[72:75], v[40:43], v[188:191], a[72:75]
    v_accvgpr_read_b32 v248, a44
    v_accvgpr_read_b32 v249, a45
    v_accvgpr_read_b32 v250, a46
    v_accvgpr_read_b32 v251, a47
    v_mul_f32 v244, v244, v211
    v_mul_f32 v245, v245, v211
    v_mul_f32 v246, v246, v211
    v_mfma_f32_16x16x32_bf16 a[76:79], v[44:47], v[188:191], a[76:79]
    v_mul_f32 v247, v247, v211
    v_mul_f32 v248, v248, v211
    v_mul_f32 v249, v249, v211
    v_mul_f32 v250, v250, v211
    v_mul_f32 v251, v251, v211
    v_cvt_pk_bf16_f32 v252, v244, v245
    v_cvt_pk_bf16_f32 v253, v246, v247
    v_mfma_f32_16x16x32_bf16 a[80:83], v[48:51], v[188:191], a[80:83]
    v_cvt_pk_bf16_f32 v254, v248, v249
    v_cvt_pk_bf16_f32 v255, v250, v251
    buffer_store_dwordx4 v[252:255], v204, s[36:39], s89 offen offset:1024 sc1
    buffer_load_dwordx4 v8, s[20:23], s63 offen offset:2048 lds
    v_accvgpr_read_b32 v220, a48
    v_mfma_f32_16x16x32_bf16 a[84:87], v[52:55], v[188:191], a[84:87]
    buffer_load_dwordx4 v9, s[20:23], s63 offen offset:3072 lds
    v_accvgpr_read_b32 v221, a49
    v_accvgpr_read_b32 v222, a50
    v_accvgpr_read_b32 v223, a51
    v_accvgpr_read_b32 v224, a52
    v_accvgpr_read_b32 v225, a53
    v_mfma_f32_16x16x32_bf16 a[88:91], v[56:59], v[188:191], a[88:91]
    v_accvgpr_read_b32 v226, a54
    v_accvgpr_read_b32 v227, a55
    v_mul_f32 v220, v220, v211
    v_mul_f32 v221, v221, v211
    v_mul_f32 v222, v222, v211
    v_mul_f32 v223, v223, v211
    v_mul_f32 v224, v224, v211
    v_mfma_f32_16x16x32_bf16 a[92:95], v[60:63], v[188:191], a[92:95]
    v_mul_f32 v225, v225, v211
    v_mul_f32 v226, v226, v211
    v_mul_f32 v227, v227, v211
    v_cvt_pk_bf16_f32 v228, v220, v221
    v_cvt_pk_bf16_f32 v229, v222, v223
    v_cvt_pk_bf16_f32 v230, v224, v225
    v_cvt_pk_bf16_f32 v231, v226, v227
    v_exp_f32 v164, v164
    v_exp_f32 v165, v165
    v_exp_f32 v166, v166
    v_cvt_pk_bf16_f32 v164, v164, v165
    v_exp_f32 v167, v167
    v_exp_f32 v168, v168
    v_cvt_pk_bf16_f32 v165, v166, v167
    v_exp_f32 v169, v169
    v_exp_f32 v170, v170
    v_cvt_pk_bf16_f32 v166, v168, v169
    v_exp_f32 v171, v171
    s_nop 0
    v_cvt_pk_bf16_f32 v167, v170, v171
    s_nop 1
    v_mfma_f32_16x16x32_bf16 a[176:179], a[180:183], v[164:167], a[176:179]
    buffer_store_dwordx4 v[228:231], v204, s[36:39], s89 offen offset:2048 sc1
    v_accvgpr_read_b32 v232, a56
    v_accvgpr_read_b32 v233, a57
    v_accvgpr_read_b32 v234, a58
    v_accvgpr_read_b32 v235, a59
    v_accvgpr_read_b32 v236, a60
    v_mfma_f32_16x16x32_bf16 a[128:131], a[224:227], v[164:167], a[128:131]
    v_accvgpr_read_b32 v237, a61
    v_accvgpr_read_b32 v238, a62
    v_accvgpr_read_b32 v239, a63
    v_mul_f32 v232, v232, v211
    v_mul_f32 v233, v233, v211
    v_mul_f32 v234, v234, v211
    v_mul_f32 v235, v235, v211
    v_mfma_f32_16x16x32_bf16 a[132:135], a[228:231], v[164:167], a[132:135]
    v_mul_f32 v236, v236, v211
    v_mul_f32 v237, v237, v211
    v_mul_f32 v238, v238, v211
    v_mul_f32 v239, v239, v211
    v_cvt_pk_bf16_f32 v240, v232, v233
    v_cvt_pk_bf16_f32 v241, v234, v235
    v_cvt_pk_bf16_f32 v242, v236, v237
    v_mfma_f32_16x16x32_bf16 a[136:139], a[232:235], v[164:167], a[136:139]
    v_cvt_pk_bf16_f32 v243, v238, v239
    buffer_store_dwordx4 v[240:243], v204, s[36:39], s89 offen offset:3072 sc1
    v_exp_f32 v160, v160
    v_exp_f32 v161, v161
    v_mfma_f32_16x16x32_bf16 a[140:143], a[236:239], v[164:167], a[140:143]
    v_exp_f32 v162, v162
    v_cvt_pk_bf16_f32 v158, v160, v161
    v_exp_f32 v163, v163
    v_exp_f32 v196, v196
    v_mfma_f32_16x16x32_bf16 a[144:147], a[240:243], v[164:167], a[144:147]
    v_cvt_pk_bf16_f32 v159, v162, v163
    v_exp_f32 v197, v197
    v_exp_f32 v198, v198
    v_cvt_pk_bf16_f32 v196, v196, v197
    v_accvgpr_read_b32 v212, a168
    v_mfma_f32_16x16x32_bf16 a[148:151], a[244:247], v[164:167], a[148:151]
    v_exp_f32 v199, v199
    v_exp_f32 v200, v200
    v_cvt_pk_bf16_f32 v197, v198, v199
    v_exp_f32 v201, v201
    v_mfma_f32_16x16x32_bf16 a[152:155], a[248:251], v[164:167], a[152:155]
    v_exp_f32 v202, v202
    v_cvt_pk_bf16_f32 v198, v200, v201
    v_exp_f32 v203, v203
    v_add_f32 v216, v216, v212
    v_cvt_pk_bf16_f32 v199, v202, v203
    v_mfma_f32_16x16x32_bf16 a[156:159], a[252:255], v[164:167], a[156:159]
    v_rcp_f32 v212, v212
    v_accvgpr_read_b32 v214, a176
    v_add_f32 v216, v216, v214
    ds_write_b128 v206, a[128:131] offset:0
    v_accvgpr_read_b32 v244, a64
    v_mfma_f32_16x16x32_bf16 a[172:175], a[180:183], v[156:159], a[172:175]
    ds_write_b128 v206, a[132:135] offset:1024
    ds_write_b128 v206, a[136:139] offset:2048
    ds_write_b128 v206, a[140:143] offset:3072
    v_accvgpr_read_b32 v245, a65
    v_mfma_f32_16x16x32_bf16 a[172:175], a[180:183], v[196:199], a[172:175]
    ds_write_b128 v206, a[144:147] offset:16384
    ds_write_b128 v206, a[148:151] offset:17408
    ds_write_b128 v206, a[152:155] offset:18432
    v_accvgpr_read_b32 v246, a66
    v_mfma_f32_16x16x32_bf16 a[96:99], a[224:227], v[156:159], a[96:99]
    ds_write_b128 v206, a[156:159] offset:19456
    ds_write_b32 v207, v128 offset:49152
    ds_write_b32 v207, v214 offset:49408
    v_accvgpr_read_b32 v213, a172
    v_mfma_f32_16x16x32_bf16 a[100:103], a[228:231], v[156:159], a[100:103]
    v_add_f32 v216, v216, v213
    v_rcp_f32 v213, v213
    v_cmp_ngt_f32 vcc, v217, v216
    s_nop 1
    v_cndmask_b32_e64 v216, 0, 1, vcc
    ds_write_b32 v207, v216 offset:51200
    v_mfma_f32_16x16x32_bf16 a[104:107], a[232:235], v[156:159], a[104:107]
    v_accvgpr_read_b32 v247, a67
    v_accvgpr_read_b32 v248, a68
    v_accvgpr_read_b32 v249, a69
    v_accvgpr_read_b32 v250, a70
    v_accvgpr_read_b32 v251, a71
    v_mul_f32 v244, v244, v212
    v_mul_f32 v245, v245, v212
    v_mfma_f32_16x16x32_bf16 a[108:111], a[236:239], v[156:159], a[108:111]
    v_mul_f32 v246, v246, v212
    v_mul_f32 v247, v247, v212
    v_mul_f32 v248, v248, v212
    v_mul_f32 v249, v249, v212
    v_mul_f32 v250, v250, v212
    v_mul_f32 v251, v251, v212
    v_cvt_pk_bf16_f32 v252, v244, v245
    v_mfma_f32_16x16x32_bf16 a[112:115], a[240:243], v[156:159], a[112:115]
    v_cvt_pk_bf16_f32 v253, v246, v247
    v_cvt_pk_bf16_f32 v254, v248, v249
    v_cvt_pk_bf16_f32 v255, v250, v251
    buffer_store_dwordx4 v[252:255], v204, s[36:39], s90 offen offset:0 sc1
    v_accvgpr_read_b32 v220, a72
    v_accvgpr_read_b32 v221, a73
    v_mfma_f32_16x16x32_bf16 a[116:119], a[244:247], v[156:159], a[116:119]
    v_accvgpr_read_b32 v222, a74
    v_accvgpr_read_b32 v223, a75
    v_accvgpr_read_b32 v224, a76
    v_accvgpr_read_b32 v225, a77
    v_accvgpr_read_b32 v226, a78
    v_accvgpr_read_b32 v227, a79
    v_mul_f32 v220, v220, v212
    v_mfma_f32_16x16x32_bf16 a[120:123], a[248:251], v[156:159], a[120:123]
    v_mul_f32 v221, v221, v212
    v_mul_f32 v222, v222, v212
    v_mul_f32 v223, v223, v212
    v_mul_f32 v224, v224, v212
    v_mul_f32 v225, v225, v212
    v_mul_f32 v226, v226, v212
    v_mul_f32 v227, v227, v212
    v_mfma_f32_16x16x32_bf16 a[124:127], a[252:255], v[156:159], a[124:127]
    v_cvt_pk_bf16_f32 v228, v220, v221
    v_cvt_pk_bf16_f32 v229, v222, v223
    v_cvt_pk_bf16_f32 v230, v224, v225
    v_cvt_pk_bf16_f32 v231, v226, v227
    buffer_store_dwordx4 v[228:231], v204, s[36:39], s90 offen offset:1024 sc1
    v_accvgpr_read_b32 v232, a80
    v_mfma_f32_16x16x32_bf16 a[96:99], v[32:35], v[196:199], a[96:99]
    v_accvgpr_read_b32 v233, a81
    v_accvgpr_read_b32 v234, a82
    v_accvgpr_read_b32 v235, a83
    v_accvgpr_read_b32 v236, a84
    v_accvgpr_read_b32 v237, a85
    v_accvgpr_read_b32 v238, a86
    v_accvgpr_read_b32 v239, a87
    v_mfma_f32_16x16x32_bf16 a[100:103], v[36:39], v[196:199], a[100:103]
    v_mul_f32 v232, v232, v212
    v_mul_f32 v233, v233, v212
    v_mul_f32 v234, v234, v212
    v_mul_f32 v235, v235, v212
    v_mul_f32 v236, v236, v212
    v_mul_f32 v237, v237, v212
    v_mul_f32 v238, v238, v212
    v_mfma_f32_16x16x32_bf16 a[104:107], v[40:43], v[196:199], a[104:107]
    v_mul_f32 v239, v239, v212
    v_cvt_pk_bf16_f32 v240, v232, v233
    v_cvt_pk_bf16_f32 v241, v234, v235
    v_cvt_pk_bf16_f32 v242, v236, v237
    v_cvt_pk_bf16_f32 v243, v238, v239
    buffer_store_dwordx4 v[240:243], v204, s[36:39], s90 offen offset:2048 sc1
    v_mfma_f32_16x16x32_bf16 a[108:111], v[44:47], v[196:199], a[108:111]
    v_accvgpr_read_b32 v244, a88
    v_accvgpr_read_b32 v245, a89
    v_accvgpr_read_b32 v246, a90
    v_accvgpr_read_b32 v247, a91
    v_accvgpr_read_b32 v248, a92
    v_accvgpr_read_b32 v249, a93
    v_accvgpr_read_b32 v250, a94
    v_mfma_f32_16x16x32_bf16 a[112:115], v[48:51], v[196:199], a[112:115]
    v_accvgpr_read_b32 v251, a95
    v_mul_f32 v244, v244, v212
    v_mul_f32 v245, v245, v212
    v_mul_f32 v246, v246, v212
    v_mul_f32 v247, v247, v212
    v_mul_f32 v248, v248, v212
    v_mul_f32 v249, v249, v212
    v_mfma_f32_16x16x32_bf16 a[116:119], v[52:55], v[196:199], a[116:119]
    v_mul_f32 v250, v250, v212
    v_mul_f32 v251, v251, v212
    v_cvt_pk_bf16_f32 v252, v244, v245
    v_cvt_pk_bf16_f32 v253, v246, v247
    v_cvt_pk_bf16_f32 v254, v248, v249
    v_cvt_pk_bf16_f32 v255, v250, v251
    v_accvgpr_read_b32 v220, a96
    v_mfma_f32_16x16x32_bf16 a[120:123], v[56:59], v[196:199], a[120:123]
    buffer_store_dwordx4 v[252:255], v204, s[36:39], s90 offen offset:3072 sc1
    s_waitcnt lgkmcnt(0)
    s_barrier
    ds_read_b32 v164, v209 offset:49152
    ds_read_b32 v165, v209 offset:49664
    ds_read_b32 v166, v209 offset:49408
    v_mfma_f32_16x16x32_bf16 a[124:127], v[60:63], v[196:199], a[124:127]
    ds_read_b32 v167, v209 offset:49920
    ds_read_b32 v168, v205 offset:51200
    ds_read_b32 v169, v205 offset:51712
    ds_read_b32 v170, v205 offset:52224
    ds_read_b32 v171, v205 offset:52736
    ds_read_b128 v[132:135], v208 offset:0
    ds_read_b128 v[136:139], v208 offset:1024
    ds_read_b128 v[140:143], v208 offset:2048
    ds_read_b128 v[144:147], v208 offset:3072
    ds_read_b128 v[148:151], v208 offset:4096
    ds_read_b128 v[152:155], v208 offset:5120
    ds_read_b128 v[172:175], v208 offset:6144
    ds_read_b128 v[176:179], v208 offset:7168
    s_waitcnt vmcnt(32)
    ds_read_b64_tr_b16 a[128:129], v18 offset:16384
    ds_read_b64_tr_b16 a[130:131], v18 offset:18432
    ds_read_b64_tr_b16 a[132:133], v19 offset:16384
    ds_read_b64_tr_b16 a[134:135], v19 offset:18432
    ds_read_b64_tr_b16 a[136:137], v20 offset:16384
    ds_read_b64_tr_b16 a[138:139], v20 offset:18432
    ds_read_b64_tr_b16 a[140:141], v21 offset:16384
    ds_read_b64_tr_b16 a[142:143], v21 offset:18432
    s_waitcnt vmcnt(28)
    ds_read_b64_tr_b16 a[144:145], v14 offset:32768
    ds_read_b64_tr_b16 a[146:147], v14 offset:34816
    ds_read_b64_tr_b16 a[148:149], v15 offset:32768
    ds_read_b64_tr_b16 a[150:151], v15 offset:34816
    ds_read_b64_tr_b16 a[152:153], v16 offset:32768
    ds_read_b64_tr_b16 a[154:155], v16 offset:34816
    ds_read_b64_tr_b16 a[156:157], v17 offset:32768
    ds_read_b64_tr_b16 a[158:159], v17 offset:34816
    v_accvgpr_read_b32 v221, a97
    v_accvgpr_read_b32 v222, a98
    v_accvgpr_read_b32 v223, a99
    v_accvgpr_read_b32 v224, a100
    v_accvgpr_read_b32 v225, a101
    v_accvgpr_read_b32 v226, a102
    v_accvgpr_read_b32 v227, a103
    v_mul_f32 v220, v220, v213
    v_mul_f32 v221, v221, v213
    v_mul_f32 v222, v222, v213
    v_mul_f32 v223, v223, v213
    v_mul_f32 v224, v224, v213
    v_mul_f32 v225, v225, v213
    v_mul_f32 v226, v226, v213
    v_mul_f32 v227, v227, v213
    v_cvt_pk_bf16_f32 v228, v220, v221
    v_cvt_pk_bf16_f32 v229, v222, v223
    v_cvt_pk_bf16_f32 v230, v224, v225
    v_cvt_pk_bf16_f32 v231, v226, v227
    buffer_store_dwordx4 v[228:231], v204, s[36:39], s91 offen offset:0 sc1
    s_add_u32 s63, s94, 11264
    s_and_b32 s63, s63, 32767
    s_add_u32 m0, s81, 81920
    s_mul_i32 s63, s63, 36
    s_waitcnt lgkmcnt(8)
    buffer_load_dwordx4 v6, s[20:23], s63 offen offset:0 lds
    buffer_load_dwordx4 v7, s[20:23], s63 offen offset:1024 lds
    v_accvgpr_read_b32 v232, a104
    v_accvgpr_read_b32 v233, a105
    v_accvgpr_read_b32 v234, a106
    v_accvgpr_read_b32 v235, a107
    v_accvgpr_read_b32 v236, a108
    v_accvgpr_read_b32 v237, a109
    v_accvgpr_read_b32 v238, a110
    v_accvgpr_read_b32 v239, a111
    v_mul_f32 v232, v232, v213
    v_mul_f32 v233, v233, v213
    v_mul_f32 v234, v234, v213
    v_mul_f32 v235, v235, v213
    v_mul_f32 v236, v236, v213
    v_mul_f32 v237, v237, v213
    v_mul_f32 v238, v238, v213
    v_mul_f32 v239, v239, v213
    v_cvt_pk_bf16_f32 v240, v232, v233
    v_cvt_pk_bf16_f32 v241, v234, v235
    v_cvt_pk_bf16_f32 v242, v236, v237
    v_cvt_pk_bf16_f32 v243, v238, v239
    buffer_store_dwordx4 v[240:243], v204, s[36:39], s91 offen offset:1024 sc1
    buffer_load_dwordx4 v8, s[20:23], s63 offen offset:2048 lds
    buffer_load_dwordx4 v9, s[20:23], s63 offen offset:3072 lds
    v_accvgpr_read_b32 v244, a112
    v_accvgpr_read_b32 v245, a113
    v_accvgpr_read_b32 v246, a114
    v_accvgpr_read_b32 v247, a115
    v_accvgpr_read_b32 v248, a116
    v_accvgpr_read_b32 v249, a117
    v_accvgpr_read_b32 v250, a118
    v_accvgpr_read_b32 v251, a119
    v_mul_f32 v244, v244, v213
    v_mul_f32 v245, v245, v213
    v_mul_f32 v246, v246, v213
    v_mul_f32 v247, v247, v213
    v_mul_f32 v248, v248, v213
    v_mul_f32 v249, v249, v213
    v_mul_f32 v250, v250, v213
    v_mul_f32 v251, v251, v213
    v_cvt_pk_bf16_f32 v252, v244, v245
    v_cvt_pk_bf16_f32 v253, v246, v247
    v_cvt_pk_bf16_f32 v254, v248, v249
    v_cvt_pk_bf16_f32 v255, v250, v251
    buffer_store_dwordx4 v[252:255], v204, s[36:39], s91 offen offset:2048 sc1
    s_add_u32 s63, s94, 12288
    s_and_b32 s63, s63, 32767
    s_add_u32 m0, s81, 32768
    s_mul_i32 s63, s63, 36
    s_waitcnt lgkmcnt(0)
    buffer_load_dwordx4 v6, s[20:23], s63 offen offset:0 lds
    buffer_load_dwordx4 v7, s[20:23], s63 offen offset:1024 lds
    v_accvgpr_read_b32 v220, a120
    v_accvgpr_read_b32 v221, a121
    v_accvgpr_read_b32 v222, a122
    v_accvgpr_read_b32 v223, a123
    v_accvgpr_read_b32 v224, a124
    v_accvgpr_read_b32 v225, a125
    v_accvgpr_read_b32 v226, a126
    v_accvgpr_read_b32 v227, a127
    v_mul_f32 v220, v220, v213
    v_mul_f32 v221, v221, v213
    v_mul_f32 v222, v222, v213
    v_mul_f32 v223, v223, v213
    v_mul_f32 v224, v224, v213
    v_mul_f32 v225, v225, v213
    v_mul_f32 v226, v226, v213
    v_mul_f32 v227, v227, v213
    v_cvt_pk_bf16_f32 v228, v220, v221
    v_cvt_pk_bf16_f32 v229, v222, v223
    v_cvt_pk_bf16_f32 v230, v224, v225
    v_cvt_pk_bf16_f32 v231, v226, v227
    buffer_store_dwordx4 v[228:231], v204, s[36:39], s91 offen offset:3072 sc1
    buffer_load_dwordx4 v8, s[20:23], s63 offen offset:2048 lds
    buffer_load_dwordx4 v9, s[20:23], s63 offen offset:3072 lds
    s_waitcnt lgkmcnt(0)
    s_barrier
    v_min_f32 v216, v164, v165
    v_sub_f32 v164, v216, v164
    v_sub_f32 v165, v216, v165
    v_exp_f32 v164, v164
    v_exp_f32 v165, v165
    v_or3_b32 v168, v168, v169, v170
    v_mul_f32 v216, v164, v166
    v_fmac_f32 v216, v165, v167
    v_rcp_f32 v216, v216
    v_or_b32 v168, v168, v171
    v_mul_f32 v164, v164, v216
    v_mul_f32 v165, v165, v216
    v_mul_f32 v132, v132, v164
    v_mul_f32 v133, v133, v164
    v_mul_f32 v134, v134, v164
    v_mul_f32 v135, v135, v164
    v_mul_f32 v136, v136, v164
    v_mul_f32 v137, v137, v164
    v_mul_f32 v138, v138, v164
    v_mul_f32 v139, v139, v164
    v_mul_f32 v140, v140, v164
    v_mul_f32 v141, v141, v164
    v_mul_f32 v142, v142, v164
    v_mul_f32 v143, v143, v164
    v_mul_f32 v144, v144, v164
    v_mul_f32 v145, v145, v164
    v_mul_f32 v146, v146, v164
    v_mul_f32 v147, v147, v164
    v_fmac_f32 v132, v148, v165
    v_fmac_f32 v133, v149, v165
    v_fmac_f32 v134, v150, v165
    v_fmac_f32 v135, v151, v165
    v_fmac_f32 v136, v152, v165
    v_fmac_f32 v137, v153, v165
    v_fmac_f32 v138, v154, v165
    v_fmac_f32 v139, v155, v165
    v_fmac_f32 v140, v172, v165
    v_fmac_f32 v141, v173, v165
    v_fmac_f32 v142, v174, v165
    v_fmac_f32 v143, v175, v165
    v_fmac_f32 v144, v176, v165
    v_fmac_f32 v145, v177, v165
    v_fmac_f32 v146, v178, v165
    v_fmac_f32 v147, v179, v165
    v_cvt_pk_bf16_f32 v148, v132, v133
    v_cvt_pk_bf16_f32 v149, v134, v135
    v_cvt_pk_bf16_f32 v150, v136, v137
    v_cvt_pk_bf16_f32 v151, v138, v139
    v_cvt_pk_bf16_f32 v152, v140, v141
    v_cvt_pk_bf16_f32 v153, v142, v143
    v_cvt_pk_bf16_f32 v154, v144, v145
    v_cvt_pk_bf16_f32 v155, v146, v147
    buffer_store_dwordx4 v[148:151], v204, s[36:39], s92 offen offset:0 sc1
    buffer_store_dwordx4 v[152:155], v204, s[36:39], s92 offen offset:1024 sc1
    s_add_u32 s63, s94, 13312
    s_and_b32 s63, s63, 32767
    s_add_u32 m0, s81, 49152
    s_mul_i32 s63, s63, 36
    buffer_load_dwordx4 v6, s[20:23], s63 offen offset:0 lds
    buffer_load_dwordx4 v7, s[20:23], s63 offen offset:1024 lds
    buffer_load_dwordx4 v8, s[20:23], s63 offen offset:2048 lds
    buffer_load_dwordx4 v9, s[20:23], s63 offen offset:3072 lds
    s_add_u32 s63, s94, 14336
    s_and_b32 s63, s63, 32767
    s_add_u32 m0, s81, 114688
    s_mul_i32 s63, s63, 36
    buffer_load_dwordx4 v6, s[20:23], s63 offen offset:0 lds
    buffer_load_dwordx4 v7, s[20:23], s63 offen offset:1024 lds
    buffer_load_dwordx4 v8, s[20:23], s63 offen offset:2048 lds
    buffer_load_dwordx4 v9, s[20:23], s63 offen offset:3072 lds
    s_add_u32 s63, s94, 15360
    s_and_b32 s63, s63, 32767
    s_add_u32 m0, s81, 131072
    s_mul_i32 s63, s63, 36
    buffer_load_dwordx4 v6, s[20:23], s63 offen offset:0 lds
    buffer_load_dwordx4 v7, s[20:23], s63 offen offset:1024 lds
    buffer_load_dwordx4 v8, s[20:23], s63 offen offset:2048 lds
    buffer_load_dwordx4 v9, s[20:23], s63 offen offset:3072 lds
    s_add_u32 s63, s94, 16384
    s_and_b32 s63, s63, 32767
    s_add_u32 m0, s81, 147456
    s_mul_i32 s63, s63, 36
    buffer_load_dwordx4 v6, s[20:23], s63 offen offset:0 lds
    buffer_load_dwordx4 v7, s[20:23], s63 offen offset:1024 lds
    buffer_load_dwordx4 v8, s[20:23], s63 offen offset:2048 lds
    buffer_load_dwordx4 v9, s[20:23], s63 offen offset:3072 lds
    v_cmp_ne_u32 vcc, 0, v168
    s_cmp_lg_u64 vcc, 0
    s_cselect_b32 s52, 1, 0
    s_andn2_b32 s52, s52, s49
    s_cbranch_scc1 L_redo
    s_mov_b32 s40, s98
    s_mov_b32 s41, s99
    s_movk_i32 s42, 256
    s_mov_b32 s43, 0x00020000
    s_and_b32 s84, s2, 3
    v_mbcnt_lo_u32_b32 v10, -1, 0
    v_mbcnt_hi_u32_b32 v10, -1, v10
    s_mul_i32 s52, s3, 32768
    v_lshlrev_b32 v11, 4, v10
    v_add_u32 v0, s52, v11
    v_add_u32 v1, 131072, v0
    v_add_u32 v2, 262144, v0
    v_add_u32 v3, 393216, v0
    v_add_u32 v4, 524288, v0
    v_add_u32 v5, 655360, v0
    s_mul_i32 s44, s83, 43
    s_lshr_b32 s44, s44, 7
    s_mul_i32 s52, s44, 3
    s_sub_u32 s56, s83, s52
    s_mul_i32 s45, s84, 3
    s_add_u32 s45, s45, s56
    s_mul_i32 s52, s4, 72
    s_mul_i32 s53, s45, 6
    s_add_u32 s52, s52, s53
    s_lshl_b32 s52, s52, 17
    s_add_u32 s24, s16, s52
    s_addc_u32 s25, s17, 0
    s_mov_b32 s26, 786432
    s_mov_b32 s28, s96
    s_mov_b32 s29, s97
    s_mov_b32 s30, 2654208
    v_and_b32 v29, 3, v10
    v_lshlrev_b32 v29, 12, v29
    v_xor_b32 v29, s81, v29
    v_add_u32 v29, 147456, v29
    s_cmp_eq_u32 s56, 0
    s_cselect_b32 s85, 4, 0x40004
    s_cmp_eq_u32 s56, 2
    s_cselect_b32 s85, 0x40000, s85
    s_lshl_b32 s52, s3, 2
    s_lshl_b32 s85, s85, s52
    s_lshl_b32 s52, s4, 2
    s_add_u32 s46, s52, s84
    s_lshl_b32 s46, s46, 5
    s_mov_b32 s82, 0
    s_lshr_b32 s53, s6, 1
    s_add_u32 s52, s52, s53
    s_lshl_b32 s52, s52, 5
    s_and_b32 s53, s6, 1
    s_lshl_b32 s53, s53, 2
    s_add_u32 s53, s53, s84
    s_lshl_b32 s53, s53, 2
    s_lshl_b32 s86, 1, s53
    v_mov_b32 v26, s86
    v_mov_b32 v27, 0
    v_mov_b32 v28, 0
    s_waitcnt vmcnt(16)
    s_barrier
    s_cmp_eq_u32 s3, 0
    s_cbranch_scc0 L_nosig
    s_mov_b64 exec, 1
    buffer_atomic_add_x2 v[26:27], v28, s[40:43], s52 offen sc0
    s_mov_b64 exec, -1
L_nosig:
    s_cmp_lt_u32 s83, 27
    s_cbranch_scc0 L_notile
    s_waitcnt vmcnt(54)
    ds_read_b64_tr_b16 a[160:161], v18 offset:32768
    ds_read_b64_tr_b16 a[162:163], v18 offset:34816
    ds_read_b64_tr_b16 a[164:165], v19 offset:32768
    ds_read_b64_tr_b16 a[166:167], v19 offset:34816
    ds_read_b64_tr_b16 a[168:169], v20 offset:32768
    ds_read_b64_tr_b16 a[170:171], v20 offset:34816
    ds_read_b64_tr_b16 a[172:173], v21 offset:32768
    ds_read_b64_tr_b16 a[174:175], v21 offset:34816
    s_waitcnt vmcnt(48)
    ds_read_b64_tr_b16 a[176:177], v14 offset:0
    ds_read_b64_tr_b16 a[178:179], v14 offset:2048
    ds_read_b64_tr_b16 a[180:181], v15 offset:0
    ds_read_b64_tr_b16 a[182:183], v15 offset:2048
    ds_read_b64_tr_b16 a[184:185], v16 offset:0
    ds_read_b64_tr_b16 a[186:187], v16 offset:2048
    ds_read_b64_tr_b16 a[188:189], v17 offset:0
    ds_read_b64_tr_b16 a[190:191], v17 offset:2048
    s_add_u32 s63, s94, 17408
    s_and_b32 s63, s63, 32767
    s_add_u32 m0, s81, 98304
    s_mul_i32 s63, s63, 36
    s_waitcnt lgkmcnt(8)
    buffer_load_dwordx4 v6, s[20:23], s63 offen offset:0 lds
    buffer_load_dwordx4 v7, s[20:23], s63 offen offset:1024 lds
    buffer_load_dwordx4 v8, s[20:23], s63 offen offset:2048 lds
    buffer_load_dwordx4 v9, s[20:23], s63 offen offset:3072 lds
    s_waitcnt vmcnt(46)
    ds_read_b64_tr_b16 v[32:33], v18 offset:0
    ds_read_b64_tr_b16 v[34:35], v18 offset:2048
    ds_read_b64_tr_b16 v[36:37], v19 offset:0
    ds_read_b64_tr_b16 v[38:39], v19 offset:2048
    ds_read_b64_tr_b16 v[40:41], v20 offset:0
    ds_read_b64_tr_b16 v[42:43], v20 offset:2048
    ds_read_b64_tr_b16 v[44:45], v21 offset:0
    ds_read_b64_tr_b16 v[46:47], v21 offset:2048
    s_add_u32 s63, s94, 18432
    s_and_b32 s63, s63, 32767
    s_add_u32 m0, s81, 0
    s_mul_i32 s63, s63, 36
    s_waitcnt lgkmcnt(8)
    buffer_load_dwordx4 v6, s[20:23], s63 offen offset:0 lds
    buffer_load_dwordx4 v7, s[20:23], s63 offen offset:1024 lds
    buffer_load_dwordx4 v8, s[20:23], s63 offen offset:2048 lds
    buffer_load_dwordx4 v9, s[20:23], s63 offen offset:3072 lds
    s_waitcnt vmcnt(44)
    ds_read_b64_tr_b16 v[48:49], v14 offset:16384
    ds_read_b64_tr_b16 v[50:51], v14 offset:18432
    ds_read_b64_tr_b16 v[52:53], v15 offset:16384
    ds_read_b64_tr_b16 v[54:55], v15 offset:18432
    ds_read_b64_tr_b16 v[56:57], v16 offset:16384
    ds_read_b64_tr_b16 v[58:59], v16 offset:18432
    ds_read_b64_tr_b16 v[60:61], v17 offset:16384
    ds_read_b64_tr_b16 v[62:63], v17 offset:18432
    s_add_u32 s63, s94, 19456
    s_and_b32 s63, s63, 32767
    s_add_u32 m0, s81, 65536
    s_mul_i32 s63, s63, 36
    s_waitcnt lgkmcnt(8)
    buffer_load_dwordx4 v6, s[20:23], s63 offen offset:0 lds
    buffer_load_dwordx4 v7, s[20:23], s63 offen offset:1024 lds
    buffer_load_dwordx4 v8, s[20:23], s63 offen offset:2048 lds
    buffer_load_dwordx4 v9, s[20:23], s63 offen offset:3072 lds
    s_waitcnt vmcnt(36)
    ds_read_b64_tr_b16 a[224:225], v18 offset:16384
    ds_read_b64_tr_b16 a[226:227], v18 offset:18432
    ds_read_b64_tr_b16 a[228:229], v19 offset:16384
    ds_read_b64_tr_b16 a[230:231], v19 offset:18432
    ds_read_b64_tr_b16 a[232:233], v20 offset:16384
    ds_read_b64_tr_b16 a[234:235], v20 offset:18432
    ds_read_b64_tr_b16 a[236:237], v21 offset:16384
    ds_read_b64_tr_b16 a[238:239], v21 offset:18432
    s_add_u32 s63, s94, 20480
    s_and_b32 s63, s63, 32767
    s_add_u32 m0, s81, 16384
    s_mul_i32 s63, s63, 36
    s_waitcnt lgkmcnt(8)
    buffer_load_dwordx4 v6, s[20:23], s63 offen offset:0 lds
    buffer_load_dwordx4 v7, s[20:23], s63 offen offset:1024 lds
    buffer_load_dwordx4 v8, s[20:23], s63 offen offset:2048 lds
    buffer_load_dwordx4 v9, s[20:23], s63 offen offset:3072 lds
    s_waitcnt vmcnt(34)
    ds_read_b64_tr_b16 a[240:241], v14 offset:32768
    ds_read_b64_tr_b16 a[242:243], v14 offset:34816
    ds_read_b64_tr_b16 a[244:245], v15 offset:32768
    ds_read_b64_tr_b16 a[246:247], v15 offset:34816
    ds_read_b64_tr_b16 a[248:249], v16 offset:32768
    ds_read_b64_tr_b16 a[250:251], v16 offset:34816
    ds_read_b64_tr_b16 a[252:253], v17 offset:32768
    ds_read_b64_tr_b16 a[254:255], v17 offset:34816
    s_add_u32 s63, s94, 21504
    s_and_b32 s63, s63, 32767
    s_add_u32 m0, s81, 81920
    s_mul_i32 s63, s63, 36
    s_waitcnt lgkmcnt(8)
    buffer_load_dwordx4 v6, s[20:23], s63 offen offset:0 lds
    buffer_load_dwordx4 v7, s[20:23], s63 offen offset:1024 lds
    buffer_load_dwordx4 v8, s[20:23], s63 offen offset:2048 lds
    buffer_load_dwordx4 v9, s[20:23], s63 offen offset:3072 lds
    s_waitcnt vmcnt(32)
    ds_read_b64_tr_b16 a[80:81], v14 offset:49152
    ds_read_b64_tr_b16 a[82:83], v14 offset:51200
    ds_read_b64_tr_b16 a[84:85], v15 offset:49152
    ds_read_b64_tr_b16 a[86:87], v15 offset:51200
    ds_read_b64_tr_b16 a[88:89], v16 offset:49152
    ds_read_b64_tr_b16 a[90:91], v16 offset:51200
    ds_read_b64_tr_b16 a[92:93], v17 offset:49152
    ds_read_b64_tr_b16 a[94:95], v17 offset:51200
    s_add_u32 s63, s94, 22528
    s_and_b32 s63, s63, 32767
    s_add_u32 m0, s81, 32768
    s_mul_i32 s63, s63, 36
    s_waitcnt lgkmcnt(8)
    buffer_load_dwordx4 v6, s[20:23], s63 offen offset:0 lds
    buffer_load_dwordx4 v7, s[20:23], s63 offen offset:1024 lds
    buffer_load_dwordx4 v8, s[20:23], s63 offen offset:2048 lds
    buffer_load_dwordx4 v9, s[20:23], s63 offen offset:3072 lds
    s_waitcnt vmcnt(32)
    ds_read_b64_tr_b16 a[96:97], v18 offset:49152
    ds_read_b64_tr_b16 a[98:99], v18 offset:51200
    ds_read_b64_tr_b16 a[100:101], v19 offset:49152
    ds_read_b64_tr_b16 a[102:103], v19 offset:51200
    ds_read_b64_tr_b16 a[104:105], v20 offset:49152
    ds_read_b64_tr_b16 a[106:107], v20 offset:51200
    ds_read_b64_tr_b16 a[108:109], v21 offset:49152
    ds_read_b64_tr_b16 a[110:111], v21 offset:51200
    s_mov_b64 exec, 1
    buffer_load_dword v30, v28, s[40:43], s46 offen sc1
    s_mov_b64 exec, -1
    s_add_u32 s63, s94, 23552
    s_and_b32 s63, s63, 32767
    s_add_u32 m0, s81, 49152
    s_mul_i32 s63, s63, 36
    s_waitcnt lgkmcnt(8)
    buffer_load_dwordx4 v6, s[20:23], s63 offen offset:0 lds
    buffer_load_dwordx4 v7, s[20:23], s63 offen offset:1024 lds
    buffer_load_dwordx4 v8, s[20:23], s63 offen offset:2048 lds
    buffer_load_dwordx4 v9, s[20:23], s63 offen offset:3072 lds
    s_waitcnt vmcnt(33)
    ds_read_b64_tr_b16 a[112:113], v22 offset:0
    ds_read_b64_tr_b16 a[114:115], v22 offset:2048
    ds_read_b64_tr_b16 a[116:117], v23 offset:0
    ds_read_b64_tr_b16 a[118:119], v23 offset:2048
    ds_read_b64_tr_b16 a[120:121], v24 offset:0
    ds_read_b64_tr_b16 a[122:123], v24 offset:2048
    ds_read_b64_tr_b16 a[124:125], v25 offset:0
    ds_read_b64_tr_b16 a[126:127], v25 offset:2048
    s_add_u32 s63, s94, 24576
    s_and_b32 s63, s63, 32767
    s_add_u32 m0, s81, 114688
    s_mul_i32 s63, s63, 36
    s_waitcnt lgkmcnt(8)
    buffer_load_dwordx4 v6, s[20:23], s63 offen offset:0 lds
    buffer_load_dwordx4 v7, s[20:23], s63 offen offset:1024 lds
    buffer_load_dwordx4 v8, s[20:23], s63 offen offset:2048 lds
    buffer_load_dwordx4 v9, s[20:23], s63 offen offset:3072 lds
    s_add_u32 s63, s94, 25600
    s_and_b32 s63, s63, 32767
    s_add_u32 m0, s81, 131072
    s_mul_i32 s63, s63, 36
    s_waitcnt lgkmcnt(0)
    buffer_load_dwordx4 v6, s[20:23], s63 offen offset:0 lds
    buffer_load_dwordx4 v7, s[20:23], s63 offen offset:1024 lds
    buffer_load_dwordx4 v8, s[20:23], s63 offen offset:2048 lds
    buffer_load_dwordx4 v9, s[20:23], s63 offen offset:3072 lds
    s_waitcnt vmcnt(12)
    v_readfirstlane_b32 s54, v26
    v_readfirstlane_b32 s47, v27
    s_add_u32 s54, s54, s86
    s_and_b32 s47, s47, 0x7ffffff
    s_cmp_eq_u32 s54, 1145324612
    s_cselect_b32 s47, s47, 0
    v_readfirstlane_b32 s54, v30
    s_and_b32 s54, s54, s85
    s_cmp_eq_u32 s54, s85
    s_cbranch_scc0 L_poll0
L_go:
    s_add_u32 s60, s94, 0
    s_and_b32 s60, s60, 32767
    buffer_load_dwordx4 v[112:115], v0, s[24:27], s60 offen sc1
    buffer_load_dwordx4 v[116:119], v1, s[24:27], s60 offen sc1
    buffer_load_dwordx4 v[120:123], v2, s[24:27], s60 offen sc1
    buffer_load_dwordx4 v[124:127], v3, s[24:27], s60 offen sc1
    buffer_load_dwordx4 v[128:131], v4, s[24:27], s60 offen sc1
    buffer_load_dwordx4 v[132:135], v5, s[24:27], s60 offen sc1
    s_add_u32 s60, s94, 1024
    s_and_b32 s60, s60, 32767
    buffer_load_dwordx4 v[136:139], v0, s[24:27], s60 offen sc1
    buffer_load_dwordx4 v[140:143], v1, s[24:27], s60 offen sc1
    buffer_load_dwordx4 v[144:147], v2, s[24:27], s60 offen sc1
    buffer_load_dwordx4 v[148:151], v3, s[24:27], s60 offen sc1
    buffer_load_dwordx4 v[152:155], v4, s[24:27], s60 offen sc1
    buffer_load_dwordx4 v[156:159], v5, s[24:27], s60 offen sc1
    s_add_u32 s60, s94, 2048
    s_and_b32 s60, s60, 32767
    buffer_load_dwordx4 v[160:163], v0, s[24:27], s60 offen sc1
    buffer_load_dwordx4 v[164:167], v1, s[24:27], s60 offen sc1
    buffer_load_dwordx4 v[168:171], v2, s[24:27], s60 offen sc1
    buffer_load_dwordx4 v[172:175], v3, s[24:27], s60 offen sc1
    buffer_load_dwordx4 v[176:179], v4, s[24:27], s60 offen sc1
    buffer_load_dwordx4 v[180:183], v5, s[24:27], s60 offen sc1
    s_add_u32 s60, s94, 3072
    s_and_b32 s60, s60, 32767
    buffer_load_dwordx4 v[184:187], v0, s[24:27], s60 offen sc1
    buffer_load_dwordx4 v[188:191], v1, s[24:27], s60 offen sc1
    buffer_load_dwordx4 v[192:195], v2, s[24:27], s60 offen sc1
    buffer_load_dwordx4 v[196:199], v3, s[24:27], s60 offen sc1
    buffer_load_dwordx4 v[200:203], v4, s[24:27], s60 offen sc1
    buffer_load_dwordx4 v[204:207], v5, s[24:27], s60 offen sc1
    s_waitcnt vmcnt(18)
    v_mfma_f32_16x16x32_bf16 v[232:235], v[96:99], v[112:115], 0
    s_add_u32 s60, s94, 4096
    s_and_b32 s60, s60, 32767
    v_lshlrev_b32 v11, 4, v10
    v_mfma_f32_16x16x32_bf16 a[0:3], v[100:103], v[112:115], 0
    buffer_load_dwordx4 v[208:211], v0, s[24:27], s60 offen sc1
    v_mfma_f32_16x16x32_bf16 a[24:27], v[104:107], v[112:115], 0
    v_lshrrev_b32 v12, 4, v10
    v_mfma_f32_16x16x32_bf16 a[48:51], v[108:111], v[112:115], 0
    buffer_load_dwordx4 v[212:215], v1, s[24:27], s60 offen sc1
    v_mfma_f32_16x16x32_bf16 v[236:239], v[96:99], v[116:119], 0
    v_mfma_f32_16x16x32_bf16 a[4:7], v[100:103], v[116:119], 0
    v_mfma_f32_16x16x32_bf16 a[28:31], v[104:107], v[116:119], 0
    v_mfma_f32_16x16x32_bf16 a[52:55], v[108:111], v[116:119], 0
    buffer_load_dwordx4 v[216:219], v2, s[24:27], s60 offen sc1
    v_mfma_f32_16x16x32_bf16 v[240:243], v[96:99], v[120:123], 0
    v_mfma_f32_16x16x32_bf16 a[8:11], v[100:103], v[120:123], 0
    v_mfma_f32_16x16x32_bf16 a[32:35], v[104:107], v[120:123], 0
    v_mfma_f32_16x16x32_bf16 a[56:59], v[108:111], v[120:123], 0
    buffer_load_dwordx4 v[220:223], v3, s[24:27], s60 offen sc1
    v_mfma_f32_16x16x32_bf16 v[244:247], v[96:99], v[124:127], 0
    v_mfma_f32_16x16x32_bf16 a[12:15], v[100:103], v[124:127], 0
    v_mfma_f32_16x16x32_bf16 a[36:39], v[104:107], v[124:127], 0
    v_mfma_f32_16x16x32_bf16 a[60:63], v[108:111], v[124:127], 0
    buffer_load_dwordx4 v[224:227], v4, s[24:27], s60 offen sc1
    v_mfma_f32_16x16x32_bf16 v[248:251], v[96:99], v[128:131], 0
    v_mfma_f32_16x16x32_bf16 a[16:19], v[100:103], v[128:131], 0
    v_mfma_f32_16x16x32_bf16 a[40:43], v[104:107], v[128:131], 0
    v_mfma_f32_16x16x32_bf16 a[64:67], v[108:111], v[128:131], 0
    buffer_load_dwordx4 v[228:231], v5, s[24:27], s60 offen sc1
    v_mfma_f32_16x16x32_bf16 v[252:255], v[96:99], v[132:135], 0
    v_mfma_f32_16x16x32_bf16 a[20:23], v[100:103], v[132:135], 0
    v_mfma_f32_16x16x32_bf16 a[44:47], v[104:107], v[132:135], 0
    v_mfma_f32_16x16x32_bf16 a[68:71], v[108:111], v[132:135], 0
    s_waitcnt vmcnt(18)
    ds_read_b64_tr_b16 v[96:97], v22 offset:16384
    ds_read_b64_tr_b16 v[98:99], v22 offset:18432
    v_mfma_f32_16x16x32_bf16 v[232:235], v[64:67], v[136:139], v[232:235]
    ds_read_b64_tr_b16 v[100:101], v23 offset:16384
    ds_read_b64_tr_b16 v[102:103], v23 offset:18432
    v_mfma_f32_16x16x32_bf16 a[0:3], v[68:71], v[136:139], a[0:3]
    ds_read_b64_tr_b16 v[104:105], v24 offset:16384
    ds_read_b64_tr_b16 v[106:107], v24 offset:18432
    v_mfma_f32_16x16x32_bf16 a[24:27], v[72:75], v[136:139], a[24:27]
    ds_read_b64_tr_b16 v[108:109], v25 offset:16384
    ds_read_b64_tr_b16 v[110:111], v25 offset:18432
    v_mfma_f32_16x16x32_bf16 a[48:51], v[76:79], v[136:139], a[48:51]
    s_add_u32 s60, s94, 5120
    s_and_b32 s60, s60, 32767
    v_mfma_f32_16x16x32_bf16 v[236:239], v[64:67], v[140:143], v[236:239]
    buffer_load_dwordx4 v[112:115], v0, s[24:27], s60 offen sc1
    v_mfma_f32_16x16x32_bf16 a[4:7], v[68:71], v[140:143], a[4:7]
    buffer_load_dwordx4 v[116:119], v1, s[24:27], s60 offen sc1
    v_mfma_f32_16x16x32_bf16 a[28:31], v[72:75], v[140:143], a[28:31]
    v_mfma_f32_16x16x32_bf16 a[52:55], v[76:79], v[140:143], a[52:55]
    buffer_load_dwordx4 v[120:123], v2, s[24:27], s60 offen sc1
    v_mfma_f32_16x16x32_bf16 v[240:243], v[64:67], v[144:147], v[240:243]
    v_mfma_f32_16x16x32_bf16 a[8:11], v[68:71], v[144:147], a[8:11]
    v_mfma_f32_16x16x32_bf16 a[32:35], v[72:75], v[144:147], a[32:35]
    v_mfma_f32_16x16x32_bf16 a[56:59], v[76:79], v[144:147], a[56:59]
    buffer_load_dwordx4 v[124:127], v3, s[24:27], s60 offen sc1
    v_mfma_f32_16x16x32_bf16 v[244:247], v[64:67], v[148:151], v[244:247]
    v_mfma_f32_16x16x32_bf16 a[12:15], v[68:71], v[148:151], a[12:15]
    v_mfma_f32_16x16x32_bf16 a[36:39], v[72:75], v[148:151], a[36:39]
    v_mfma_f32_16x16x32_bf16 a[60:63], v[76:79], v[148:151], a[60:63]
    buffer_load_dwordx4 v[128:131], v4, s[24:27], s60 offen sc1
    v_mfma_f32_16x16x32_bf16 v[248:251], v[64:67], v[152:155], v[248:251]
    v_mfma_f32_16x16x32_bf16 a[16:19], v[68:71], v[152:155], a[16:19]
    v_mfma_f32_16x16x32_bf16 a[40:43], v[72:75], v[152:155], a[40:43]
    v_mfma_f32_16x16x32_bf16 a[64:67], v[76:79], v[152:155], a[64:67]
    buffer_load_dwordx4 v[132:135], v5, s[24:27], s60 offen sc1
    v_mfma_f32_16x16x32_bf16 v[252:255], v[64:67], v[156:159], v[252:255]
    v_mfma_f32_16x16x32_bf16 a[20:23], v[68:71], v[156:159], a[20:23]
    v_mfma_f32_16x16x32_bf16 a[44:47], v[72:75], v[156:159], a[44:47]
    v_mfma_f32_16x16x32_bf16 a[68:71], v[76:79], v[156:159], a[68:71]
    s_waitcnt vmcnt(18)
    ds_read_b64_tr_b16 v[64:65], v18 offset:32768
    ds_read_b64_tr_b16 v[66:67], v18 offset:34816
    v_mfma_f32_16x16x32_bf16 v[232:235], v[80:83], v[160:163], v[232:235]
    ds_read_b64_tr_b16 v[68:69], v19 offset:32768
    ds_read_b64_tr_b16 v[70:71], v19 offset:34816
    v_mfma_f32_16x16x32_bf16 a[0:3], v[84:87], v[160:163], a[0:3]
    ds_read_b64_tr_b16 v[72:73], v20 offset:32768
    ds_read_b64_tr_b16 v[74:75], v20 offset:34816
    v_mfma_f32_16x16x32_bf16 a[24:27], v[88:91], v[160:163], a[24:27]
    ds_read_b64_tr_b16 v[76:77], v21 offset:32768
    ds_read_b64_tr_b16 v[78:79], v21 offset:34816
    v_mfma_f32_16x16x32_bf16 a[48:51], v[92:95], v[160:163], a[48:51]
    s_add_u32 s60, s94, 6144
    s_and_b32 s60, s60, 32767
    v_mfma_f32_16x16x32_bf16 v[236:239], v[80:83], v[164:167], v[236:239]
    buffer_load_dwordx4 v[136:139], v0, s[24:27], s60 offen sc1
    v_mfma_f32_16x16x32_bf16 a[4:7], v[84:87], v[164:167], a[4:7]
    buffer_load_dwordx4 v[140:143], v1, s[24:27], s60 offen sc1
    v_mfma_f32_16x16x32_bf16 a[28:31], v[88:91], v[164:167], a[28:31]
    v_mfma_f32_16x16x32_bf16 a[52:55], v[92:95], v[164:167], a[52:55]
    buffer_load_dwordx4 v[144:147], v2, s[24:27], s60 offen sc1
    v_mfma_f32_16x16x32_bf16 v[240:243], v[80:83], v[168:171], v[240:243]
    v_mfma_f32_16x16x32_bf16 a[8:11], v[84:87], v[168:171], a[8:11]
    v_mfma_f32_16x16x32_bf16 a[32:35], v[88:91], v[168:171], a[32:35]
    v_mfma_f32_16x16x32_bf16 a[56:59], v[92:95], v[168:171], a[56:59]
    buffer_load_dwordx4 v[148:151], v3, s[24:27], s60 offen sc1
    v_mfma_f32_16x16x32_bf16 v[244:247], v[80:83], v[172:175], v[244:247]
    v_mfma_f32_16x16x32_bf16 a[12:15], v[84:87], v[172:175], a[12:15]
    v_mfma_f32_16x16x32_bf16 a[36:39], v[88:91], v[172:175], a[36:39]
    v_mfma_f32_16x16x32_bf16 a[60:63], v[92:95], v[172:175], a[60:63]
    buffer_load_dwordx4 v[152:155], v4, s[24:27], s60 offen sc1
    v_mfma_f32_16x16x32_bf16 v[248:251], v[80:83], v[176:179], v[248:251]
    v_mfma_f32_16x16x32_bf16 a[16:19], v[84:87], v[176:179], a[16:19]
    v_mfma_f32_16x16x32_bf16 a[40:43], v[88:91], v[176:179], a[40:43]
    v_mfma_f32_16x16x32_bf16 a[64:67], v[92:95], v[176:179], a[64:67]
    buffer_load_dwordx4 v[156:159], v5, s[24:27], s60 offen sc1
    v_mfma_f32_16x16x32_bf16 v[252:255], v[80:83], v[180:183], v[252:255]
    v_mfma_f32_16x16x32_bf16 a[20:23], v[84:87], v[180:183], a[20:23]
    v_mfma_f32_16x16x32_bf16 a[44:47], v[88:91], v[180:183], a[44:47]
    v_mfma_f32_16x16x32_bf16 a[68:71], v[92:95], v[180:183], a[68:71]
    s_waitcnt vmcnt(18)
    ds_read_b64_tr_b16 v[80:81], v14 offset:0
    ds_read_b64_tr_b16 v[82:83], v14 offset:2048
    v_mfma_f32_16x16x32_bf16 v[232:235], a[192:195], v[184:187], v[232:235]
    ds_read_b64_tr_b16 v[84:85], v15 offset:0
    ds_read_b64_tr_b16 v[86:87], v15 offset:2048
    v_mfma_f32_16x16x32_bf16 a[0:3], a[196:199], v[184:187], a[0:3]
    ds_read_b64_tr_b16 v[88:89], v16 offset:0
    ds_read_b64_tr_b16 v[90:91], v16 offset:2048
    v_mfma_f32_16x16x32_bf16 a[24:27], a[200:203], v[184:187], a[24:27]
    ds_read_b64_tr_b16 v[92:93], v17 offset:0
    ds_read_b64_tr_b16 v[94:95], v17 offset:2048
    v_mfma_f32_16x16x32_bf16 a[48:51], a[204:207], v[184:187], a[48:51]
    s_add_u32 s60, s94, 7168
    s_and_b32 s60, s60, 32767
    s_add_u32 s63, s94, 26624
    v_mfma_f32_16x16x32_bf16 v[236:239], a[192:195], v[188:191], v[236:239]
    buffer_load_dwordx4 v[160:163], v0, s[24:27], s60 offen sc1
    v_mfma_f32_16x16x32_bf16 a[4:7], a[196:199], v[188:191], a[4:7]
    buffer_load_dwordx4 v[164:167], v1, s[24:27], s60 offen sc1
    v_mfma_f32_16x16x32_bf16 a[28:31], a[200:203], v[188:191], a[28:31]
    s_and_b32 s63, s63, 32767
    s_add_u32 m0, s81, 147456
    s_mul_i32 s63, s63, 36
    v_mfma_f32_16x16x32_bf16 a[52:55], a[204:207], v[188:191], a[52:55]
    s_waitcnt lgkmcnt(0)
    buffer_load_dwordx4 v6, s[20:23], s63 offen offset:0 lds
    v_mfma_f32_16x16x32_bf16 v[240:243], a[192:195], v[192:195], v[240:243]
    buffer_load_dwordx4 v[168:171], v2, s[24:27], s60 offen sc1
    v_mfma_f32_16x16x32_bf16 a[8:11], a[196:199], v[192:195], a[8:11]
    buffer_load_dwordx4 v7, s[20:23], s63 offen offset:1024 lds
    v_mfma_f32_16x16x32_bf16 a[32:35], a[200:203], v[192:195], a[32:35]
    v_mfma_f32_16x16x32_bf16 a[56:59], a[204:207], v[192:195], a[56:59]
    buffer_load_dwordx4 v[172:175], v3, s[24:27], s60 offen sc1
    v_mfma_f32_16x16x32_bf16 v[244:247], a[192:195], v[196:199], v[244:247]
    v_mfma_f32_16x16x32_bf16 a[12:15], a[196:199], v[196:199], a[12:15]
    buffer_load_dwordx4 v8, s[20:23], s63 offen offset:2048 lds
    v_mfma_f32_16x16x32_bf16 a[36:39], a[200:203], v[196:199], a[36:39]
    v_mfma_f32_16x16x32_bf16 a[60:63], a[204:207], v[196:199], a[60:63]
    v_mfma_f32_16x16x32_bf16 v[248:251], a[192:195], v[200:203], v[248:251]
    buffer_load_dwordx4 v[176:179], v4, s[24:27], s60 offen sc1
    v_mfma_f32_16x16x32_bf16 a[16:19], a[196:199], v[200:203], a[16:19]
    v_mfma_f32_16x16x32_bf16 a[40:43], a[200:203], v[200:203], a[40:43]
    buffer_load_dwordx4 v9, s[20:23], s63 offen offset:3072 lds
    v_mfma_f32_16x16x32_bf16 a[64:67], a[204:207], v[200:203], a[64:67]
    v_mfma_f32_16x16x32_bf16 v[252:255], a[192:195], v[204:207], v[252:255]
    buffer_load_dwordx4 v[180:183], v5, s[24:27], s60 offen sc1
    v_mfma_f32_16x16x32_bf16 a[20:23], a[196:199], v[204:207], a[20:23]
    v_mfma_f32_16x16x32_bf16 a[44:47], a[200:203], v[204:207], a[44:47]
    v_mfma_f32_16x16x32_bf16 a[68:71], a[204:207], v[204:207], a[68:71]
    s_waitcnt vmcnt(22)
    ds_read_b64_tr_b16 a[192:193], v18 offset:0
    ds_read_b64_tr_b16 a[194:195], v18 offset:2048
    v_mfma_f32_16x16x32_bf16 v[232:235], a[208:211], v[208:211], v[232:235]
    ds_read_b64_tr_b16 a[196:197], v19 offset:0
    ds_read_b64_tr_b16 a[198:199], v19 offset:2048
    v_mfma_f32_16x16x32_bf16 a[0:3], a[212:215], v[208:211], a[0:3]
    ds_read_b64_tr_b16 a[200:201], v20 offset:0
    ds_read_b64_tr_b16 a[202:203], v20 offset:2048
    v_mfma_f32_16x16x32_bf16 a[24:27], a[216:219], v[208:211], a[24:27]
    ds_read_b64_tr_b16 a[204:205], v21 offset:0
    ds_read_b64_tr_b16 a[206:207], v21 offset:2048
    v_mfma_f32_16x16x32_bf16 a[48:51], a[220:223], v[208:211], a[48:51]
    s_add_u32 s60, s94, 8192
    s_and_b32 s60, s60, 32767
    v_mfma_f32_16x16x32_bf16 v[236:239], a[208:211], v[212:215], v[236:239]
    buffer_load_dwordx4 v[184:187], v0, s[24:27], s60 offen sc1
    v_mfma_f32_16x16x32_bf16 a[4:7], a[212:215], v[212:215], a[4:7]
    buffer_load_dwordx4 v[188:191], v1, s[24:27], s60 offen sc1
    v_mfma_f32_16x16x32_bf16 a[28:31], a[216:219], v[212:215], a[28:31]
    v_mfma_f32_16x16x32_bf16 a[52:55], a[220:223], v[212:215], a[52:55]
    buffer_load_dwordx4 v[192:195], v2, s[24:27], s60 offen sc1
    v_mfma_f32_16x16x32_bf16 v[240:243], a[208:211], v[216:219], v[240:243]
    v_mfma_f32_16x16x32_bf16 a[8:11], a[212:215], v[216:219], a[8:11]
    v_mfma_f32_16x16x32_bf16 a[32:35], a[216:219], v[216:219], a[32:35]
    v_mfma_f32_16x16x32_bf16 a[56:59], a[220:223], v[216:219], a[56:59]
    buffer_load_dwordx4 v[196:199], v3, s[24:27], s60 offen sc1
    v_mfma_f32_16x16x32_bf16 v[244:247], a[208:211], v[220:223], v[244:247]
    v_mfma_f32_16x16x32_bf16 a[12:15], a[212:215], v[220:223], a[12:15]
    v_mfma_f32_16x16x32_bf16 a[36:39], a[216:219], v[220:223], a[36:39]
    v_mfma_f32_16x16x32_bf16 a[60:63], a[220:223], v[220:223], a[60:63]
    buffer_load_dwordx4 v[200:203], v4, s[24:27], s60 offen sc1
    v_mfma_f32_16x16x32_bf16 v[248:251], a[208:211], v[224:227], v[248:251]
    v_mfma_f32_16x16x32_bf16 a[16:19], a[212:215], v[224:227], a[16:19]
    v_mfma_f32_16x16x32_bf16 a[40:43], a[216:219], v[224:227], a[40:43]
    v_mfma_f32_16x16x32_bf16 a[64:67], a[220:223], v[224:227], a[64:67]
    buffer_load_dwordx4 v[204:207], v5, s[24:27], s60 offen sc1
    v_mfma_f32_16x16x32_bf16 v[252:255], a[208:211], v[228:231], v[252:255]
    v_mfma_f32_16x16x32_bf16 a[20:23], a[212:215], v[228:231], a[20:23]
    v_mfma_f32_16x16x32_bf16 a[44:47], a[216:219], v[228:231], a[44:47]
    v_mfma_f32_16x16x32_bf16 a[68:71], a[220:223], v[228:231], a[68:71]
    s_waitcnt vmcnt(22)
    ds_read_b64_tr_b16 a[208:209], v14 offset:16384
    ds_read_b64_tr_b16 a[210:211], v14 offset:18432
    v_mfma_f32_16x16x32_bf16 v[232:235], a[128:131], v[112:115], v[232:235]
    ds_read_b64_tr_b16 a[212:213], v15 offset:16384
    ds_read_b64_tr_b16 a[214:215], v15 offset:18432
    v_mfma_f32_16x16x32_bf16 a[0:3], a[132:135], v[112:115], a[0:3]
    ds_read_b64_tr_b16 a[216:217], v16 offset:16384
    ds_read_b64_tr_b16 a[218:219], v16 offset:18432
    v_mfma_f32_16x16x32_bf16 a[24:27], a[136:139], v[112:115], a[24:27]
    ds_read_b64_tr_b16 a[220:221], v17 offset:16384
    ds_read_b64_tr_b16 a[222:223], v17 offset:18432
    v_mfma_f32_16x16x32_bf16 a[48:51], a[140:143], v[112:115], a[48:51]
    s_add_u32 s60, s94, 9216
    s_and_b32 s60, s60, 32767
    s_add_u32 s63, s94, 27648
    v_mfma_f32_16x16x32_bf16 v[236:239], a[128:131], v[116:119], v[236:239]
    buffer_load_dwordx4 v[208:211], v0, s[24:27], s60 offen sc1
    v_mfma_f32_16x16x32_bf16 a[4:7], a[132:135], v[116:119], a[4:7]
    buffer_load_dwordx4 v[212:215], v1, s[24:27], s60 offen sc1
    v_mfma_f32_16x16x32_bf16 a[28:31], a[136:139], v[116:119], a[28:31]
    s_and_b32 s63, s63, 32767
    s_add_u32 m0, s81, 98304
    s_mul_i32 s63, s63, 36
    v_mfma_f32_16x16x32_bf16 a[52:55], a[140:143], v[116:119], a[52:55]
    buffer_load_dwordx4 v6, s[20:23], s63 offen offset:0 lds
    v_mfma_f32_16x16x32_bf16 v[240:243], a[128:131], v[120:123], v[240:243]
    buffer_load_dwordx4 v[216:219], v2, s[24:27], s60 offen sc1
    v_mfma_f32_16x16x32_bf16 a[8:11], a[132:135], v[120:123], a[8:11]
    buffer_load_dwordx4 v7, s[20:23], s63 offen offset:1024 lds
    v_mfma_f32_16x16x32_bf16 a[32:35], a[136:139], v[120:123], a[32:35]
    v_mfma_f32_16x16x32_bf16 a[56:59], a[140:143], v[120:123], a[56:59]
    buffer_load_dwordx4 v[220:223], v3, s[24:27], s60 offen sc1
    v_mfma_f32_16x16x32_bf16 v[244:247], a[128:131], v[124:127], v[244:247]
    v_mfma_f32_16x16x32_bf16 a[12:15], a[132:135], v[124:127], a[12:15]
    buffer_load_dwordx4 v8, s[20:23], s63 offen offset:2048 lds
    v_mfma_f32_16x16x32_bf16 a[36:39], a[136:139], v[124:127], a[36:39]
    v_mfma_f32_16x16x32_bf16 a[60:63], a[140:143], v[124:127], a[60:63]
    v_mfma_f32_16x16x32_bf16 v[248:251], a[128:131], v[128:131], v[248:251]
    buffer_load_dwordx4 v[224:227], v4, s[24:27], s60 offen sc1
    v_mfma_f32_16x16x32_bf16 a[16:19], a[132:135], v[128:131], a[16:19]
    v_mfma_f32_16x16x32_bf16 a[40:43], a[136:139], v[128:131], a[40:43]
    buffer_load_dwordx4 v9, s[20:23], s63 offen offset:3072 lds
    v_mfma_f32_16x16x32_bf16 a[64:67], a[140:143], v[128:131], a[64:67]
    v_mfma_f32_16x16x32_bf16 v[252:255], a[128:131], v[132:135], v[252:255]
    buffer_load_dwordx4 v[228:231], v5, s[24:27], s60 offen sc1
    v_mfma_f32_16x16x32_bf16 a[20:23], a[132:135], v[132:135], a[20:23]
    v_mfma_f32_16x16x32_bf16 a[44:47], a[136:139], v[132:135], a[44:47]
    v_mfma_f32_16x16x32_bf16 a[68:71], a[140:143], v[132:135], a[68:71]
    s_waitcnt vmcnt(26)
    ds_read_b64_tr_b16 a[128:129], v18 offset:16384
    ds_read_b64_tr_b16 a[130:131], v18 offset:18432
    v_mfma_f32_16x16x32_bf16 v[232:235], a[144:147], v[136:139], v[232:235]
    ds_read_b64_tr_b16 a[132:133], v19 offset:16384
    ds_read_b64_tr_b16 a[134:135], v19 offset:18432
    v_mfma_f32_16x16x32_bf16 a[0:3], a[148:151], v[136:139], a[0:3]
    ds_read_b64_tr_b16 a[136:137], v20 offset:16384
    ds_read_b64_tr_b16 a[138:139], v20 offset:18432
    v_mfma_f32_16x16x32_bf16 a[24:27], a[152:155], v[136:139], a[24:27]
    ds_read_b64_tr_b16 a[140:141], v21 offset:16384
    ds_read_b64_tr_b16 a[142:143], v21 offset:18432
    v_mfma_f32_16x16x32_bf16 a[48:51], a[156:159], v[136:139], a[48:51]
    s_add_u32 s60, s94, 10240
    s_and_b32 s60, s60, 32767
    v_mfma_f32_16x16x32_bf16 v[236:239], a[144:147], v[140:143], v[236:239]
    buffer_load_dwordx4 v[112:115], v0, s[24:27], s60 offen sc1
    v_mfma_f32_16x16x32_bf16 a[4:7], a[148:151], v[140:143], a[4:7]
    buffer_load_dwordx4 v[116:119], v1, s[24:27], s60 offen sc1
    v_mfma_f32_16x16x32_bf16 a[28:31], a[152:155], v[140:143], a[28:31]
    v_mfma_f32_16x16x32_bf16 a[52:55], a[156:159], v[140:143], a[52:55]
    buffer_load_dwordx4 v[120:123], v2, s[24:27], s60 offen sc1
    v_mfma_f32_16x16x32_bf16 v[240:243], a[144:147], v[144:147], v[240:243]
    v_mfma_f32_16x16x32_bf16 a[8:11], a[148:151], v[144:147], a[8:11]
    v_mfma_f32_16x16x32_bf16 a[32:35], a[152:155], v[144:147], a[32:35]
    v_mfma_f32_16x16x32_bf16 a[56:59], a[156:159], v[144:147], a[56:59]
    buffer_load_dwordx4 v[124:127], v3, s[24:27], s60 offen sc1
    v_mfma_f32_16x16x32_bf16 v[244:247], a[144:147], v[148:151], v[244:247]
    v_mfma_f32_16x16x32_bf16 a[12:15], a[148:151], v[148:151], a[12:15]
    v_mfma_f32_16x16x32_bf16 a[36:39], a[152:155], v[148:151], a[36:39]
    v_mfma_f32_16x16x32_bf16 a[60:63], a[156:159], v[148:151], a[60:63]
    buffer_load_dwordx4 v[128:131], v4, s[24:27], s60 offen sc1
    v_mfma_f32_16x16x32_bf16 v[248:251], a[144:147], v[152:155], v[248:251]
    v_mfma_f32_16x16x32_bf16 a[16:19], a[148:151], v[152:155], a[16:19]
    v_mfma_f32_16x16x32_bf16 a[40:43], a[152:155], v[152:155], a[40:43]
    v_mfma_f32_16x16x32_bf16 a[64:67], a[156:159], v[152:155], a[64:67]
    buffer_load_dwordx4 v[132:135], v5, s[24:27], s60 offen sc1
    v_mfma_f32_16x16x32_bf16 v[252:255], a[144:147], v[156:159], v[252:255]
    v_mfma_f32_16x16x32_bf16 a[20:23], a[148:151], v[156:159], a[20:23]
    v_mfma_f32_16x16x32_bf16 a[44:47], a[152:155], v[156:159], a[44:47]
    v_mfma_f32_16x16x32_bf16 a[68:71], a[156:159], v[156:159], a[68:71]
    s_waitcnt vmcnt(22)
    ds_read_b64_tr_b16 a[144:145], v14 offset:32768
    ds_read_b64_tr_b16 a[146:147], v14 offset:34816
    v_mfma_f32_16x16x32_bf16 v[232:235], a[160:163], v[160:163], v[232:235]
    ds_read_b64_tr_b16 a[148:149], v15 offset:32768
    ds_read_b64_tr_b16 a[150:151], v15 offset:34816
    v_mfma_f32_16x16x32_bf16 a[0:3], a[164:167], v[160:163], a[0:3]
    ds_read_b64_tr_b16 a[152:153], v16 offset:32768
    ds_read_b64_tr_b16 a[154:155], v16 offset:34816
    v_mfma_f32_16x16x32_bf16 a[24:27], a[168:171], v[160:163], a[24:27]
    ds_read_b64_tr_b16 a[156:157], v17 offset:32768
    ds_read_b64_tr_b16 a[158:159], v17 offset:34816
    v_mfma_f32_16x16x32_bf16 a[48:51], a[172:175], v[160:163], a[48:51]
    s_add_u32 s60, s94, 11264
    s_and_b32 s60, s60, 32767
    s_add_u32 s63, s94, 28672
    v_mfma_f32_16x16x32_bf16 v[236:239], a[160:163], v[164:167], v[236:239]
    buffer_load_dwordx4 v[136:139], v0, s[24:27], s60 offen sc1
    v_mfma_f32_16x16x32_bf16 a[4:7], a[164:167], v[164:167], a[4:7]
    buffer_load_dwordx4 v[140:143], v1, s[24:27], s60 offen sc1
    v_mfma_f32_16x16x32_bf16 a[28:31], a[168:171], v[164:167], a[28:31]
    s_and_b32 s63, s63, 32767
    s_add_u32 m0, s81, 0
    s_mul_i32 s63, s63, 36
    v_mfma_f32_16x16x32_bf16 a[52:55], a[172:175], v[164:167], a[52:55]
    buffer_load_dwordx4 v6, s[20:23], s63 offen offset:0 lds
    v_mfma_f32_16x16x32_bf16 v[240:243], a[160:163], v[168:171], v[240:243]
    buffer_load_dwordx4 v[144:147], v2, s[24:27], s60 offen sc1
    v_mfma_f32_16x16x32_bf16 a[8:11], a[164:167], v[168:171], a[8:11]
    buffer_load_dwordx4 v7, s[20:23], s63 offen offset:1024 lds
    v_mfma_f32_16x16x32_bf16 a[32:35], a[168:171], v[168:171], a[32:35]
    v_mfma_f32_16x16x32_bf16 a[56:59], a[172:175], v[168:171], a[56:59]
    buffer_load_dwordx4 v[148:151], v3, s[24:27], s60 offen sc1
    v_mfma_f32_16x16x32_bf16 v[244:247], a[160:163], v[172:175], v[244:247]
    v_mfma_f32_16x16x32_bf16 a[12:15], a[164:167], v[172:175], a[12:15]
    buffer_load_dwordx4 v8, s[20:23], s63 offen offset:2048 lds
    v_mfma_f32_16x16x32_bf16 a[36:39], a[168:171], v[172:175], a[36:39]
    v_mfma_f32_16x16x32_bf16 a[60:63], a[172:175], v[172:175], a[60:63]
    v_mfma_f32_16x16x32_bf16 v[248:251], a[160:163], v[176:179], v[248:251]
    buffer_load_dwordx4 v[152:155], v4, s[24:27], s60 offen sc1
    v_mfma_f32_16x16x32_bf16 a[16:19], a[164:167], v[176:179], a[16:19]
    v_mfma_f32_16x16x32_bf16 a[40:43], a[168:171], v[176:179], a[40:43]
    buffer_load_dwordx4 v9, s[20:23], s63 offen offset:3072 lds
    v_mfma_f32_16x16x32_bf16 a[64:67], a[172:175], v[176:179], a[64:67]
    v_mfma_f32_16x16x32_bf16 v[252:255], a[160:163], v[180:183], v[252:255]
    buffer_load_dwordx4 v[156:159], v5, s[24:27], s60 offen sc1
    v_mfma_f32_16x16x32_bf16 a[20:23], a[164:167], v[180:183], a[20:23]
    v_mfma_f32_16x16x32_bf16 a[44:47], a[168:171], v[180:183], a[44:47]
    v_mfma_f32_16x16x32_bf16 a[68:71], a[172:175], v[180:183], a[68:71]
    s_waitcnt vmcnt(26)
    ds_read_b64_tr_b16 a[160:161], v14 offset:49152
    ds_read_b64_tr_b16 a[162:163], v14 offset:51200
    v_mfma_f32_16x16x32_bf16 v[232:235], a[176:179], v[184:187], v[232:235]
    ds_read_b64_tr_b16 a[164:165], v15 offset:49152
    ds_read_b64_tr_b16 a[166:167], v15 offset:51200
    v_mfma_f32_16x16x32_bf16 a[0:3], a[180:183], v[184:187], a[0:3]
    ds_read_b64_tr_b16 a[168:169], v16 offset:49152
    ds_read_b64_tr_b16 a[170:171], v16 offset:51200
    v_mfma_f32_16x16x32_bf16 a[24:27], a[184:187], v[184:187], a[24:27]
    ds_read_b64_tr_b16 a[172:173], v17 offset:49152
    ds_read_b64_tr_b16 a[174:175], v17 offset:51200
    v_mfma_f32_16x16x32_bf16 a[48:51], a[188:191], v[184:187], a[48:51]
    s_add_u32 s60, s94, 12288
    s_and_b32 s60, s60, 32767
    v_mfma_f32_16x16x32_bf16 v[236:239], a[176:179], v[188:191], v[236:239]
    buffer_load_dwordx4 v[160:163], v0, s[24:27], s60 offen sc1
    v_mfma_f32_16x16x32_bf16 a[4:7], a[180:183], v[188:191], a[4:7]
    buffer_load_dwordx4 v[164:167], v1, s[24:27], s60 offen sc1
    v_mfma_f32_16x16x32_bf16 a[28:31], a[184:187], v[188:191], a[28:31]
    v_mfma_f32_16x16x32_bf16 a[52:55], a[188:191], v[188:191], a[52:55]
    buffer_load_dwordx4 v[168:171], v2, s[24:27], s60 offen sc1
    v_mfma_f32_16x16x32_bf16 v[240:243], a[176:179], v[192:195], v[240:243]
    v_mfma_f32_16x16x32_bf16 a[8:11], a[180:183], v[192:195], a[8:11]
    v_mfma_f32_16x16x32_bf16 a[32:35], a[184:187], v[192:195], a[32:35]
    v_mfma_f32_16x16x32_bf16 a[56:59], a[188:191], v[192:195], a[56:59]
    buffer_load_dwordx4 v[172:175], v3, s[24:27], s60 offen sc1
    v_mfma_f32_16x16x32_bf16 v[244:247], a[176:179], v[196:199], v[244:247]
    v_mfma_f32_16x16x32_bf16 a[12:15], a[180:183], v[196:199], a[12:15]
    v_mfma_f32_16x16x32_bf16 a[36:39], a[184:187], v[196:199], a[36:39]
    v_mfma_f32_16x16x32_bf16 a[60:63], a[188:191], v[196:199], a[60:63]
    buffer_load_dwordx4 v[176:179], v4, s[24:27], s60 offen sc1
    v_mfma_f32_16x16x32_bf16 v[248:251], a[176:179], v[200:203], v[248:251]
    v_mfma_f32_16x16x32_bf16 a[16:19], a[180:183], v[200:203], a[16:19]
    v_mfma_f32_16x16x32_bf16 a[40:43], a[184:187], v[200:203], a[40:43]
    v_mfma_f32_16x16x32_bf16 a[64:67], a[188:191], v[200:203], a[64:67]
    buffer_load_dwordx4 v[180:183], v5, s[24:27], s60 offen sc1
    v_mfma_f32_16x16x32_bf16 v[252:255], a[176:179], v[204:207], v[252:255]
    v_mfma_f32_16x16x32_bf16 a[20:23], a[180:183], v[204:207], a[20:23]
    v_mfma_f32_16x16x32_bf16 a[44:47], a[184:187], v[204:207], a[44:47]
    v_mfma_f32_16x16x32_bf16 a[68:71], a[188:191], v[204:207], a[68:71]
    s_waitcnt vmcnt(22)
    ds_read_b64_tr_b16 a[176:177], v18 offset:49152
    ds_read_b64_tr_b16 a[178:179], v18 offset:51200
    v_mfma_f32_16x16x32_bf16 v[232:235], v[32:35], v[208:211], v[232:235]
    ds_read_b64_tr_b16 a[180:181], v19 offset:49152
    ds_read_b64_tr_b16 a[182:183], v19 offset:51200
    v_mfma_f32_16x16x32_bf16 a[0:3], v[36:39], v[208:211], a[0:3]
    ds_read_b64_tr_b16 a[184:185], v20 offset:49152
    ds_read_b64_tr_b16 a[186:187], v20 offset:51200
    v_mfma_f32_16x16x32_bf16 a[24:27], v[40:43], v[208:211], a[24:27]
    ds_read_b64_tr_b16 a[188:189], v21 offset:49152
    ds_read_b64_tr_b16 a[190:191], v21 offset:51200
    v_mfma_f32_16x16x32_bf16 a[48:51], v[44:47], v[208:211], a[48:51]
    s_add_u32 s60, s94, 13312
    s_and_b32 s60, s60, 32767
    s_add_u32 s63, s94, 29696
    v_mfma_f32_16x16x32_bf16 v[236:239], v[32:35], v[212:215], v[236:239]
    buffer_load_dwordx4 v[184:187], v0, s[24:27], s60 offen sc1
    v_mfma_f32_16x16x32_bf16 a[4:7], v[36:39], v[212:215], a[4:7]
    buffer_load_dwordx4 v[188:191], v1, s[24:27], s60 offen sc1
    v_mfma_f32_16x16x32_bf16 a[28:31], v[40:43], v[212:215], a[28:31]
    s_and_b32 s63, s63, 32767
    s_add_u32 m0, s81, 65536
    s_mul_i32 s63, s63, 36
    v_mfma_f32_16x16x32_bf16 a[52:55], v[44:47], v[212:215], a[52:55]
    s_waitcnt lgkmcnt(0)
    buffer_load_dwordx4 v6, s[20:23], s63 offen offset:0 lds
    v_mfma_f32_16x16x32_bf16 v[240:243], v[32:35], v[216:219], v[240:243]
    buffer_load_dwordx4 v[192:195], v2, s[24:27], s60 offen sc1
    v_mfma_f32_16x16x32_bf16 a[8:11], v[36:39], v[216:219], a[8:11]
    buffer_load_dwordx4 v7, s[20:23], s63 offen offset:1024 lds
    v_mfma_f32_16x16x32_bf16 a[32:35], v[40:43], v[216:219], a[32:35]
    v_mfma_f32_16x16x32_bf16 a[56:59], v[44:47], v[216:219], a[56:59]
    buffer_load_dwordx4 v[196:199], v3, s[24:27], s60 offen sc1
    v_mfma_f32_16x16x32_bf16 v[244:247], v[32:35], v[220:223], v[244:247]
    v_mfma_f32_16x16x32_bf16 a[12:15], v[36:39], v[220:223], a[12:15]
    buffer_load_dwordx4 v8, s[20:23], s63 offen offset:2048 lds
    v_mfma_f32_16x16x32_bf16 a[36:39], v[40:43], v[220:223], a[36:39]
    v_mfma_f32_16x16x32_bf16 a[60:63], v[44:47], v[220:223], a[60:63]
    v_mfma_f32_16x16x32_bf16 v[248:251], v[32:35], v[224:227], v[248:251]
    buffer_load_dwordx4 v[200:203], v4, s[24:27], s60 offen sc1
    v_mfma_f32_16x16x32_bf16 a[16:19], v[36:39], v[224:227], a[16:19]
    v_mfma_f32_16x16x32_bf16 a[40:43], v[40:43], v[224:227], a[40:43]
    buffer_load_dwordx4 v9, s[20:23], s63 offen offset:3072 lds
    v_mfma_f32_16x16x32_bf16 a[64:67], v[44:47], v[224:227], a[64:67]
    v_mfma_f32_16x16x32_bf16 v[252:255], v[32:35], v[228:231], v[252:255]
    buffer_load_dwordx4 v[204:207], v5, s[24:27], s60 offen sc1
    v_mfma_f32_16x16x32_bf16 a[20:23], v[36:39], v[228:231], a[20:23]
    v_mfma_f32_16x16x32_bf16 a[44:47], v[40:43], v[228:231], a[44:47]
    v_mfma_f32_16x16x32_bf16 a[68:71], v[44:47], v[228:231], a[68:71]
    s_waitcnt vmcnt(26)
    ds_read_b64_tr_b16 v[32:33], v22 offset:0
    ds_read_b64_tr_b16 v[34:35], v22 offset:2048
    v_mfma_f32_16x16x32_bf16 v[232:235], v[48:51], v[112:115], v[232:235]
    ds_read_b64_tr_b16 v[36:37], v23 offset:0
    ds_read_b64_tr_b16 v[38:39], v23 offset:2048
    v_mfma_f32_16x16x32_bf16 a[0:3], v[52:55], v[112:115], a[0:3]
    ds_read_b64_tr_b16 v[40:41], v24 offset:0
    ds_read_b64_tr_b16 v[42:43], v24 offset:2048
    v_mfma_f32_16x16x32_bf16 a[24:27], v[56:59], v[112:115], a[24:27]
    ds_read_b64_tr_b16 v[44:45], v25 offset:0
    ds_read_b64_tr_b16 v[46:47], v25 offset:2048
    v_mfma_f32_16x16x32_bf16 a[48:51], v[60:63], v[112:115], a[48:51]
    s_add_u32 s60, s94, 14336
    s_and_b32 s60, s60, 32767
    v_mfma_f32_16x16x32_bf16 v[236:239], v[48:51], v[116:119], v[236:239]
    buffer_load_dwordx4 v[208:211], v0, s[24:27], s60 offen sc1
    v_mfma_f32_16x16x32_bf16 a[4:7], v[52:55], v[116:119], a[4:7]
    buffer_load_dwordx4 v[212:215], v1, s[24:27], s60 offen sc1
    v_mfma_f32_16x16x32_bf16 a[28:31], v[56:59], v[116:119], a[28:31]
    v_mfma_f32_16x16x32_bf16 a[52:55], v[60:63], v[116:119], a[52:55]
    buffer_load_dwordx4 v[216:219], v2, s[24:27], s60 offen sc1
    v_mfma_f32_16x16x32_bf16 v[240:243], v[48:51], v[120:123], v[240:243]
    v_mfma_f32_16x16x32_bf16 a[8:11], v[52:55], v[120:123], a[8:11]
    v_mfma_f32_16x16x32_bf16 a[32:35], v[56:59], v[120:123], a[32:35]
    v_mfma_f32_16x16x32_bf16 a[56:59], v[60:63], v[120:123], a[56:59]
    buffer_load_dwordx4 v[220:223], v3, s[24:27], s60 offen sc1
    v_mfma_f32_16x16x32_bf16 v[244:247], v[48:51], v[124:127], v[244:247]
    v_mfma_f32_16x16x32_bf16 a[12:15], v[52:55], v[124:127], a[12:15]
    v_mfma_f32_16x16x32_bf16 a[36:39], v[56:59], v[124:127], a[36:39]
    v_mfma_f32_16x16x32_bf16 a[60:63], v[60:63], v[124:127], a[60:63]
    buffer_load_dwordx4 v[224:227], v4, s[24:27], s60 offen sc1
    v_mfma_f32_16x16x32_bf16 v[248:251], v[48:51], v[128:131], v[248:251]
    v_mfma_f32_16x16x32_bf16 a[16:19], v[52:55], v[128:131], a[16:19]
    v_mfma_f32_16x16x32_bf16 a[40:43], v[56:59], v[128:131], a[40:43]
    v_mfma_f32_16x16x32_bf16 a[64:67], v[60:63], v[128:131], a[64:67]
    buffer_load_dwordx4 v[228:231], v5, s[24:27], s60 offen sc1
    v_mfma_f32_16x16x32_bf16 v[252:255], v[48:51], v[132:135], v[252:255]
    v_mfma_f32_16x16x32_bf16 a[20:23], v[52:55], v[132:135], a[20:23]
    v_mfma_f32_16x16x32_bf16 a[44:47], v[56:59], v[132:135], a[44:47]
    v_mfma_f32_16x16x32_bf16 a[68:71], v[60:63], v[132:135], a[68:71]
    s_waitcnt vmcnt(22)
    s_add_u32 s60, s94, 15360
    s_and_b32 s60, s60, 32767
    v_mfma_f32_16x16x32_bf16 v[232:235], a[224:227], v[136:139], v[232:235]
    buffer_load_dwordx4 v[112:115], v0, s[24:27], s60 offen sc1
    v_mfma_f32_16x16x32_bf16 a[0:3], a[228:231], v[136:139], a[0:3]
    v_mfma_f32_16x16x32_bf16 a[24:27], a[232:235], v[136:139], a[24:27]
    buffer_load_dwordx4 v[116:119], v1, s[24:27], s60 offen sc1
    v_mfma_f32_16x16x32_bf16 a[48:51], a[236:239], v[136:139], a[48:51]
    s_add_u32 s63, s94, 30720
    s_and_b32 s63, s63, 32767
    s_add_u32 m0, s81, 16384
    v_mfma_f32_16x16x32_bf16 v[236:239], a[224:227], v[140:143], v[236:239]
    s_mul_i32 s63, s63, 36
    buffer_load_dwordx4 v6, s[20:23], s63 offen offset:0 lds
    v_mfma_f32_16x16x32_bf16 a[4:7], a[228:231], v[140:143], a[4:7]
    v_mfma_f32_16x16x32_bf16 a[28:31], a[232:235], v[140:143], a[28:31]
    buffer_load_dwordx4 v[120:123], v2, s[24:27], s60 offen sc1
    v_mfma_f32_16x16x32_bf16 a[52:55], a[236:239], v[140:143], a[52:55]
    v_mfma_f32_16x16x32_bf16 v[240:243], a[224:227], v[144:147], v[240:243]
    v_mfma_f32_16x16x32_bf16 a[8:11], a[228:231], v[144:147], a[8:11]
    buffer_load_dwordx4 v7, s[20:23], s63 offen offset:1024 lds
    v_mfma_f32_16x16x32_bf16 a[32:35], a[232:235], v[144:147], a[32:35]
    v_mfma_f32_16x16x32_bf16 a[56:59], a[236:239], v[144:147], a[56:59]
    buffer_load_dwordx4 v[124:127], v3, s[24:27], s60 offen sc1
    v_mfma_f32_16x16x32_bf16 v[244:247], a[224:227], v[148:151], v[244:247]
    v_mfma_f32_16x16x32_bf16 a[12:15], a[228:231], v[148:151], a[12:15]
    buffer_load_dwordx4 v8, s[20:23], s63 offen offset:2048 lds
    v_mfma_f32_16x16x32_bf16 a[36:39], a[232:235], v[148:151], a[36:39]
    v_mfma_f32_16x16x32_bf16 a[60:63], a[236:239], v[148:151], a[60:63]
    v_mfma_f32_16x16x32_bf16 v[248:251], a[224:227], v[152:155], v[248:251]
    buffer_load_dwordx4 v[128:131], v4, s[24:27], s60 offen sc1
    v_mfma_f32_16x16x32_bf16 a[16:19], a[228:231], v[152:155], a[16:19]
    v_mfma_f32_16x16x32_bf16 a[40:43], a[232:235], v[152:155], a[40:43]
    buffer_load_dwordx4 v9, s[20:23], s63 offen offset:3072 lds
    v_mfma_f32_16x16x32_bf16 a[64:67], a[236:239], v[152:155], a[64:67]
    v_mfma_f32_16x16x32_bf16 v[252:255], a[224:227], v[156:159], v[252:255]
    buffer_load_dwordx4 v[132:135], v5, s[24:27], s60 offen sc1
    v_mfma_f32_16x16x32_bf16 a[20:23], a[228:231], v[156:159], a[20:23]
    v_mfma_f32_16x16x32_bf16 a[44:47], a[232:235], v[156:159], a[44:47]
    v_mfma_f32_16x16x32_bf16 a[68:71], a[236:239], v[156:159], a[68:71]
    s_waitcnt vmcnt(26)
    s_add_u32 s60, s94, 16384
    s_and_b32 s60, s60, 32767
    v_mfma_f32_16x16x32_bf16 v[232:235], a[240:243], v[160:163], v[232:235]
    buffer_load_dwordx4 v[136:139], v0, s[24:27], s60 offen sc1
    v_mfma_f32_16x16x32_bf16 a[0:3], a[244:247], v[160:163], a[0:3]
    v_mfma_f32_16x16x32_bf16 a[24:27], a[248:251], v[160:163], a[24:27]
    v_mfma_f32_16x16x32_bf16 a[48:51], a[252:255], v[160:163], a[48:51]
    buffer_load_dwordx4 v[140:143], v1, s[24:27], s60 offen sc1
    v_mfma_f32_16x16x32_bf16 v[236:239], a[240:243], v[164:167], v[236:239]
    v_mfma_f32_16x16x32_bf16 a[4:7], a[244:247], v[164:167], a[4:7]
    v_mfma_f32_16x16x32_bf16 a[28:31], a[248:251], v[164:167], a[28:31]
    v_mfma_f32_16x16x32_bf16 a[52:55], a[252:255], v[164:167], a[52:55]
    buffer_load_dwordx4 v[144:147], v2, s[24:27], s60 offen sc1
    v_mfma_f32_16x16x32_bf16 v[240:243], a[240:243], v[168:171], v[240:243]
    v_mfma_f32_16x16x32_bf16 a[8:11], a[244:247], v[168:171], a[8:11]
    v_mfma_f32_16x16x32_bf16 a[32:35], a[248:251], v[168:171], a[32:35]
    v_mfma_f32_16x16x32_bf16 a[56:59], a[252:255], v[168:171], a[56:59]
    buffer_load_dwordx4 v[148:151], v3, s[24:27], s60 offen sc1
    v_mfma_f32_16x16x32_bf16 v[244:247], a[240:243], v[172:175], v[244:247]
    v_mfma_f32_16x16x32_bf16 a[12:15], a[244:247], v[172:175], a[12:15]
    v_mfma_f32_16x16x32_bf16 a[36:39], a[248:251], v[172:175], a[36:39]
    v_mfma_f32_16x16x32_bf16 a[60:63], a[252:255], v[172:175], a[60:63]
    buffer_load_dwordx4 v[152:155], v4, s[24:27], s60 offen sc1
    v_mfma_f32_16x16x32_bf16 v[248:251], a[240:243], v[176:179], v[248:251]
    v_mfma_f32_16x16x32_bf16 a[16:19], a[244:247], v[176:179], a[16:19]
    v_mfma_f32_16x16x32_bf16 a[40:43], a[248:251], v[176:179], a[40:43]
    v_mfma_f32_16x16x32_bf16 a[64:67], a[252:255], v[176:179], a[64:67]
    buffer_load_dwordx4 v[156:159], v5, s[24:27], s60 offen sc1
    v_mfma_f32_16x16x32_bf16 v[252:255], a[240:243], v[180:183], v[252:255]
    v_mfma_f32_16x16x32_bf16 a[20:23], a[244:247], v[180:183], a[20:23]
    v_mfma_f32_16x16x32_bf16 a[44:47], a[248:251], v[180:183], a[44:47]
    v_mfma_f32_16x16x32_bf16 a[68:71], a[252:255], v[180:183], a[68:71]
    s_waitcnt vmcnt(22)
    s_add_u32 s60, s94, 17408
    s_and_b32 s60, s60, 32767
    v_mfma_f32_16x16x32_bf16 v[232:235], a[80:83], v[184:187], v[232:235]
    buffer_load_dwordx4 v[160:163], v0, s[24:27], s60 offen sc1
    v_mfma_f32_16x16x32_bf16 a[0:3], a[84:87], v[184:187], a[0:3]
    v_mfma_f32_16x16x32_bf16 a[24:27], a[88:91], v[184:187], a[24:27]
    buffer_load_dwordx4 v[164:167], v1, s[24:27], s60 offen sc1
    v_mfma_f32_16x16x32_bf16 a[48:51], a[92:95], v[184:187], a[48:51]
    s_add_u32 s63, s94, 31744
    s_and_b32 s63, s63, 32767
    s_add_u32 m0, s81, 81920
    v_mfma_f32_16x16x32_bf16 v[236:239], a[80:83], v[188:191], v[236:239]
    s_mul_i32 s63, s63, 36
    buffer_load_dwordx4 v6, s[20:23], s63 offen offset:0 lds
    v_mfma_f32_16x16x32_bf16 a[4:7], a[84:87], v[188:191], a[4:7]
    v_mfma_f32_16x16x32_bf16 a[28:31], a[88:91], v[188:191], a[28:31]
    buffer_load_dwordx4 v[168:171], v2, s[24:27], s60 offen sc1
    v_mfma_f32_16x16x32_bf16 a[52:55], a[92:95], v[188:191], a[52:55]
    v_mfma_f32_16x16x32_bf16 v[240:243], a[80:83], v[192:195], v[240:243]
    v_mfma_f32_16x16x32_bf16 a[8:11], a[84:87], v[192:195], a[8:11]
    buffer_load_dwordx4 v7, s[20:23], s63 offen offset:1024 lds
    v_mfma_f32_16x16x32_bf16 a[32:35], a[88:91], v[192:195], a[32:35]
    v_mfma_f32_16x16x32_bf16 a[56:59], a[92:95], v[192:195], a[56:59]
    buffer_load_dwordx4 v[172:175], v3, s[24:27], s60 offen sc1
    v_mfma_f32_16x16x32_bf16 v[244:247], a[80:83], v[196:199], v[244:247]
    v_mfma_f32_16x16x32_bf16 a[12:15], a[84:87], v[196:199], a[12:15]
    buffer_load_dwordx4 v8, s[20:23], s63 offen offset:2048 lds
    v_mfma_f32_16x16x32_bf16 a[36:39], a[88:91], v[196:199], a[36:39]
    v_mfma_f32_16x16x32_bf16 a[60:63], a[92:95], v[196:199], a[60:63]
    v_mfma_f32_16x16x32_bf16 v[248:251], a[80:83], v[200:203], v[248:251]
    buffer_load_dwordx4 v[176:179], v4, s[24:27], s60 offen sc1
    v_mfma_f32_16x16x32_bf16 a[16:19], a[84:87], v[200:203], a[16:19]
    v_mfma_f32_16x16x32_bf16 a[40:43], a[88:91], v[200:203], a[40:43]
    buffer_load_dwordx4 v9, s[20:23], s63 offen offset:3072 lds
    v_mfma_f32_16x16x32_bf16 a[64:67], a[92:95], v[200:203], a[64:67]
    v_mfma_f32_16x16x32_bf16 v[252:255], a[80:83], v[204:207], v[252:255]
    buffer_load_dwordx4 v[180:183], v5, s[24:27], s60 offen sc1
    v_mfma_f32_16x16x32_bf16 a[20:23], a[84:87], v[204:207], a[20:23]
    v_mfma_f32_16x16x32_bf16 a[44:47], a[88:91], v[204:207], a[44:47]
    v_mfma_f32_16x16x32_bf16 a[68:71], a[92:95], v[204:207], a[68:71]
    s_waitcnt vmcnt(26)
    ds_read_b64_tr_b16 v[48:49], v22 offset:16384
    ds_read_b64_tr_b16 v[50:51], v22 offset:18432
    v_mfma_f32_16x16x32_bf16 v[232:235], a[96:99], v[208:211], v[232:235]
    ds_read_b64_tr_b16 v[52:53], v23 offset:16384
    ds_read_b64_tr_b16 v[54:55], v23 offset:18432
    v_mfma_f32_16x16x32_bf16 a[0:3], a[100:103], v[208:211], a[0:3]
    ds_read_b64_tr_b16 v[56:57], v24 offset:16384
    ds_read_b64_tr_b16 v[58:59], v24 offset:18432
    v_mfma_f32_16x16x32_bf16 a[24:27], a[104:107], v[208:211], a[24:27]
    ds_read_b64_tr_b16 v[60:61], v25 offset:16384
    ds_read_b64_tr_b16 v[62:63], v25 offset:18432
    v_mfma_f32_16x16x32_bf16 a[48:51], a[108:111], v[208:211], a[48:51]
    s_add_u32 s60, s94, 18432
    s_and_b32 s60, s60, 32767
    v_and_b32 v22, 15, v10
    v_mfma_f32_16x16x32_bf16 v[236:239], a[96:99], v[212:215], v[236:239]
    buffer_load_dwordx4 v[184:187], v0, s[24:27], s60 offen sc1
    v_mfma_f32_16x16x32_bf16 a[4:7], a[100:103], v[212:215], a[4:7]
    buffer_load_dwordx4 v[188:191], v1, s[24:27], s60 offen sc1
    v_mfma_f32_16x16x32_bf16 a[28:31], a[104:107], v[212:215], a[28:31]
    v_mul_u32_u24 v22, 2304, v22
    v_lshl_add_u32 v22, v12, 3, v22
    v_mfma_f32_16x16x32_bf16 a[52:55], a[108:111], v[212:215], a[52:55]
    buffer_load_dwordx4 v[192:195], v2, s[24:27], s60 offen sc1
    v_mfma_f32_16x16x32_bf16 v[240:243], a[96:99], v[216:219], v[240:243]
    v_mfma_f32_16x16x32_bf16 a[8:11], a[100:103], v[216:219], a[8:11]
    v_mfma_f32_16x16x32_bf16 a[32:35], a[104:107], v[216:219], a[32:35]
    v_mfma_f32_16x16x32_bf16 a[56:59], a[108:111], v[216:219], a[56:59]
    buffer_load_dwordx4 v[196:199], v3, s[24:27], s60 offen sc1
    v_mfma_f32_16x16x32_bf16 v[244:247], a[96:99], v[220:223], v[244:247]
    v_mfma_f32_16x16x32_bf16 a[12:15], a[100:103], v[220:223], a[12:15]
    v_mfma_f32_16x16x32_bf16 a[36:39], a[104:107], v[220:223], a[36:39]
    v_mfma_f32_16x16x32_bf16 a[60:63], a[108:111], v[220:223], a[60:63]
    buffer_load_dwordx4 v[200:203], v4, s[24:27], s60 offen sc1
    v_mfma_f32_16x16x32_bf16 v[248:251], a[96:99], v[224:227], v[248:251]
    v_mfma_f32_16x16x32_bf16 a[16:19], a[100:103], v[224:227], a[16:19]
    v_mfma_f32_16x16x32_bf16 a[40:43], a[104:107], v[224:227], a[40:43]
    v_mfma_f32_16x16x32_bf16 a[64:67], a[108:111], v[224:227], a[64:67]
    buffer_load_dwordx4 v[204:207], v5, s[24:27], s60 offen sc1
    v_mfma_f32_16x16x32_bf16 v[252:255], a[96:99], v[228:231], v[252:255]
    v_mfma_f32_16x16x32_bf16 a[20:23], a[100:103], v[228:231], a[20:23]
    v_mfma_f32_16x16x32_bf16 a[44:47], a[104:107], v[228:231], a[44:47]
    v_mfma_f32_16x16x32_bf16 a[68:71], a[108:111], v[228:231], a[68:71]
    s_waitcnt vmcnt(22)
    s_add_u32 s60, s94, 19456
    s_and_b32 s60, s60, 32767
    v_mfma_f32_16x16x32_bf16 v[232:235], a[112:115], v[112:115], v[232:235]
    buffer_load_dwordx4 v[208:211], v0, s[24:27], s60 offen sc1
    v_mfma_f32_16x16x32_bf16 a[0:3], a[116:119], v[112:115], a[0:3]
    v_mfma_f32_16x16x32_bf16 a[24:27], a[120:123], v[112:115], a[24:27]
    v_mfma_f32_16x16x32_bf16 a[48:51], a[124:127], v[112:115], a[48:51]
    buffer_load_dwordx4 v[212:215], v1, s[24:27], s60 offen sc1
    v_mfma_f32_16x16x32_bf16 v[236:239], a[112:115], v[116:119], v[236:239]
    v_mfma_f32_16x16x32_bf16 a[4:7], a[116:119], v[116:119], a[4:7]
    v_mfma_f32_16x16x32_bf16 a[28:31], a[120:123], v[116:119], a[28:31]
    v_mfma_f32_16x16x32_bf16 a[52:55], a[124:127], v[116:119], a[52:55]
    buffer_load_dwordx4 v[216:219], v2, s[24:27], s60 offen sc1
    v_mfma_f32_16x16x32_bf16 v[240:243], a[112:115], v[120:123], v[240:243]
    v_mfma_f32_16x16x32_bf16 a[8:11], a[116:119], v[120:123], a[8:11]
    v_mfma_f32_16x16x32_bf16 a[32:35], a[120:123], v[120:123], a[32:35]
    v_mfma_f32_16x16x32_bf16 a[56:59], a[124:127], v[120:123], a[56:59]
    buffer_load_dwordx4 v[220:223], v3, s[24:27], s60 offen sc1
    v_mfma_f32_16x16x32_bf16 v[244:247], a[112:115], v[124:127], v[244:247]
    v_mfma_f32_16x16x32_bf16 a[12:15], a[116:119], v[124:127], a[12:15]
    v_mfma_f32_16x16x32_bf16 a[36:39], a[120:123], v[124:127], a[36:39]
    v_mfma_f32_16x16x32_bf16 a[60:63], a[124:127], v[124:127], a[60:63]
    buffer_load_dwordx4 v[224:227], v4, s[24:27], s60 offen sc1
    v_mfma_f32_16x16x32_bf16 v[248:251], a[112:115], v[128:131], v[248:251]
    v_mfma_f32_16x16x32_bf16 a[16:19], a[116:119], v[128:131], a[16:19]
    v_mfma_f32_16x16x32_bf16 a[40:43], a[120:123], v[128:131], a[40:43]
    v_mfma_f32_16x16x32_bf16 a[64:67], a[124:127], v[128:131], a[64:67]
    buffer_load_dwordx4 v[228:231], v5, s[24:27], s60 offen sc1
    v_mfma_f32_16x16x32_bf16 v[252:255], a[112:115], v[132:135], v[252:255]
    v_mfma_f32_16x16x32_bf16 a[20:23], a[116:119], v[132:135], a[20:23]
    v_mfma_f32_16x16x32_bf16 a[44:47], a[120:123], v[132:135], a[44:47]
    v_mfma_f32_16x16x32_bf16 a[68:71], a[124:127], v[132:135], a[68:71]
    s_waitcnt vmcnt(22)
    ds_read_b64_tr_b16 a[224:225], v18 offset:32768
    ds_read_b64_tr_b16 a[226:227], v18 offset:34816
    v_mfma_f32_16x16x32_bf16 v[232:235], v[96:99], v[136:139], v[232:235]
    ds_read_b64_tr_b16 a[228:229], v19 offset:32768
    ds_read_b64_tr_b16 a[230:231], v19 offset:34816
    v_mfma_f32_16x16x32_bf16 a[0:3], v[100:103], v[136:139], a[0:3]
    ds_read_b64_tr_b16 a[232:233], v20 offset:32768
    ds_read_b64_tr_b16 a[234:235], v20 offset:34816
    v_mfma_f32_16x16x32_bf16 a[24:27], v[104:107], v[136:139], a[24:27]
    ds_read_b64_tr_b16 a[236:237], v21 offset:32768
    ds_read_b64_tr_b16 a[238:239], v21 offset:34816
    v_mfma_f32_16x16x32_bf16 a[48:51], v[108:111], v[136:139], a[48:51]
    s_add_u32 s60, s94, 20480
    s_and_b32 s60, s60, 32767
    v_mfma_f32_16x16x32_bf16 v[236:239], v[96:99], v[140:143], v[236:239]
    buffer_load_dwordx4 v[112:115], v0, s[24:27], s60 offen sc1
    v_mfma_f32_16x16x32_bf16 a[4:7], v[100:103], v[140:143], a[4:7]
    buffer_load_dwordx4 v[116:119], v1, s[24:27], s60 offen sc1
    v_mfma_f32_16x16x32_bf16 a[28:31], v[104:107], v[140:143], a[28:31]
    v_mfma_f32_16x16x32_bf16 a[52:55], v[108:111], v[140:143], a[52:55]
    buffer_load_dwordx4 v[120:123], v2, s[24:27], s60 offen sc1
    v_mfma_f32_16x16x32_bf16 v[240:243], v[96:99], v[144:147], v[240:243]
    v_mfma_f32_16x16x32_bf16 a[8:11], v[100:103], v[144:147], a[8:11]
    v_mfma_f32_16x16x32_bf16 a[32:35], v[104:107], v[144:147], a[32:35]
    v_mfma_f32_16x16x32_bf16 a[56:59], v[108:111], v[144:147], a[56:59]
    buffer_load_dwordx4 v[124:127], v3, s[24:27], s60 offen sc1
    v_mfma_f32_16x16x32_bf16 v[244:247], v[96:99], v[148:151], v[244:247]
    v_mfma_f32_16x16x32_bf16 a[12:15], v[100:103], v[148:151], a[12:15]
    v_mfma_f32_16x16x32_bf16 a[36:39], v[104:107], v[148:151], a[36:39]
    v_mfma_f32_16x16x32_bf16 a[60:63], v[108:111], v[148:151], a[60:63]
    buffer_load_dwordx4 v[128:131], v4, s[24:27], s60 offen sc1
    v_mfma_f32_16x16x32_bf16 v[248:251], v[96:99], v[152:155], v[248:251]
    v_mfma_f32_16x16x32_bf16 a[16:19], v[100:103], v[152:155], a[16:19]
    v_mfma_f32_16x16x32_bf16 a[40:43], v[104:107], v[152:155], a[40:43]
    v_mfma_f32_16x16x32_bf16 a[64:67], v[108:111], v[152:155], a[64:67]
    buffer_load_dwordx4 v[132:135], v5, s[24:27], s60 offen sc1
    v_mfma_f32_16x16x32_bf16 v[252:255], v[96:99], v[156:159], v[252:255]
    v_mfma_f32_16x16x32_bf16 a[20:23], v[100:103], v[156:159], a[20:23]
    v_mfma_f32_16x16x32_bf16 a[44:47], v[104:107], v[156:159], a[44:47]
    v_mfma_f32_16x16x32_bf16 a[68:71], v[108:111], v[156:159], a[68:71]
    s_waitcnt vmcnt(18)
    s_add_u32 s60, s94, 21504
    s_and_b32 s60, s60, 32767
    v_mfma_f32_16x16x32_bf16 v[232:235], v[64:67], v[160:163], v[232:235]
    buffer_load_dwordx4 v[136:139], v0, s[24:27], s60 offen sc1
    v_mfma_f32_16x16x32_bf16 a[0:3], v[68:71], v[160:163], a[0:3]
    v_mfma_f32_16x16x32_bf16 a[24:27], v[72:75], v[160:163], a[24:27]
    v_mfma_f32_16x16x32_bf16 a[48:51], v[76:79], v[160:163], a[48:51]
    buffer_load_dwordx4 v[140:143], v1, s[24:27], s60 offen sc1
    v_mfma_f32_16x16x32_bf16 v[236:239], v[64:67], v[164:167], v[236:239]
    v_mfma_f32_16x16x32_bf16 a[4:7], v[68:71], v[164:167], a[4:7]
    v_mfma_f32_16x16x32_bf16 a[28:31], v[72:75], v[164:167], a[28:31]
    v_mfma_f32_16x16x32_bf16 a[52:55], v[76:79], v[164:167], a[52:55]
    buffer_load_dwordx4 v[144:147], v2, s[24:27], s60 offen sc1
    v_mfma_f32_16x16x32_bf16 v[240:243], v[64:67], v[168:171], v[240:243]
    v_mfma_f32_16x16x32_bf16 a[8:11], v[68:71], v[168:171], a[8:11]
    v_mfma_f32_16x16x32_bf16 a[32:35], v[72:75], v[168:171], a[32:35]
    v_mfma_f32_16x16x32_bf16 a[56:59], v[76:79], v[168:171], a[56:59]
    buffer_load_dwordx4 v[148:151], v3, s[24:27], s60 offen sc1
    v_mfma_f32_16x16x32_bf16 v[244:247], v[64:67], v[172:175], v[244:247]
    v_mfma_f32_16x16x32_bf16 a[12:15], v[68:71], v[172:175], a[12:15]
    v_mfma_f32_16x16x32_bf16 a[36:39], v[72:75], v[172:175], a[36:39]
    v_mfma_f32_16x16x32_bf16 a[60:63], v[76:79], v[172:175], a[60:63]
    buffer_load_dwordx4 v[152:155], v4, s[24:27], s60 offen sc1
    v_mfma_f32_16x16x32_bf16 v[248:251], v[64:67], v[176:179], v[248:251]
    v_mfma_f32_16x16x32_bf16 a[16:19], v[68:71], v[176:179], a[16:19]
    v_mfma_f32_16x16x32_bf16 a[40:43], v[72:75], v[176:179], a[40:43]
    v_mfma_f32_16x16x32_bf16 a[64:67], v[76:79], v[176:179], a[64:67]
    buffer_load_dwordx4 v[156:159], v5, s[24:27], s60 offen sc1
    v_mfma_f32_16x16x32_bf16 v[252:255], v[64:67], v[180:183], v[252:255]
    v_mfma_f32_16x16x32_bf16 a[20:23], v[68:71], v[180:183], a[20:23]
    v_mfma_f32_16x16x32_bf16 a[44:47], v[72:75], v[180:183], a[44:47]
    v_mfma_f32_16x16x32_bf16 a[68:71], v[76:79], v[180:183], a[68:71]
    s_waitcnt vmcnt(18)
    ds_read_b64_tr_b16 a[240:241], v14 offset:0
    ds_read_b64_tr_b16 a[242:243], v14 offset:2048
    v_mfma_f32_16x16x32_bf16 v[232:235], v[80:83], v[184:187], v[232:235]
    ds_read_b64_tr_b16 a[244:245], v15 offset:0
    ds_read_b64_tr_b16 a[246:247], v15 offset:2048
    v_mfma_f32_16x16x32_bf16 a[0:3], v[84:87], v[184:187], a[0:3]
    ds_read_b64_tr_b16 a[248:249], v16 offset:0
    ds_read_b64_tr_b16 a[250:251], v16 offset:2048
    v_mfma_f32_16x16x32_bf16 a[24:27], v[88:91], v[184:187], a[24:27]
    ds_read_b64_tr_b16 a[252:253], v17 offset:0
    ds_read_b64_tr_b16 a[254:255], v17 offset:2048
    v_mfma_f32_16x16x32_bf16 a[48:51], v[92:95], v[184:187], a[48:51]
    s_add_u32 s60, s94, 22528
    s_and_b32 s60, s60, 32767
    v_mfma_f32_16x16x32_bf16 v[236:239], v[80:83], v[188:191], v[236:239]
    buffer_load_dwordx4 v[160:163], v0, s[24:27], s60 offen sc1
    v_mfma_f32_16x16x32_bf16 a[4:7], v[84:87], v[188:191], a[4:7]
    buffer_load_dwordx4 v[164:167], v1, s[24:27], s60 offen sc1
    v_mfma_f32_16x16x32_bf16 a[28:31], v[88:91], v[188:191], a[28:31]
    v_mfma_f32_16x16x32_bf16 a[52:55], v[92:95], v[188:191], a[52:55]
    buffer_load_dwordx4 v[168:171], v2, s[24:27], s60 offen sc1
    v_mfma_f32_16x16x32_bf16 v[240:243], v[80:83], v[192:195], v[240:243]
    v_mfma_f32_16x16x32_bf16 a[8:11], v[84:87], v[192:195], a[8:11]
    v_mfma_f32_16x16x32_bf16 a[32:35], v[88:91], v[192:195], a[32:35]
    v_mfma_f32_16x16x32_bf16 a[56:59], v[92:95], v[192:195], a[56:59]
    buffer_load_dwordx4 v[172:175], v3, s[24:27], s60 offen sc1
    v_mfma_f32_16x16x32_bf16 v[244:247], v[80:83], v[196:199], v[244:247]
    v_mfma_f32_16x16x32_bf16 a[12:15], v[84:87], v[196:199], a[12:15]
    v_mfma_f32_16x16x32_bf16 a[36:39], v[88:91], v[196:199], a[36:39]
    v_mfma_f32_16x16x32_bf16 a[60:63], v[92:95], v[196:199], a[60:63]
    buffer_load_dwordx4 v[176:179], v4, s[24:27], s60 offen sc1
    v_mfma_f32_16x16x32_bf16 v[248:251], v[80:83], v[200:203], v[248:251]
    v_mfma_f32_16x16x32_bf16 a[16:19], v[84:87], v[200:203], a[16:19]
    v_mfma_f32_16x16x32_bf16 a[40:43], v[88:91], v[200:203], a[40:43]
    v_mfma_f32_16x16x32_bf16 a[64:67], v[92:95], v[200:203], a[64:67]
    buffer_load_dwordx4 v[180:183], v5, s[24:27], s60 offen sc1
    v_mfma_f32_16x16x32_bf16 v[252:255], v[80:83], v[204:207], v[252:255]
    v_mfma_f32_16x16x32_bf16 a[20:23], v[84:87], v[204:207], a[20:23]
    v_mfma_f32_16x16x32_bf16 a[44:47], v[88:91], v[204:207], a[44:47]
    v_mfma_f32_16x16x32_bf16 a[68:71], v[92:95], v[204:207], a[68:71]
    s_waitcnt vmcnt(18)
    s_add_u32 s60, s94, 23552
    s_and_b32 s60, s60, 32767
    v_mfma_f32_16x16x32_bf16 v[232:235], a[192:195], v[208:211], v[232:235]
    buffer_load_dwordx4 v[184:187], v0, s[24:27], s60 offen sc1
    v_mfma_f32_16x16x32_bf16 a[0:3], a[196:199], v[208:211], a[0:3]
    v_mfma_f32_16x16x32_bf16 a[24:27], a[200:203], v[208:211], a[24:27]
    v_mfma_f32_16x16x32_bf16 a[48:51], a[204:207], v[208:211], a[48:51]
    buffer_load_dwordx4 v[188:191], v1, s[24:27], s60 offen sc1
    v_mfma_f32_16x16x32_bf16 v[236:239], a[192:195], v[212:215], v[236:239]
    v_mfma_f32_16x16x32_bf16 a[4:7], a[196:199], v[212:215], a[4:7]
    v_mfma_f32_16x16x32_bf16 a[28:31], a[200:203], v[212:215], a[28:31]
    v_mfma_f32_16x16x32_bf16 a[52:55], a[204:207], v[212:215], a[52:55]
    buffer_load_dwordx4 v[192:195], v2, s[24:27], s60 offen sc1
    v_mfma_f32_16x16x32_bf16 v[240:243], a[192:195], v[216:219], v[240:243]
    v_mfma_f32_16x16x32_bf16 a[8:11], a[196:199], v[216:219], a[8:11]
    v_mfma_f32_16x16x32_bf16 a[32:35], a[200:203], v[216:219], a[32:35]
    v_mfma_f32_16x16x32_bf16 a[56:59], a[204:207], v[216:219], a[56:59]
    buffer_load_dwordx4 v[196:199], v3, s[24:27], s60 offen sc1
    v_mfma_f32_16x16x32_bf16 v[244:247], a[192:195], v[220:223], v[244:247]
    v_mfma_f32_16x16x32_bf16 a[12:15], a[196:199], v[220:223], a[12:15]
    v_mfma_f32_16x16x32_bf16 a[36:39], a[200:203], v[220:223], a[36:39]
    v_mfma_f32_16x16x32_bf16 a[60:63], a[204:207], v[220:223], a[60:63]
    buffer_load_dwordx4 v[200:203], v4, s[24:27], s60 offen sc1
    v_mfma_f32_16x16x32_bf16 v[248:251], a[192:195], v[224:227], v[248:251]
    v_mfma_f32_16x16x32_bf16 a[16:19], a[196:199], v[224:227], a[16:19]
    v_mfma_f32_16x16x32_bf16 a[40:43], a[200:203], v[224:227], a[40:43]
    v_mfma_f32_16x16x32_bf16 a[64:67], a[204:207], v[224:227], a[64:67]
    buffer_load_dwordx4 v[204:207], v5, s[24:27], s60 offen sc1
    v_mfma_f32_16x16x32_bf16 v[252:255], a[192:195], v[228:231], v[252:255]
    v_mfma_f32_16x16x32_bf16 a[20:23], a[196:199], v[228:231], a[20:23]
    v_mfma_f32_16x16x32_bf16 a[44:47], a[200:203], v[228:231], a[44:47]
    v_mfma_f32_16x16x32_bf16 a[68:71], a[204:207], v[228:231], a[68:71]
    s_waitcnt vmcnt(18)
    ds_read_b64_tr_b16 a[80:81], v18 offset:0
    ds_read_b64_tr_b16 a[82:83], v18 offset:2048
    v_mfma_f32_16x16x32_bf16 v[232:235], a[208:211], v[112:115], v[232:235]
    ds_read_b64_tr_b16 a[84:85], v19 offset:0
    ds_read_b64_tr_b16 a[86:87], v19 offset:2048
    v_mfma_f32_16x16x32_bf16 a[0:3], a[212:215], v[112:115], a[0:3]
    ds_read_b64_tr_b16 a[88:89], v20 offset:0
    ds_read_b64_tr_b16 a[90:91], v20 offset:2048
    v_mfma_f32_16x16x32_bf16 a[24:27], a[216:219], v[112:115], a[24:27]
    ds_read_b64_tr_b16 a[92:93], v21 offset:0
    ds_read_b64_tr_b16 a[94:95], v21 offset:2048
    v_mfma_f32_16x16x32_bf16 a[48:51], a[220:223], v[112:115], a[48:51]
    s_add_u32 s60, s94, 24576
    s_and_b32 s60, s60, 32767
    v_mfma_f32_16x16x32_bf16 v[236:239], a[208:211], v[116:119], v[236:239]
    buffer_load_dwordx4 v[208:211], v0, s[24:27], s60 offen sc1
    v_mfma_f32_16x16x32_bf16 a[4:7], a[212:215], v[116:119], a[4:7]
    buffer_load_dwordx4 v[212:215], v1, s[24:27], s60 offen sc1
    v_mfma_f32_16x16x32_bf16 a[28:31], a[216:219], v[116:119], a[28:31]
    v_mfma_f32_16x16x32_bf16 a[52:55], a[220:223], v[116:119], a[52:55]
    buffer_load_dwordx4 v[216:219], v2, s[24:27], s60 offen sc1
    v_mfma_f32_16x16x32_bf16 v[240:243], a[208:211], v[120:123], v[240:243]
    v_mfma_f32_16x16x32_bf16 a[8:11], a[212:215], v[120:123], a[8:11]
    v_mfma_f32_16x16x32_bf16 a[32:35], a[216:219], v[120:123], a[32:35]
    v_mfma_f32_16x16x32_bf16 a[56:59], a[220:223], v[120:123], a[56:59]
    buffer_load_dwordx4 v[220:223], v3, s[24:27], s60 offen sc1
    v_mfma_f32_16x16x32_bf16 v[244:247], a[208:211], v[124:127], v[244:247]
    v_mfma_f32_16x16x32_bf16 a[12:15], a[212:215], v[124:127], a[12:15]
    v_mfma_f32_16x16x32_bf16 a[36:39], a[216:219], v[124:127], a[36:39]
    v_mfma_f32_16x16x32_bf16 a[60:63], a[220:223], v[124:127], a[60:63]
    buffer_load_dwordx4 v[224:227], v4, s[24:27], s60 offen sc1
    v_mfma_f32_16x16x32_bf16 v[248:251], a[208:211], v[128:131], v[248:251]
    v_mfma_f32_16x16x32_bf16 a[16:19], a[212:215], v[128:131], a[16:19]
    v_mfma_f32_16x16x32_bf16 a[40:43], a[216:219], v[128:131], a[40:43]
    v_mfma_f32_16x16x32_bf16 a[64:67], a[220:223], v[128:131], a[64:67]
    buffer_load_dwordx4 v[228:231], v5, s[24:27], s60 offen sc1
    v_mfma_f32_16x16x32_bf16 v[252:255], a[208:211], v[132:135], v[252:255]
    v_mfma_f32_16x16x32_bf16 a[20:23], a[212:215], v[132:135], a[20:23]
    v_mfma_f32_16x16x32_bf16 a[44:47], a[216:219], v[132:135], a[44:47]
    v_mfma_f32_16x16x32_bf16 a[68:71], a[220:223], v[132:135], a[68:71]
    s_waitcnt vmcnt(18)
    s_add_u32 s60, s94, 25600
    s_and_b32 s60, s60, 32767
    v_mfma_f32_16x16x32_bf16 v[232:235], a[128:131], v[136:139], v[232:235]
    buffer_load_dwordx4 v[112:115], v0, s[24:27], s60 offen sc1
    v_mfma_f32_16x16x32_bf16 a[0:3], a[132:135], v[136:139], a[0:3]
    v_mfma_f32_16x16x32_bf16 a[24:27], a[136:139], v[136:139], a[24:27]
    v_mfma_f32_16x16x32_bf16 a[48:51], a[140:143], v[136:139], a[48:51]
    buffer_load_dwordx4 v[116:119], v1, s[24:27], s60 offen sc1
    v_mfma_f32_16x16x32_bf16 v[236:239], a[128:131], v[140:143], v[236:239]
    v_mfma_f32_16x16x32_bf16 a[4:7], a[132:135], v[140:143], a[4:7]
    v_mfma_f32_16x16x32_bf16 a[28:31], a[136:139], v[140:143], a[28:31]
    v_mfma_f32_16x16x32_bf16 a[52:55], a[140:143], v[140:143], a[52:55]
    buffer_load_dwordx4 v[120:123], v2, s[24:27], s60 offen sc1
    v_mfma_f32_16x16x32_bf16 v[240:243], a[128:131], v[144:147], v[240:243]
    v_mfma_f32_16x16x32_bf16 a[8:11], a[132:135], v[144:147], a[8:11]
    v_mfma_f32_16x16x32_bf16 a[32:35], a[136:139], v[144:147], a[32:35]
    v_mfma_f32_16x16x32_bf16 a[56:59], a[140:143], v[144:147], a[56:59]
    buffer_load_dwordx4 v[124:127], v3, s[24:27], s60 offen sc1
    v_mfma_f32_16x16x32_bf16 v[244:247], a[128:131], v[148:151], v[244:247]
    v_mfma_f32_16x16x32_bf16 a[12:15], a[132:135], v[148:151], a[12:15]
    v_mfma_f32_16x16x32_bf16 a[36:39], a[136:139], v[148:151], a[36:39]
    v_mfma_f32_16x16x32_bf16 a[60:63], a[140:143], v[148:151], a[60:63]
    buffer_load_dwordx4 v[128:131], v4, s[24:27], s60 offen sc1
    v_mfma_f32_16x16x32_bf16 v[248:251], a[128:131], v[152:155], v[248:251]
    v_mfma_f32_16x16x32_bf16 a[16:19], a[132:135], v[152:155], a[16:19]
    v_mfma_f32_16x16x32_bf16 a[40:43], a[136:139], v[152:155], a[40:43]
    v_mfma_f32_16x16x32_bf16 a[64:67], a[140:143], v[152:155], a[64:67]
    buffer_load_dwordx4 v[132:135], v5, s[24:27], s60 offen sc1
    v_mfma_f32_16x16x32_bf16 v[252:255], a[128:131], v[156:159], v[252:255]
    v_mfma_f32_16x16x32_bf16 a[20:23], a[132:135], v[156:159], a[20:23]
    v_mfma_f32_16x16x32_bf16 a[44:47], a[136:139], v[156:159], a[44:47]
    v_mfma_f32_16x16x32_bf16 a[68:71], a[140:143], v[156:159], a[68:71]
    s_waitcnt vmcnt(18)
    ds_read_b64_tr_b16 a[96:97], v14 offset:16384
    ds_read_b64_tr_b16 a[98:99], v14 offset:18432
    v_mfma_f32_16x16x32_bf16 v[232:235], a[144:147], v[160:163], v[232:235]
    ds_read_b64_tr_b16 a[100:101], v15 offset:16384
    ds_read_b64_tr_b16 a[102:103], v15 offset:18432
    v_mfma_f32_16x16x32_bf16 a[0:3], a[148:151], v[160:163], a[0:3]
    ds_read_b64_tr_b16 a[104:105], v16 offset:16384
    ds_read_b64_tr_b16 a[106:107], v16 offset:18432
    v_mfma_f32_16x16x32_bf16 a[24:27], a[152:155], v[160:163], a[24:27]
    ds_read_b64_tr_b16 a[108:109], v17 offset:16384
    ds_read_b64_tr_b16 a[110:111], v17 offset:18432
    v_mfma_f32_16x16x32_bf16 a[48:51], a[156:159], v[160:163], a[48:51]
    s_add_u32 s60, s94, 26624
    s_and_b32 s60, s60, 32767
    v_add_u32 v14, s81, v11
    v_mfma_f32_16x16x32_bf16 v[236:239], a[144:147], v[164:167], v[236:239]
    buffer_load_dwordx4 v[136:139], v0, s[24:27], s60 offen sc1
    v_mfma_f32_16x16x32_bf16 a[4:7], a[148:151], v[164:167], a[4:7]
    buffer_load_dwordx4 v[140:143], v1, s[24:27], s60 offen sc1
    v_mfma_f32_16x16x32_bf16 a[28:31], a[152:155], v[164:167], a[28:31]
    v_add_u32 v15, 65536, v14
    v_mfma_f32_16x16x32_bf16 a[52:55], a[156:159], v[164:167], a[52:55]
    buffer_load_dwordx4 v[144:147], v2, s[24:27], s60 offen sc1
    v_mfma_f32_16x16x32_bf16 v[240:243], a[144:147], v[168:171], v[240:243]
    v_mfma_f32_16x16x32_bf16 a[8:11], a[148:151], v[168:171], a[8:11]
    v_mfma_f32_16x16x32_bf16 a[32:35], a[152:155], v[168:171], a[32:35]
    v_mfma_f32_16x16x32_bf16 a[56:59], a[156:159], v[168:171], a[56:59]
    buffer_load_dwordx4 v[148:151], v3, s[24:27], s60 offen sc1
    v_mfma_f32_16x16x32_bf16 v[244:247], a[144:147], v[172:175], v[244:247]
    v_mfma_f32_16x16x32_bf16 a[12:15], a[148:151], v[172:175], a[12:15]
    v_mfma_f32_16x16x32_bf16 a[36:39], a[152:155], v[172:175], a[36:39]
    v_mfma_f32_16x16x32_bf16 a[60:63], a[156:159], v[172:175], a[60:63]
    buffer_load_dwordx4 v[152:155], v4, s[24:27], s60 offen sc1
    v_mfma_f32_16x16x32_bf16 v[248:251], a[144:147], v[176:179], v[248:251]
    v_mfma_f32_16x16x32_bf16 a[16:19], a[148:151], v[176:179], a[16:19]
    v_mfma_f32_16x16x32_bf16 a[40:43], a[152:155], v[176:179], a[40:43]
    v_mfma_f32_16x16x32_bf16 a[64:67], a[156:159], v[176:179], a[64:67]
    buffer_load_dwordx4 v[156:159], v5, s[24:27], s60 offen sc1
    v_mfma_f32_16x16x32_bf16 v[252:255], a[144:147], v[180:183], v[252:255]
    v_mfma_f32_16x16x32_bf16 a[20:23], a[148:151], v[180:183], a[20:23]
    v_mfma_f32_16x16x32_bf16 a[44:47], a[152:155], v[180:183], a[44:47]
    v_mfma_f32_16x16x32_bf16 a[68:71], a[156:159], v[180:183], a[68:71]
    s_waitcnt vmcnt(18)
    s_add_u32 s60, s94, 27648
    s_and_b32 s60, s60, 32767
    v_mfma_f32_16x16x32_bf16 v[232:235], a[160:163], v[184:187], v[232:235]
    buffer_load_dwordx4 v[160:163], v0, s[24:27], s60 offen sc1
    v_mfma_f32_16x16x32_bf16 a[0:3], a[164:167], v[184:187], a[0:3]
    v_mfma_f32_16x16x32_bf16 a[24:27], a[168:171], v[184:187], a[24:27]
    v_mfma_f32_16x16x32_bf16 a[48:51], a[172:175], v[184:187], a[48:51]
    buffer_load_dwordx4 v[164:167], v1, s[24:27], s60 offen sc1
    v_mfma_f32_16x16x32_bf16 v[236:239], a[160:163], v[188:191], v[236:239]
    v_mfma_f32_16x16x32_bf16 a[4:7], a[164:167], v[188:191], a[4:7]
    v_mfma_f32_16x16x32_bf16 a[28:31], a[168:171], v[188:191], a[28:31]
    v_mfma_f32_16x16x32_bf16 a[52:55], a[172:175], v[188:191], a[52:55]
    buffer_load_dwordx4 v[168:171], v2, s[24:27], s60 offen sc1
    v_mfma_f32_16x16x32_bf16 v[240:243], a[160:163], v[192:195], v[240:243]
    v_mfma_f32_16x16x32_bf16 a[8:11], a[164:167], v[192:195], a[8:11]
    v_mfma_f32_16x16x32_bf16 a[32:35], a[168:171], v[192:195], a[32:35]
    v_mfma_f32_16x16x32_bf16 a[56:59], a[172:175], v[192:195], a[56:59]
    buffer_load_dwordx4 v[172:175], v3, s[24:27], s60 offen sc1
    v_mfma_f32_16x16x32_bf16 v[244:247], a[160:163], v[196:199], v[244:247]
    v_mfma_f32_16x16x32_bf16 a[12:15], a[164:167], v[196:199], a[12:15]
    v_mfma_f32_16x16x32_bf16 a[36:39], a[168:171], v[196:199], a[36:39]
    v_mfma_f32_16x16x32_bf16 a[60:63], a[172:175], v[196:199], a[60:63]
    buffer_load_dwordx4 v[176:179], v4, s[24:27], s60 offen sc1
    v_mfma_f32_16x16x32_bf16 v[248:251], a[160:163], v[200:203], v[248:251]
    v_mfma_f32_16x16x32_bf16 a[16:19], a[164:167], v[200:203], a[16:19]
    v_mfma_f32_16x16x32_bf16 a[40:43], a[168:171], v[200:203], a[40:43]
    v_mfma_f32_16x16x32_bf16 a[64:67], a[172:175], v[200:203], a[64:67]
    buffer_load_dwordx4 v[180:183], v5, s[24:27], s60 offen sc1
    v_mfma_f32_16x16x32_bf16 v[252:255], a[160:163], v[204:207], v[252:255]
    v_mfma_f32_16x16x32_bf16 a[20:23], a[164:167], v[204:207], a[20:23]
    v_mfma_f32_16x16x32_bf16 a[44:47], a[168:171], v[204:207], a[44:47]
    v_mfma_f32_16x16x32_bf16 a[68:71], a[172:175], v[204:207], a[68:71]
    s_waitcnt vmcnt(18)
    ds_read_b64_tr_b16 a[112:113], v18 offset:16384
    ds_read_b64_tr_b16 a[114:115], v18 offset:18432
    v_mfma_f32_16x16x32_bf16 v[232:235], a[176:179], v[208:211], v[232:235]
    ds_read_b64_tr_b16 a[116:117], v19 offset:16384
    ds_read_b64_tr_b16 a[118:119], v19 offset:18432
    v_mfma_f32_16x16x32_bf16 a[0:3], a[180:183], v[208:211], a[0:3]
    ds_read_b64_tr_b16 a[120:121], v20 offset:16384
    ds_read_b64_tr_b16 a[122:123], v20 offset:18432
    v_mfma_f32_16x16x32_bf16 a[24:27], a[184:187], v[208:211], a[24:27]
    ds_read_b64_tr_b16 a[124:125], v21 offset:16384
    ds_read_b64_tr_b16 a[126:127], v21 offset:18432
    v_mfma_f32_16x16x32_bf16 a[48:51], a[188:191], v[208:211], a[48:51]
    s_add_u32 s60, s94, 28672
    s_and_b32 s60, s60, 32767
    v_xor_b32 v18, 4096, v14
    v_mfma_f32_16x16x32_bf16 v[236:239], a[176:179], v[212:215], v[236:239]
    buffer_load_dwordx4 v[184:187], v0, s[24:27], s60 offen sc1
    v_mfma_f32_16x16x32_bf16 a[4:7], a[180:183], v[212:215], a[4:7]
    buffer_load_dwordx4 v[188:191], v1, s[24:27], s60 offen sc1
    v_mfma_f32_16x16x32_bf16 a[28:31], a[184:187], v[212:215], a[28:31]
    v_xor_b32 v19, 40960, v14
    v_xor_b32 v20, 77824, v14
    v_mfma_f32_16x16x32_bf16 a[52:55], a[188:191], v[212:215], a[52:55]
    buffer_load_dwordx4 v[192:195], v2, s[24:27], s60 offen sc1
    v_mfma_f32_16x16x32_bf16 v[240:243], a[176:179], v[216:219], v[240:243]
    v_mfma_f32_16x16x32_bf16 a[8:11], a[180:183], v[216:219], a[8:11]
    v_mfma_f32_16x16x32_bf16 a[32:35], a[184:187], v[216:219], a[32:35]
    v_mfma_f32_16x16x32_bf16 a[56:59], a[188:191], v[216:219], a[56:59]
    buffer_load_dwordx4 v[196:199], v3, s[24:27], s60 offen sc1
    v_mfma_f32_16x16x32_bf16 v[244:247], a[176:179], v[220:223], v[244:247]
    v_mfma_f32_16x16x32_bf16 a[12:15], a[180:183], v[220:223], a[12:15]
    v_mfma_f32_16x16x32_bf16 a[36:39], a[184:187], v[220:223], a[36:39]
    v_mfma_f32_16x16x32_bf16 a[60:63], a[188:191], v[220:223], a[60:63]
    buffer_load_dwordx4 v[200:203], v4, s[24:27], s60 offen sc1
    v_mfma_f32_16x16x32_bf16 v[248:251], a[176:179], v[224:227], v[248:251]
    v_mfma_f32_16x16x32_bf16 a[16:19], a[180:183], v[224:227], a[16:19]
    v_mfma_f32_16x16x32_bf16 a[40:43], a[184:187], v[224:227], a[40:43]
    v_mfma_f32_16x16x32_bf16 a[64:67], a[188:191], v[224:227], a[64:67]
    buffer_load_dwordx4 v[204:207], v5, s[24:27], s60 offen sc1
    v_mfma_f32_16x16x32_bf16 v[252:255], a[176:179], v[228:231], v[252:255]
    v_mfma_f32_16x16x32_bf16 a[20:23], a[180:183], v[228:231], a[20:23]
    v_mfma_f32_16x16x32_bf16 a[44:47], a[184:187], v[228:231], a[44:47]
    v_mfma_f32_16x16x32_bf16 a[68:71], a[188:191], v[228:231], a[68:71]
    s_waitcnt vmcnt(18) lgkmcnt(0)
    s_add_u32 s60, s94, 29696
    s_and_b32 s60, s60, 32767
    v_mfma_f32_16x16x32_bf16 v[232:235], v[32:35], v[112:115], v[232:235]
    buffer_load_dwordx4 v[208:211], v0, s[24:27], s60 offen sc1
    v_mfma_f32_16x16x32_bf16 a[0:3], v[36:39], v[112:115], a[0:3]
    v_mfma_f32_16x16x32_bf16 a[24:27], v[40:43], v[112:115], a[24:27]
    v_mfma_f32_16x16x32_bf16 a[48:51], v[44:47], v[112:115], a[48:51]
    buffer_load_dwordx4 v[212:215], v1, s[24:27], s60 offen sc1
    v_mfma_f32_16x16x32_bf16 v[236:239], v[32:35], v[116:119], v[236:239]
    v_mfma_f32_16x16x32_bf16 a[4:7], v[36:39], v[116:119], a[4:7]
    v_mfma_f32_16x16x32_bf16 a[28:31], v[40:43], v[116:119], a[28:31]
    v_mfma_f32_16x16x32_bf16 a[52:55], v[44:47], v[116:119], a[52:55]
    buffer_load_dwordx4 v[216:219], v2, s[24:27], s60 offen sc1
    v_mfma_f32_16x16x32_bf16 v[240:243], v[32:35], v[120:123], v[240:243]
    v_mfma_f32_16x16x32_bf16 a[8:11], v[36:39], v[120:123], a[8:11]
    v_mfma_f32_16x16x32_bf16 a[32:35], v[40:43], v[120:123], a[32:35]
    v_mfma_f32_16x16x32_bf16 a[56:59], v[44:47], v[120:123], a[56:59]
    buffer_load_dwordx4 v[220:223], v3, s[24:27], s60 offen sc1
    v_mfma_f32_16x16x32_bf16 v[244:247], v[32:35], v[124:127], v[244:247]
    v_mfma_f32_16x16x32_bf16 a[12:15], v[36:39], v[124:127], a[12:15]
    v_mfma_f32_16x16x32_bf16 a[36:39], v[40:43], v[124:127], a[36:39]
    v_mfma_f32_16x16x32_bf16 a[60:63], v[44:47], v[124:127], a[60:63]
    buffer_load_dwordx4 v[224:227], v4, s[24:27], s60 offen sc1
    v_mfma_f32_16x16x32_bf16 v[248:251], v[32:35], v[128:131], v[248:251]
    v_mfma_f32_16x16x32_bf16 a[16:19], v[36:39], v[128:131], a[16:19]
    v_mfma_f32_16x16x32_bf16 a[40:43], v[40:43], v[128:131], a[40:43]
    v_mfma_f32_16x16x32_bf16 a[64:67], v[44:47], v[128:131], a[64:67]
    buffer_load_dwordx4 v[228:231], v5, s[24:27], s60 offen sc1
    v_mfma_f32_16x16x32_bf16 v[252:255], v[32:35], v[132:135], v[252:255]
    v_mfma_f32_16x16x32_bf16 a[20:23], v[36:39], v[132:135], a[20:23]
    v_mfma_f32_16x16x32_bf16 a[44:47], v[40:43], v[132:135], a[44:47]
    v_mfma_f32_16x16x32_bf16 a[68:71], v[44:47], v[132:135], a[68:71]
    s_waitcnt vmcnt(18)
    s_add_u32 s60, s94, 30720
    s_and_b32 s60, s60, 32767
    v_mfma_f32_16x16x32_bf16 v[232:235], v[48:51], v[136:139], v[232:235]
    buffer_load_dwordx4 v[112:115], v0, s[24:27], s60 offen sc1
    v_mfma_f32_16x16x32_bf16 a[0:3], v[52:55], v[136:139], a[0:3]
    v_mfma_f32_16x16x32_bf16 a[24:27], v[56:59], v[136:139], a[24:27]
    v_mfma_f32_16x16x32_bf16 a[48:51], v[60:63], v[136:139], a[48:51]
    buffer_load_dwordx4 v[116:119], v1, s[24:27], s60 offen sc1
    v_mfma_f32_16x16x32_bf16 v[236:239], v[48:51], v[140:143], v[236:239]
    v_mfma_f32_16x16x32_bf16 a[4:7], v[52:55], v[140:143], a[4:7]
    v_mfma_f32_16x16x32_bf16 a[28:31], v[56:59], v[140:143], a[28:31]
    v_mfma_f32_16x16x32_bf16 a[52:55], v[60:63], v[140:143], a[52:55]
    buffer_load_dwordx4 v[120:123], v2, s[24:27], s60 offen sc1
    v_mfma_f32_16x16x32_bf16 v[240:243], v[48:51], v[144:147], v[240:243]
    v_mfma_f32_16x16x32_bf16 a[8:11], v[52:55], v[144:147], a[8:11]
    v_mfma_f32_16x16x32_bf16 a[32:35], v[56:59], v[144:147], a[32:35]
    v_mfma_f32_16x16x32_bf16 a[56:59], v[60:63], v[144:147], a[56:59]
    buffer_load_dwordx4 v[124:127], v3, s[24:27], s60 offen sc1
    v_mfma_f32_16x16x32_bf16 v[244:247], v[48:51], v[148:151], v[244:247]
    v_mfma_f32_16x16x32_bf16 a[12:15], v[52:55], v[148:151], a[12:15]
    v_mfma_f32_16x16x32_bf16 a[36:39], v[56:59], v[148:151], a[36:39]
    v_mfma_f32_16x16x32_bf16 a[60:63], v[60:63], v[148:151], a[60:63]
    buffer_load_dwordx4 v[128:131], v4, s[24:27], s60 offen sc1
    v_mfma_f32_16x16x32_bf16 v[248:251], v[48:51], v[152:155], v[248:251]
    v_mfma_f32_16x16x32_bf16 a[16:19], v[52:55], v[152:155], a[16:19]
    v_mfma_f32_16x16x32_bf16 a[40:43], v[56:59], v[152:155], a[40:43]
    v_mfma_f32_16x16x32_bf16 a[64:67], v[60:63], v[152:155], a[64:67]
    buffer_load_dwordx4 v[132:135], v5, s[24:27], s60 offen sc1
    v_mfma_f32_16x16x32_bf16 v[252:255], v[48:51], v[156:159], v[252:255]
    v_mfma_f32_16x16x32_bf16 a[20:23], v[52:55], v[156:159], a[20:23]
    v_mfma_f32_16x16x32_bf16 a[44:47], v[56:59], v[156:159], a[44:47]
    v_mfma_f32_16x16x32_bf16 a[68:71], v[60:63], v[156:159], a[68:71]
    s_waitcnt vmcnt(18)
    s_add_u32 s60, s94, 31744
    s_and_b32 s60, s60, 32767
    v_mfma_f32_16x16x32_bf16 v[232:235], a[224:227], v[160:163], v[232:235]
    buffer_load_dwordx4 v[136:139], v0, s[24:27], s60 offen sc1
    v_mfma_f32_16x16x32_bf16 a[0:3], a[228:231], v[160:163], a[0:3]
    s_mul_i32 s52, s45, 221184
    s_mul_i32 s53, s4, 1152
    s_add_u32 s52, s52, s53
    v_mfma_f32_16x16x32_bf16 a[24:27], a[232:235], v[160:163], a[24:27]
    s_lshl_b32 s53, s44, 7
    s_add_u32 s52, s52, s53
    s_lshl_b32 s53, s3, 5
    v_mfma_f32_16x16x32_bf16 a[48:51], a[236:239], v[160:163], a[48:51]
    buffer_load_dwordx4 v[140:143], v1, s[24:27], s60 offen sc1
    v_mfma_f32_16x16x32_bf16 v[236:239], a[224:227], v[164:167], v[236:239]
    s_add_u32 s88, s52, s53
    s_add_u32 s89, s88, 36864
    s_add_u32 s90, s88, 73728
    v_mfma_f32_16x16x32_bf16 a[4:7], a[228:231], v[164:167], a[4:7]
    s_add_u32 s91, s88, 110592
    s_add_u32 s92, s88, 147456
    s_add_u32 s93, s88, 184320
    v_mfma_f32_16x16x32_bf16 a[28:31], a[232:235], v[164:167], a[28:31]
    v_mfma_f32_16x16x32_bf16 a[52:55], a[236:239], v[164:167], a[52:55]
    buffer_load_dwordx4 v[144:147], v2, s[24:27], s60 offen sc1
    v_mfma_f32_16x16x32_bf16 v[240:243], a[224:227], v[168:171], v[240:243]
    v_mfma_f32_16x16x32_bf16 a[8:11], a[228:231], v[168:171], a[8:11]
    v_mfma_f32_16x16x32_bf16 a[32:35], a[232:235], v[168:171], a[32:35]
    v_mfma_f32_16x16x32_bf16 a[56:59], a[236:239], v[168:171], a[56:59]
    buffer_load_dwordx4 v[148:151], v3, s[24:27], s60 offen sc1
    v_mfma_f32_16x16x32_bf16 v[244:247], a[224:227], v[172:175], v[244:247]
    v_mfma_f32_16x16x32_bf16 a[12:15], a[228:231], v[172:175], a[12:15]
    v_mfma_f32_16x16x32_bf16 a[36:39], a[232:235], v[172:175], a[36:39]
    v_mfma_f32_16x16x32_bf16 a[60:63], a[236:239], v[172:175], a[60:63]
    buffer_load_dwordx4 v[152:155], v4, s[24:27], s60 offen sc1
    v_mfma_f32_16x16x32_bf16 v[248:251], a[224:227], v[176:179], v[248:251]
    v_mfma_f32_16x16x32_bf16 a[16:19], a[228:231], v[176:179], a[16:19]
    v_mfma_f32_16x16x32_bf16 a[40:43], a[232:235], v[176:179], a[40:43]
    v_mfma_f32_16x16x32_bf16 a[64:67], a[236:239], v[176:179], a[64:67]
    buffer_load_dwordx4 v[156:159], v5, s[24:27], s60 offen sc1
    v_mfma_f32_16x16x32_bf16 v[252:255], a[224:227], v[180:183], v[252:255]
    v_mfma_f32_16x16x32_bf16 a[20:23], a[228:231], v[180:183], a[20:23]
    v_mfma_f32_16x16x32_bf16 a[44:47], a[232:235], v[180:183], a[44:47]
    v_mfma_f32_16x16x32_bf16 a[68:71], a[236:239], v[180:183], a[68:71]
    s_waitcnt vmcnt(18)
    v_mfma_f32_16x16x32_bf16 v[232:235], a[240:243], v[184:187], v[232:235]
    v_mfma_f32_16x16x32_bf16 a[0:3], a[244:247], v[184:187], a[0:3]
    v_mfma_f32_16x16x32_bf16 a[24:27], a[248:251], v[184:187], a[24:27]
    v_mfma_f32_16x16x32_bf16 a[48:51], a[252:255], v[184:187], a[48:51]
    v_mfma_f32_16x16x32_bf16 v[236:239], a[240:243], v[188:191], v[236:239]
    v_mfma_f32_16x16x32_bf16 a[4:7], a[244:247], v[188:191], a[4:7]
    v_mfma_f32_16x16x32_bf16 a[28:31], a[248:251], v[188:191], a[28:31]
    v_mfma_f32_16x16x32_bf16 a[52:55], a[252:255], v[188:191], a[52:55]
    v_mfma_f32_16x16x32_bf16 v[240:243], a[240:243], v[192:195], v[240:243]
    v_mfma_f32_16x16x32_bf16 a[8:11], a[244:247], v[192:195], a[8:11]
    v_mfma_f32_16x16x32_bf16 a[32:35], a[248:251], v[192:195], a[32:35]
    v_mfma_f32_16x16x32_bf16 a[56:59], a[252:255], v[192:195], a[56:59]
    v_mfma_f32_16x16x32_bf16 v[244:247], a[240:243], v[196:199], v[244:247]
    v_mfma_f32_16x16x32_bf16 a[12:15], a[244:247], v[196:199], a[12:15]
    v_mfma_f32_16x16x32_bf16 a[36:39], a[248:251], v[196:199], a[36:39]
    v_mfma_f32_16x16x32_bf16 a[60:63], a[252:255], v[196:199], a[60:63]
    v_mfma_f32_16x16x32_bf16 v[248:251], a[240:243], v[200:203], v[248:251]
    v_mfma_f32_16x16x32_bf16 a[16:19], a[244:247], v[200:203], a[16:19]
    v_mfma_f32_16x16x32_bf16 a[40:43], a[248:251], v[200:203], a[40:43]
    v_mfma_f32_16x16x32_bf16 a[64:67], a[252:255], v[200:203], a[64:67]
    v_mfma_f32_16x16x32_bf16 v[252:255], a[240:243], v[204:207], v[252:255]
    v_mfma_f32_16x16x32_bf16 a[20:23], a[244:247], v[204:207], a[20:23]
    v_mfma_f32_16x16x32_bf16 a[44:47], a[248:251], v[204:207], a[44:47]
    v_mfma_f32_16x16x32_bf16 a[68:71], a[252:255], v[204:207], a[68:71]
    s_waitcnt vmcnt(12)
    v_mfma_f32_16x16x32_bf16 v[232:235], a[80:83], v[208:211], v[232:235]
    v_mfma_f32_16x16x32_bf16 a[0:3], a[84:87], v[208:211], a[0:3]
    v_mfma_f32_16x16x32_bf16 a[24:27], a[88:91], v[208:211], a[24:27]
    v_mfma_f32_16x16x32_bf16 a[48:51], a[92:95], v[208:211], a[48:51]
    v_mfma_f32_16x16x32_bf16 v[236:239], a[80:83], v[212:215], v[236:239]
    v_mfma_f32_16x16x32_bf16 a[4:7], a[84:87], v[212:215], a[4:7]
    v_mfma_f32_16x16x32_bf16 a[28:31], a[88:91], v[212:215], a[28:31]
    v_mfma_f32_16x16x32_bf16 a[52:55], a[92:95], v[212:215], a[52:55]
    v_mfma_f32_16x16x32_bf16 v[240:243], a[80:83], v[216:219], v[240:243]
    v_mfma_f32_16x16x32_bf16 a[8:11], a[84:87], v[216:219], a[8:11]
    v_mfma_f32_16x16x32_bf16 a[32:35], a[88:91], v[216:219], a[32:35]
    v_mfma_f32_16x16x32_bf16 a[56:59], a[92:95], v[216:219], a[56:59]
    v_mfma_f32_16x16x32_bf16 v[244:247], a[80:83], v[220:223], v[244:247]
    v_mfma_f32_16x16x32_bf16 a[12:15], a[84:87], v[220:223], a[12:15]
    v_mfma_f32_16x16x32_bf16 a[36:39], a[88:91], v[220:223], a[36:39]
    v_mfma_f32_16x16x32_bf16 a[60:63], a[92:95], v[220:223], a[60:63]
    v_mfma_f32_16x16x32_bf16 v[248:251], a[80:83], v[224:227], v[248:251]
    v_mfma_f32_16x16x32_bf16 a[16:19], a[84:87], v[224:227], a[16:19]
    v_mfma_f32_16x16x32_bf16 a[40:43], a[88:91], v[224:227], a[40:43]
    v_mfma_f32_16x16x32_bf16 a[64:67], a[92:95], v[224:227], a[64:67]
    v_mfma_f32_16x16x32_bf16 v[252:255], a[80:83], v[228:231], v[252:255]
    v_mfma_f32_16x16x32_bf16 a[20:23], a[84:87], v[228:231], a[20:23]
    v_mfma_f32_16x16x32_bf16 a[44:47], a[88:91], v[228:231], a[44:47]
    v_mfma_f32_16x16x32_bf16 a[68:71], a[92:95], v[228:231], a[68:71]
    s_waitcnt vmcnt(6)
    v_mfma_f32_16x16x32_bf16 v[232:235], a[96:99], v[112:115], v[232:235]
    v_mfma_f32_16x16x32_bf16 a[0:3], a[100:103], v[112:115], a[0:3]
    v_mfma_f32_16x16x32_bf16 a[24:27], a[104:107], v[112:115], a[24:27]
    v_mfma_f32_16x16x32_bf16 a[48:51], a[108:111], v[112:115], a[48:51]
    v_mfma_f32_16x16x32_bf16 v[236:239], a[96:99], v[116:119], v[236:239]
    v_mfma_f32_16x16x32_bf16 a[4:7], a[100:103], v[116:119], a[4:7]
    v_mfma_f32_16x16x32_bf16 a[28:31], a[104:107], v[116:119], a[28:31]
    v_mfma_f32_16x16x32_bf16 a[52:55], a[108:111], v[116:119], a[52:55]
    v_mfma_f32_16x16x32_bf16 v[240:243], a[96:99], v[120:123], v[240:243]
    v_mfma_f32_16x16x32_bf16 a[8:11], a[100:103], v[120:123], a[8:11]
    v_mfma_f32_16x16x32_bf16 a[32:35], a[104:107], v[120:123], a[32:35]
    v_mfma_f32_16x16x32_bf16 a[56:59], a[108:111], v[120:123], a[56:59]
    v_mfma_f32_16x16x32_bf16 v[244:247], a[96:99], v[124:127], v[244:247]
    v_mfma_f32_16x16x32_bf16 a[12:15], a[100:103], v[124:127], a[12:15]
    v_mfma_f32_16x16x32_bf16 a[36:39], a[104:107], v[124:127], a[36:39]
    v_mfma_f32_16x16x32_bf16 a[60:63], a[108:111], v[124:127], a[60:63]
    v_mfma_f32_16x16x32_bf16 v[248:251], a[96:99], v[128:131], v[248:251]
    v_mfma_f32_16x16x32_bf16 a[16:19], a[100:103], v[128:131], a[16:19]
    v_mfma_f32_16x16x32_bf16 a[40:43], a[104:107], v[128:131], a[40:43]
    v_mfma_f32_16x16x32_bf16 a[64:67], a[108:111], v[128:131], a[64:67]
    v_mfma_f32_16x16x32_bf16 v[252:255], a[96:99], v[132:135], v[252:255]
    v_mfma_f32_16x16x32_bf16 a[20:23], a[100:103], v[132:135], a[20:23]
    v_mfma_f32_16x16x32_bf16 a[44:47], a[104:107], v[132:135], a[44:47]
    v_mfma_f32_16x16x32_bf16 a[68:71], a[108:111], v[132:135], a[68:71]
    s_waitcnt vmcnt(0)
    v_mfma_f32_16x16x32_bf16 a[0:3], a[116:119], v[136:139], a[0:3]
    v_mfma_f32_16x16x32_bf16 a[4:7], a[116:119], v[140:143], a[4:7]
    v_mfma_f32_16x16x32_bf16 a[8:11], a[116:119], v[144:147], a[8:11]
    v_mfma_f32_16x16x32_bf16 a[12:15], a[116:119], v[148:151], a[12:15]
    v_mfma_f32_16x16x32_bf16 a[16:19], a[116:119], v[152:155], a[16:19]
    v_mfma_f32_16x16x32_bf16 a[20:23], a[116:119], v[156:159], a[20:23]
    v_mfma_f32_16x16x32_bf16 a[24:27], a[120:123], v[136:139], a[24:27]
    v_mfma_f32_16x16x32_bf16 a[28:31], a[120:123], v[140:143], a[28:31]
    v_mfma_f32_16x16x32_bf16 a[32:35], a[120:123], v[144:147], a[32:35]
    ds_write_b128 v14, a[0:3] offset:0
    v_mfma_f32_16x16x32_bf16 a[36:39], a[120:123], v[148:151], a[36:39]
    ds_write_b128 v14, a[4:7] offset:1024
    v_mfma_f32_16x16x32_bf16 a[40:43], a[120:123], v[152:155], a[40:43]
    ds_write_b128 v14, a[8:11] offset:2048
    v_mfma_f32_16x16x32_bf16 a[44:47], a[120:123], v[156:159], a[44:47]
    ds_write_b128 v14, a[12:15] offset:3072
    v_mfma_f32_16x16x32_bf16 a[48:51], a[124:127], v[136:139], a[48:51]
    ds_write_b128 v14, a[16:19] offset:16384
    v_mfma_f32_16x16x32_bf16 a[52:55], a[124:127], v[140:143], a[52:55]
    ds_write_b128 v14, a[20:23] offset:17408
    v_mfma_f32_16x16x32_bf16 a[56:59], a[124:127], v[144:147], a[56:59]
    ds_write_b128 v14, a[24:27] offset:32768
    v_mfma_f32_16x16x32_bf16 a[60:63], a[124:127], v[148:151], a[60:63]
    ds_write_b128 v14, a[28:31] offset:33792
    v_mfma_f32_16x16x32_bf16 a[64:67], a[124:127], v[152:155], a[64:67]
    ds_write_b128 v14, a[32:35] offset:34816
    v_mfma_f32_16x16x32_bf16 a[68:71], a[124:127], v[156:159], a[68:71]
    ds_write_b128 v14, a[36:39] offset:35840
    v_mfma_f32_16x16x32_bf16 v[232:235], a[112:115], v[136:139], v[232:235]
    ds_write_b128 v14, a[40:43] offset:49152
    v_mfma_f32_16x16x32_bf16 v[236:239], a[112:115], v[140:143], v[236:239]
    ds_write_b128 v14, a[44:47] offset:50176
    v_mfma_f32_16x16x32_bf16 v[240:243], a[112:115], v[144:147], v[240:243]
    ds_write_b128 v15, a[48:51] offset:0
    v_mfma_f32_16x16x32_bf16 v[244:247], a[112:115], v[148:151], v[244:247]
    ds_write_b128 v15, a[52:55] offset:1024
    v_mfma_f32_16x16x32_bf16 v[248:251], a[112:115], v[152:155], v[248:251]
    ds_write_b128 v15, a[56:59] offset:2048
    v_mfma_f32_16x16x32_bf16 v[252:255], a[112:115], v[156:159], v[252:255]
    ds_write_b128 v15, a[60:63] offset:3072
    ds_write_b128 v15, a[64:67] offset:16384
    ds_write_b128 v15, a[68:71] offset:17408
    s_mov_b64 exec, 1
    v_mov_b32 v30, s47
    ds_write_b32 v29, v30
    s_mov_b64 exec, -1
    s_waitcnt lgkmcnt(0)
    s_barrier
    ds_read_b32 v30, v29
    ds_read_b128 v[32:35], v18 offset:0
    ds_read_b128 v[36:39], v19 offset:0
    ds_read_b128 v[40:43], v20 offset:0
    ds_read_b128 v[44:47], v18 offset:1024
    ds_read_b128 v[48:51], v19 offset:1024
    ds_read_b128 v[52:55], v20 offset:1024
    ds_read_b128 v[56:59], v18 offset:2048
    ds_read_b128 v[60:63], v19 offset:2048
    ds_read_b128 v[64:67], v20 offset:2048
    ds_read_b128 v[68:71], v18 offset:3072
    ds_read_b128 v[72:75], v19 offset:3072
    ds_read_b128 v[76:79], v20 offset:3072
    ds_read_b128 v[80:83], v18 offset:16384
    ds_read_b128 v[84:87], v19 offset:16384
    ds_read_b128 v[88:91], v20 offset:16384
    ds_read_b128 v[92:95], v18 offset:17408
    ds_read_b128 v[96:99], v19 offset:17408
    ds_read_b128 v[100:103], v20 offset:17408
    s_waitcnt lgkmcnt(15)
    v_readlane_b32 s53, v30, 1
    v_readlane_b32 s54, v30, 2
    v_readlane_b32 s55, v30, 3
    s_or_b32 s82, s82, s47
    s_or_b32 s53, s53, s54
    s_or_b32 s82, s82, s55
    s_or_b32 s82, s82, s53
    s_cmp_gt_u32 s82, 0x7ffffff
    s_cbranch_scc1 L_bad
    v_pk_add_f32 v[232:233], v[232:233], v[32:33]
    v_pk_add_f32 v[234:235], v[234:235], v[34:35]
    v_pk_add_f32 v[36:37], v[36:37], v[40:41]
    v_pk_add_f32 v[38:39], v[38:39], v[42:43]
    v_pk_add_f32 v[232:233], v[232:233], v[36:37]
    v_pk_add_f32 v[234:235], v[234:235], v[38:39]
    v_cvt_pk_bf16_f32 v32, v232, v233
    v_cvt_pk_bf16_f32 v33, v234, v235
    buffer_store_dwordx2 v[32:33], v22, s[28:31], s88 offen
    s_waitcnt lgkmcnt(14)
    v_pk_add_f32 v[236:237], v[236:237], v[44:45]
    v_pk_add_f32 v[238:239], v[238:239], v[46:47]
    s_waitcnt lgkmcnt(12)
    v_pk_add_f32 v[48:49], v[48:49], v[52:53]
    v_pk_add_f32 v[50:51], v[50:51], v[54:55]
    v_pk_add_f32 v[236:237], v[236:237], v[48:49]
    v_pk_add_f32 v[238:239], v[238:239], v[50:51]
    v_cvt_pk_bf16_f32 v44, v236, v237
    v_cvt_pk_bf16_f32 v45, v238, v239
    buffer_store_dwordx2 v[44:45], v22, s[28:31], s89 offen
    s_waitcnt lgkmcnt(11)
    v_pk_add_f32 v[240:241], v[240:241], v[56:57]
    v_pk_add_f32 v[242:243], v[242:243], v[58:59]
    s_waitcnt lgkmcnt(9)
    v_pk_add_f32 v[60:61], v[60:61], v[64:65]
    v_pk_add_f32 v[62:63], v[62:63], v[66:67]
    v_pk_add_f32 v[240:241], v[240:241], v[60:61]
    v_pk_add_f32 v[242:243], v[242:243], v[62:63]
    v_cvt_pk_bf16_f32 v56, v240, v241
    v_cvt_pk_bf16_f32 v57, v242, v243
    buffer_store_dwordx2 v[56:57], v22, s[28:31], s90 offen
    s_waitcnt lgkmcnt(8)
    v_pk_add_f32 v[244:245], v[244:245], v[68:69]
    v_pk_add_f32 v[246:247], v[246:247], v[70:71]
    s_waitcnt lgkmcnt(6)
    v_pk_add_f32 v[72:73], v[72:73], v[76:77]
    v_pk_add_f32 v[74:75], v[74:75], v[78:79]
    v_pk_add_f32 v[244:245], v[244:245], v[72:73]
    v_pk_add_f32 v[246:247], v[246:247], v[74:75]
    v_cvt_pk_bf16_f32 v68, v244, v245
    v_cvt_pk_bf16_f32 v69, v246, v247
    buffer_store_dwordx2 v[68:69], v22, s[28:31], s91 offen
    s_waitcnt lgkmcnt(5)
    v_pk_add_f32 v[248:249], v[248:249], v[80:81]
    v_pk_add_f32 v[250:251], v[250:251], v[82:83]
    s_waitcnt lgkmcnt(3)
    v_pk_add_f32 v[84:85], v[84:85], v[88:89]
    v_pk_add_f32 v[86:87], v[86:87], v[90:91]
    v_pk_add_f32 v[248:249], v[248:249], v[84:85]
    v_pk_add_f32 v[250:251], v[250:251], v[86:87]
    v_cvt_pk_bf16_f32 v80, v248, v249
    v_cvt_pk_bf16_f32 v81, v250, v251
    buffer_store_dwordx2 v[80:81], v22, s[28:31], s92 offen
    s_waitcnt lgkmcnt(2)
    v_pk_add_f32 v[252:253], v[252:253], v[92:93]
    v_pk_add_f32 v[254:255], v[254:255], v[94:95]
    s_waitcnt lgkmcnt(0)
    v_pk_add_f32 v[96:97], v[96:97], v[100:101]
    v_pk_add_f32 v[98:99], v[98:99], v[102:103]
    v_pk_add_f32 v[252:253], v[252:253], v[96:97]
    v_pk_add_f32 v[254:255], v[254:255], v[98:99]
    v_cvt_pk_bf16_f32 v92, v252, v253
    v_cvt_pk_bf16_f32 v93, v254, v255
    buffer_store_dwordx2 v[92:93], v22, s[28:31], s93 offen
L_next:
    s_waitcnt vmcnt(0)
    s_and_b32 s82, s82, 0x7ffffff
    s_cbranch_scc0 L_exit
    s_ff1_i32_b32 s83, s82
    s_bitset0_b32 s82, s83
    s_lshr_b32 s84, s6, 1
L_again:
    s_waitcnt vmcnt(0) lgkmcnt(0)
    s_barrier
    s_mov_b32 s47, 0
    s_mul_i32 s44, s83, 43
    s_lshr_b32 s44, s44, 7
    s_mul_i32 s52, s44, 3
    s_sub_u32 s56, s83, s52
    s_mul_i32 s45, s84, 3
    s_add_u32 s45, s45, s56
    s_mul_i32 s52, s4, 72
    s_mul_i32 s53, s45, 6
    s_add_u32 s52, s52, s53
    s_lshl_b32 s52, s52, 17
    s_add_u32 s24, s16, s52
    s_addc_u32 s25, s17, 0
    s_mov_b32 s26, 786432
    s_mul_i32 s52, s83, 43
    s_and_b32 s52, s52, 0xff80
    s_mul_i32 s94, s52, 0
    s_mul_i32 s95, s83, 0
    s_add_u32 s94, s94, s95
    s_and_b32 s95, s52, 1920
    s_mul_i32 s95, s95, 0
    s_add_u32 s94, s94, s95
    s_and_b32 s94, s94, 32767
    s_mul_i32 s95, s94, 36
    s_add_u32 s20, s18, s52
    s_addc_u32 s21, s19, 0
    s_sub_u32 s22, 4718592, s52
    s_cmp_lt_u32 s83, 27
    s_cselect_b32 s22, s22, 0
    v_lshrrev_b32 v11, 5, v10
    v_lshlrev_b32 v11, 10, v11
    v_bfe_u32 v12, v10, 2, 3
    v_lshl_add_u32 v11, v12, 7, v11
    v_and_b32 v12, 3, v10
    v_lshl_add_u32 v11, v12, 3, v11
    v_add_u32 v11, s81, v11
    v_bfe_u32 v12, v10, 3, 2
    v_xor_b32 v12, s3, v12
    v_lshl_add_u32 v14, v12, 5, v11
    v_xor_b32 v15, 32, v14
    v_xor_b32 v16, 64, v14
    v_xor_b32 v17, 96, v14
    v_xor_b32 v18, 65536, v14
    v_xor_b32 v19, 65568, v14
    v_xor_b32 v20, 65600, v14
    v_xor_b32 v21, 65632, v14
    v_xor_b32 v22, 131072, v14
    v_xor_b32 v23, 131104, v14
    v_xor_b32 v24, 131136, v14
    v_xor_b32 v25, 131168, v14
    s_add_u32 s63, s94, 0
    s_and_b32 s63, s63, 32767
    s_add_u32 m0, s81, 131072
    s_mul_i32 s63, s63, 36
    buffer_load_dwordx4 v6, s[20:23], s63 offen offset:0 lds
    buffer_load_dwordx4 v7, s[20:23], s63 offen offset:1024 lds
    buffer_load_dwordx4 v8, s[20:23], s63 offen offset:2048 lds
    buffer_load_dwordx4 v9, s[20:23], s63 offen offset:3072 lds
    s_waitcnt vmcnt(0)
    ds_read_b64_tr_b16 v[96:97], v22 offset:0
    ds_read_b64_tr_b16 v[98:99], v22 offset:2048
    ds_read_b64_tr_b16 v[100:101], v23 offset:0
    ds_read_b64_tr_b16 v[102:103], v23 offset:2048
    ds_read_b64_tr_b16 v[104:105], v24 offset:0
    ds_read_b64_tr_b16 v[106:107], v24 offset:2048
    ds_read_b64_tr_b16 v[108:109], v25 offset:0
    ds_read_b64_tr_b16 v[110:111], v25 offset:2048
    s_waitcnt lgkmcnt(0)
    s_add_u32 s63, s94, 1024
    s_and_b32 s63, s63, 32767
    s_add_u32 m0, s81, 147456
    s_mul_i32 s63, s63, 36
    buffer_load_dwordx4 v6, s[20:23], s63 offen offset:0 lds
    buffer_load_dwordx4 v7, s[20:23], s63 offen offset:1024 lds
    buffer_load_dwordx4 v8, s[20:23], s63 offen offset:2048 lds
    buffer_load_dwordx4 v9, s[20:23], s63 offen offset:3072 lds
    s_waitcnt vmcnt(0)
    ds_read_b64_tr_b16 v[64:65], v22 offset:16384
    ds_read_b64_tr_b16 v[66:67], v22 offset:18432
    ds_read_b64_tr_b16 v[68:69], v23 offset:16384
    ds_read_b64_tr_b16 v[70:71], v23 offset:18432
    ds_read_b64_tr_b16 v[72:73], v24 offset:16384
    ds_read_b64_tr_b16 v[74:75], v24 offset:18432
    ds_read_b64_tr_b16 v[76:77], v25 offset:16384
    ds_read_b64_tr_b16 v[78:79], v25 offset:18432
    s_waitcnt lgkmcnt(0)
    s_add_u32 s63, s94, 2048
    s_and_b32 s63, s63, 32767
    s_add_u32 m0, s81, 0
    s_mul_i32 s63, s63, 36
    buffer_load_dwordx4 v6, s[20:23], s63 offen offset:0 lds
    buffer_load_dwordx4 v7, s[20:23], s63 offen offset:1024 lds
    buffer_load_dwordx4 v8, s[20:23], s63 offen offset:2048 lds
    buffer_load_dwordx4 v9, s[20:23], s63 offen offset:3072 lds
    s_waitcnt vmcnt(0)
    ds_read_b64_tr_b16 v[80:81], v14 offset:0
    ds_read_b64_tr_b16 v[82:83], v14 offset:2048
    ds_read_b64_tr_b16 v[84:85], v15 offset:0
    ds_read_b64_tr_b16 v[86:87], v15 offset:2048
    ds_read_b64_tr_b16 v[88:89], v16 offset:0
    ds_read_b64_tr_b16 v[90:91], v16 offset:2048
    ds_read_b64_tr_b16 v[92:93], v17 offset:0
    ds_read_b64_tr_b16 v[94:95], v17 offset:2048
    s_waitcnt lgkmcnt(0)
    s_add_u32 s63, s94, 3072
    s_and_b32 s63, s63, 32767
    s_add_u32 m0, s81, 65536
    s_mul_i32 s63, s63, 36
    buffer_load_dwordx4 v6, s[20:23], s63 offen offset:0 lds
    buffer_load_dwordx4 v7, s[20:23], s63 offen offset:1024 lds
    buffer_load_dwordx4 v8, s[20:23], s63 offen offset:2048 lds
    buffer_load_dwordx4 v9, s[20:23], s63 offen offset:3072 lds
    s_waitcnt vmcnt(0)
    ds_read_b64_tr_b16 a[192:193], v18 offset:0
    ds_read_b64_tr_b16 a[194:195], v18 offset:2048
    ds_read_b64_tr_b16 a[196:197], v19 offset:0
    ds_read_b64_tr_b16 a[198:199], v19 offset:2048
    ds_read_b64_tr_b16 a[200:201], v20 offset:0
    ds_read_b64_tr_b16 a[202:203], v20 offset:2048
    ds_read_b64_tr_b16 a[204:205], v21 offset:0
    ds_read_b64_tr_b16 a[206:207], v21 offset:2048
    s_waitcnt lgkmcnt(0)
    s_add_u32 s63, s94, 4096
    s_and_b32 s63, s63, 32767
    s_add_u32 m0, s81, 16384
    s_mul_i32 s63, s63, 36
    buffer_load_dwordx4 v6, s[20:23], s63 offen offset:0 lds
    buffer_load_dwordx4 v7, s[20:23], s63 offen offset:1024 lds
    buffer_load_dwordx4 v8, s[20:23], s63 offen offset:2048 lds
    buffer_load_dwordx4 v9, s[20:23], s63 offen offset:3072 lds
    s_waitcnt vmcnt(0)
    ds_read_b64_tr_b16 a[208:209], v14 offset:16384
    ds_read_b64_tr_b16 a[210:211], v14 offset:18432
    ds_read_b64_tr_b16 a[212:213], v15 offset:16384
    ds_read_b64_tr_b16 a[214:215], v15 offset:18432
    ds_read_b64_tr_b16 a[216:217], v16 offset:16384
    ds_read_b64_tr_b16 a[218:219], v16 offset:18432
    ds_read_b64_tr_b16 a[220:221], v17 offset:16384
    ds_read_b64_tr_b16 a[222:223], v17 offset:18432
    s_waitcnt lgkmcnt(0)
    s_add_u32 s63, s94, 5120
    s_and_b32 s63, s63, 32767
    s_add_u32 m0, s81, 81920
    s_mul_i32 s63, s63, 36
    buffer_load_dwordx4 v6, s[20:23], s63 offen offset:0 lds
    buffer_load_dwordx4 v7, s[20:23], s63 offen offset:1024 lds
    buffer_load_dwordx4 v8, s[20:23], s63 offen offset:2048 lds
    buffer_load_dwordx4 v9, s[20:23], s63 offen offset:3072 lds
    s_waitcnt vmcnt(0)
    ds_read_b64_tr_b16 a[128:129], v18 offset:16384
    ds_read_b64_tr_b16 a[130:131], v18 offset:18432
    ds_read_b64_tr_b16 a[132:133], v19 offset:16384
    ds_read_b64_tr_b16 a[134:135], v19 offset:18432
    ds_read_b64_tr_b16 a[136:137], v20 offset:16384
    ds_read_b64_tr_b16 a[138:139], v20 offset:18432
    ds_read_b64_tr_b16 a[140:141], v21 offset:16384
    ds_read_b64_tr_b16 a[142:143], v21 offset:18432
    s_waitcnt lgkmcnt(0)
    s_add_u32 s63, s94, 6144
    s_and_b32 s63, s63, 32767
    s_add_u32 m0, s81, 32768
    s_mul_i32 s63, s63, 36
    buffer_load_dwordx4 v6, s[20:23], s63 offen offset:0 lds
    buffer_load_dwordx4 v7, s[20:23], s63 offen offset:1024 lds
    buffer_load_dwordx4 v8, s[20:23], s63 offen offset:2048 lds
    buffer_load_dwordx4 v9, s[20:23], s63 offen offset:3072 lds
    s_waitcnt vmcnt(0)
    ds_read_b64_tr_b16 a[144:145], v14 offset:32768
    ds_read_b64_tr_b16 a[146:147], v14 offset:34816
    ds_read_b64_tr_b16 a[148:149], v15 offset:32768
    ds_read_b64_tr_b16 a[150:151], v15 offset:34816
    ds_read_b64_tr_b16 a[152:153], v16 offset:32768
    ds_read_b64_tr_b16 a[154:155], v16 offset:34816
    ds_read_b64_tr_b16 a[156:157], v17 offset:32768
    ds_read_b64_tr_b16 a[158:159], v17 offset:34816
    s_waitcnt lgkmcnt(0)
    s_add_u32 s63, s94, 7168
    s_and_b32 s63, s63, 32767
    s_add_u32 m0, s81, 98304
    s_mul_i32 s63, s63, 36
    buffer_load_dwordx4 v6, s[20:23], s63 offen offset:0 lds
    buffer_load_dwordx4 v7, s[20:23], s63 offen offset:1024 lds
    buffer_load_dwordx4 v8, s[20:23], s63 offen offset:2048 lds
    buffer_load_dwordx4 v9, s[20:23], s63 offen offset:3072 lds
    s_waitcnt vmcnt(0)
    ds_read_b64_tr_b16 a[160:161], v18 offset:32768
    ds_read_b64_tr_b16 a[162:163], v18 offset:34816
    ds_read_b64_tr_b16 a[164:165], v19 offset:32768
    ds_read_b64_tr_b16 a[166:167], v19 offset:34816
    ds_read_b64_tr_b16 a[168:169], v20 offset:32768
    ds_read_b64_tr_b16 a[170:171], v20 offset:34816
    ds_read_b64_tr_b16 a[172:173], v21 offset:32768
    ds_read_b64_tr_b16 a[174:175], v21 offset:34816
    s_waitcnt lgkmcnt(0)
    s_add_u32 s63, s94, 8192
    s_and_b32 s63, s63, 32767
    s_add_u32 m0, s81, 0
    s_mul_i32 s63, s63, 36
    buffer_load_dwordx4 v6, s[20:23], s63 offen offset:0 lds
    buffer_load_dwordx4 v7, s[20:23], s63 offen offset:1024 lds
    buffer_load_dwordx4 v8, s[20:23], s63 offen offset:2048 lds
    buffer_load_dwordx4 v9, s[20:23], s63 offen offset:3072 lds
    s_waitcnt vmcnt(0)
    ds_read_b64_tr_b16 a[176:177], v14 offset:0
    ds_read_b64_tr_b16 a[178:179], v14 offset:2048
    ds_read_b64_tr_b16 a[180:181], v15 offset:0
    ds_read_b64_tr_b16 a[182:183], v15 offset:2048
    ds_read_b64_tr_b16 a[184:185], v16 offset:0
    ds_read_b64_tr_b16 a[186:187], v16 offset:2048
    ds_read_b64_tr_b16 a[188:189], v17 offset:0
    ds_read_b64_tr_b16 a[190:191], v17 offset:2048
    s_waitcnt lgkmcnt(0)
    s_add_u32 s63, s94, 9216
    s_and_b32 s63, s63, 32767
    s_add_u32 m0, s81, 65536
    s_mul_i32 s63, s63, 36
    buffer_load_dwordx4 v6, s[20:23], s63 offen offset:0 lds
    buffer_load_dwordx4 v7, s[20:23], s63 offen offset:1024 lds
    buffer_load_dwordx4 v8, s[20:23], s63 offen offset:2048 lds
    buffer_load_dwordx4 v9, s[20:23], s63 offen offset:3072 lds
    s_waitcnt vmcnt(0)
    ds_read_b64_tr_b16 v[32:33], v18 offset:0
    ds_read_b64_tr_b16 v[34:35], v18 offset:2048
    ds_read_b64_tr_b16 v[36:37], v19 offset:0
    ds_read_b64_tr_b16 v[38:39], v19 offset:2048
    ds_read_b64_tr_b16 v[40:41], v20 offset:0
    ds_read_b64_tr_b16 v[42:43], v20 offset:2048
    ds_read_b64_tr_b16 v[44:45], v21 offset:0
    ds_read_b64_tr_b16 v[46:47], v21 offset:2048
    s_waitcnt lgkmcnt(0)
    s_add_u32 s63, s94, 10240
    s_and_b32 s63, s63, 32767
    s_add_u32 m0, s81, 16384
    s_mul_i32 s63, s63, 36
    buffer_load_dwordx4 v6, s[20:23], s63 offen offset:0 lds
    buffer_load_dwordx4 v7, s[20:23], s63 offen offset:1024 lds
    buffer_load_dwordx4 v8, s[20:23], s63 offen offset:2048 lds
    buffer_load_dwordx4 v9, s[20:23], s63 offen offset:3072 lds
    s_waitcnt vmcnt(0)
    ds_read_b64_tr_b16 v[48:49], v14 offset:16384
    ds_read_b64_tr_b16 v[50:51], v14 offset:18432
    ds_read_b64_tr_b16 v[52:53], v15 offset:16384
    ds_read_b64_tr_b16 v[54:55], v15 offset:18432
    ds_read_b64_tr_b16 v[56:57], v16 offset:16384
    ds_read_b64_tr_b16 v[58:59], v16 offset:18432
    ds_read_b64_tr_b16 v[60:61], v17 offset:16384
    ds_read_b64_tr_b16 v[62:63], v17 offset:18432
    s_waitcnt lgkmcnt(0)
    s_add_u32 s63, s94, 11264
    s_and_b32 s63, s63, 32767
    s_add_u32 m0, s81, 81920
    s_mul_i32 s63, s63, 36
    buffer_load_dwordx4 v6, s[20:23], s63 offen offset:0 lds
    buffer_load_dwordx4 v7, s[20:23], s63 offen offset:1024 lds
    buffer_load_dwordx4 v8, s[20:23], s63 offen offset:2048 lds
    buffer_load_dwordx4 v9, s[20:23], s63 offen offset:3072 lds
    s_waitcnt vmcnt(0)
    ds_read_b64_tr_b16 a[224:225], v18 offset:16384
    ds_read_b64_tr_b16 a[226:227], v18 offset:18432
    ds_read_b64_tr_b16 a[228:229], v19 offset:16384
    ds_read_b64_tr_b16 a[230:231], v19 offset:18432
    ds_read_b64_tr_b16 a[232:233], v20 offset:16384
    ds_read_b64_tr_b16 a[234:235], v20 offset:18432
    ds_read_b64_tr_b16 a[236:237], v21 offset:16384
    ds_read_b64_tr_b16 a[238:239], v21 offset:18432
    s_waitcnt lgkmcnt(0)
    s_add_u32 s63, s94, 12288
    s_and_b32 s63, s63, 32767
    s_add_u32 m0, s81, 32768
    s_mul_i32 s63, s63, 36
    buffer_load_dwordx4 v6, s[20:23], s63 offen offset:0 lds
    buffer_load_dwordx4 v7, s[20:23], s63 offen offset:1024 lds
    buffer_load_dwordx4 v8, s[20:23], s63 offen offset:2048 lds
    buffer_load_dwordx4 v9, s[20:23], s63 offen offset:3072 lds
    s_waitcnt vmcnt(0)
    ds_read_b64_tr_b16 a[240:241], v14 offset:32768
    ds_read_b64_tr_b16 a[242:243], v14 offset:34816
    ds_read_b64_tr_b16 a[244:245], v15 offset:32768
    ds_read_b64_tr_b16 a[246:247], v15 offset:34816
    ds_read_b64_tr_b16 a[248:249], v16 offset:32768
    ds_read_b64_tr_b16 a[250:251], v16 offset:34816
    ds_read_b64_tr_b16 a[252:253], v17 offset:32768
    ds_read_b64_tr_b16 a[254:255], v17 offset:34816
    s_waitcnt lgkmcnt(0)
    s_add_u32 s63, s94, 13312
    s_and_b32 s63, s63, 32767
    s_add_u32 m0, s81, 49152
    s_mul_i32 s63, s63, 36
    buffer_load_dwordx4 v6, s[20:23], s63 offen offset:0 lds
    buffer_load_dwordx4 v7, s[20:23], s63 offen offset:1024 lds
    buffer_load_dwordx4 v8, s[20:23], s63 offen offset:2048 lds
    buffer_load_dwordx4 v9, s[20:23], s63 offen offset:3072 lds
    s_waitcnt vmcnt(0)
    ds_read_b64_tr_b16 a[80:81], v14 offset:49152
    ds_read_b64_tr_b16 a[82:83], v14 offset:51200
    ds_read_b64_tr_b16 a[84:85], v15 offset:49152
    ds_read_b64_tr_b16 a[86:87], v15 offset:51200
    ds_read_b64_tr_b16 a[88:89], v16 offset:49152
    ds_read_b64_tr_b16 a[90:91], v16 offset:51200
    ds_read_b64_tr_b16 a[92:93], v17 offset:49152
    ds_read_b64_tr_b16 a[94:95], v17 offset:51200
    s_waitcnt lgkmcnt(0)
    s_add_u32 s63, s94, 14336
    s_and_b32 s63, s63, 32767
    s_add_u32 m0, s81, 114688
    s_mul_i32 s63, s63, 36
    buffer_load_dwordx4 v6, s[20:23], s63 offen offset:0 lds
    buffer_load_dwordx4 v7, s[20:23], s63 offen offset:1024 lds
    buffer_load_dwordx4 v8, s[20:23], s63 offen offset:2048 lds
    buffer_load_dwordx4 v9, s[20:23], s63 offen offset:3072 lds
    s_waitcnt vmcnt(0)
    ds_read_b64_tr_b16 a[96:97], v18 offset:49152
    ds_read_b64_tr_b16 a[98:99], v18 offset:51200
    ds_read_b64_tr_b16 a[100:101], v19 offset:49152
    ds_read_b64_tr_b16 a[102:103], v19 offset:51200
    ds_read_b64_tr_b16 a[104:105], v20 offset:49152
    ds_read_b64_tr_b16 a[106:107], v20 offset:51200
    ds_read_b64_tr_b16 a[108:109], v21 offset:49152
    ds_read_b64_tr_b16 a[110:111], v21 offset:51200
    s_waitcnt lgkmcnt(0)
    s_add_u32 s63, s94, 15360
    s_and_b32 s63, s63, 32767
    s_add_u32 m0, s81, 131072
    s_mul_i32 s63, s63, 36
    buffer_load_dwordx4 v6, s[20:23], s63 offen offset:0 lds
    buffer_load_dwordx4 v7, s[20:23], s63 offen offset:1024 lds
    buffer_load_dwordx4 v8, s[20:23], s63 offen offset:2048 lds
    buffer_load_dwordx4 v9, s[20:23], s63 offen offset:3072 lds
    s_waitcnt vmcnt(0)
    ds_read_b64_tr_b16 a[112:113], v22 offset:0
    ds_read_b64_tr_b16 a[114:115], v22 offset:2048
    ds_read_b64_tr_b16 a[116:117], v23 offset:0
    ds_read_b64_tr_b16 a[118:119], v23 offset:2048
    ds_read_b64_tr_b16 a[120:121], v24 offset:0
    ds_read_b64_tr_b16 a[122:123], v24 offset:2048
    ds_read_b64_tr_b16 a[124:125], v25 offset:0
    ds_read_b64_tr_b16 a[126:127], v25 offset:2048
    s_waitcnt lgkmcnt(0)
    s_add_u32 s63, s94, 16384
    s_and_b32 s63, s63, 32767
    s_add_u32 m0, s81, 147456
    s_mul_i32 s63, s63, 36
    buffer_load_dwordx4 v6, s[20:23], s63 offen offset:0 lds
    buffer_load_dwordx4 v7, s[20:23], s63 offen offset:1024 lds
    buffer_load_dwordx4 v8, s[20:23], s63 offen offset:2048 lds
    buffer_load_dwordx4 v9, s[20:23], s63 offen offset:3072 lds
    s_add_u32 s63, s94, 17408
    s_and_b32 s63, s63, 32767
    s_add_u32 m0, s81, 98304
    s_mul_i32 s63, s63, 36
    buffer_load_dwordx4 v6, s[20:23], s63 offen offset:0 lds
    buffer_load_dwordx4 v7, s[20:23], s63 offen offset:1024 lds
    buffer_load_dwordx4 v8, s[20:23], s63 offen offset:2048 lds
    buffer_load_dwordx4 v9, s[20:23], s63 offen offset:3072 lds
    s_add_u32 s63, s94, 18432
    s_and_b32 s63, s63, 32767
    s_add_u32 m0, s81, 0
    s_mul_i32 s63, s63, 36
    buffer_load_dwordx4 v6, s[20:23], s63 offen offset:0 lds
    buffer_load_dwordx4 v7, s[20:23], s63 offen offset:1024 lds
    buffer_load_dwordx4 v8, s[20:23], s63 offen offset:2048 lds
    buffer_load_dwordx4 v9, s[20:23], s63 offen offset:3072 lds
    s_add_u32 s63, s94, 19456
    s_and_b32 s63, s63, 32767
    s_add_u32 m0, s81, 65536
    s_mul_i32 s63, s63, 36
    buffer_load_dwordx4 v6, s[20:23], s63 offen offset:0 lds
    buffer_load_dwordx4 v7, s[20:23], s63 offen offset:1024 lds
    buffer_load_dwordx4 v8, s[20:23], s63 offen offset:2048 lds
    buffer_load_dwordx4 v9, s[20:23], s63 offen offset:3072 lds
    s_add_u32 s63, s94, 20480
    s_and_b32 s63, s63, 32767
    s_add_u32 m0, s81, 16384
    s_mul_i32 s63, s63, 36
    buffer_load_dwordx4 v6, s[20:23], s63 offen offset:0 lds
    buffer_load_dwordx4 v7, s[20:23], s63 offen offset:1024 lds
    buffer_load_dwordx4 v8, s[20:23], s63 offen offset:2048 lds
    buffer_load_dwordx4 v9, s[20:23], s63 offen offset:3072 lds
    s_add_u32 s63, s94, 21504
    s_and_b32 s63, s63, 32767
    s_add_u32 m0, s81, 81920
    s_mul_i32 s63, s63, 36
    buffer_load_dwordx4 v6, s[20:23], s63 offen offset:0 lds
    buffer_load_dwordx4 v7, s[20:23], s63 offen offset:1024 lds
    buffer_load_dwordx4 v8, s[20:23], s63 offen offset:2048 lds
    buffer_load_dwordx4 v9, s[20:23], s63 offen offset:3072 lds
    s_add_u32 s63, s94, 22528
    s_and_b32 s63, s63, 32767
    s_add_u32 m0, s81, 32768
    s_mul_i32 s63, s63, 36
    buffer_load_dwordx4 v6, s[20:23], s63 offen offset:0 lds
    buffer_load_dwordx4 v7, s[20:23], s63 offen offset:1024 lds
    buffer_load_dwordx4 v8, s[20:23], s63 offen offset:2048 lds
    buffer_load_dwordx4 v9, s[20:23], s63 offen offset:3072 lds
    s_add_u32 s63, s94, 23552
    s_and_b32 s63, s63, 32767
    s_add_u32 m0, s81, 49152
    s_mul_i32 s63, s63, 36
    buffer_load_dwordx4 v6, s[20:23], s63 offen offset:0 lds
    buffer_load_dwordx4 v7, s[20:23], s63 offen offset:1024 lds
    buffer_load_dwordx4 v8, s[20:23], s63 offen offset:2048 lds
    buffer_load_dwordx4 v9, s[20:23], s63 offen offset:3072 lds
    s_add_u32 s63, s94, 24576
    s_and_b32 s63, s63, 32767
    s_add_u32 m0, s81, 114688
    s_mul_i32 s63, s63, 36
    buffer_load_dwordx4 v6, s[20:23], s63 offen offset:0 lds
    buffer_load_dwordx4 v7, s[20:23], s63 offen offset:1024 lds
    buffer_load_dwordx4 v8, s[20:23], s63 offen offset:2048 lds
    buffer_load_dwordx4 v9, s[20:23], s63 offen offset:3072 lds
    s_add_u32 s63, s94, 25600
    s_and_b32 s63, s63, 32767
    s_add_u32 m0, s81, 131072
    s_mul_i32 s63, s63, 36
    buffer_load_dwordx4 v6, s[20:23], s63 offen offset:0 lds
    buffer_load_dwordx4 v7, s[20:23], s63 offen offset:1024 lds
    buffer_load_dwordx4 v8, s[20:23], s63 offen offset:2048 lds
    buffer_load_dwordx4 v9, s[20:23], s63 offen offset:3072 lds
    s_waitcnt vmcnt(0)
    s_branch L_go
L_poll0:
    s_mov_b32 s53, 0
L_poll:
    s_mov_b64 exec, 1
    buffer_load_dword v30, v28, s[40:43], s46 offen sc1
    s_mov_b64 exec, -1
    s_waitcnt vmcnt(0)
    v_readfirstlane_b32 s54, v30
    s_and_b32 s54, s54, s85
    s_cmp_eq_u32 s54, s85
    s_cbranch_scc1 L_go
    s_sleep 8
    s_add_u32 s53, s53, 1
    s_cmp_lt_u32 s53, 4000
    s_cbranch_scc1 L_poll
    s_bitset1_b32 s47, 31
    s_branch L_sync2
L_notile:
    s_waitcnt vmcnt(0)
    v_readfirstlane_b32 s54, v26
    v_readfirstlane_b32 s47, v27
    s_add_u32 s54, s54, s86
    s_and_b32 s47, s47, 0x7ffffff
    s_cmp_eq_u32 s54, 1145324612
    s_cselect_b32 s47, s47, 0
    s_bitset1_b32 s47, 30
L_sync2:
    s_mov_b64 exec, 1
    v_mov_b32 v30, s47
    ds_write_b32 v29, v30
    s_mov_b64 exec, -1
    s_waitcnt lgkmcnt(0)
    s_barrier
    ds_read_b32 v30, v29
    s_waitcnt lgkmcnt(0)
    v_readlane_b32 s53, v30, 1
    v_readlane_b32 s54, v30, 2
    v_readlane_b32 s55, v30, 3
    s_or_b32 s82, s82, s47
    s_or_b32 s53, s53, s54
    s_or_b32 s82, s82, s55
    s_or_b32 s82, s82, s53
L_bad:
    s_bitcmp1_b32 s82, 30
    s_cbranch_scc1 L_next
    s_waitcnt lgkmcnt(0)
    s_barrier
    s_cmp_eq_u32 s3, 0
    s_cbranch_scc0 L_bad2
    s_mov_b64 exec, 1
    s_lshl_b32 s54, 1, s83
    v_mov_b32 v30, 0
    v_mov_b32 v31, s54
    buffer_atomic_or_x2 v[30:31], v28, s[40:43], s46 offen sc0
    s_waitcnt vmcnt(0)
    ds_write_b32 v28, v30
    s_mov_b64 exec, -1
    s_waitcnt lgkmcnt(0)
L_bad2:
    s_barrier
    ds_read_b32 v30, v28
    s_waitcnt lgkmcnt(0)
    v_readfirstlane_b32 s54, v30
    s_and_b32 s82, s82, 0x7ffffff
    s_cmp_eq_u32 s54, 1145324612
    s_cbranch_scc1 L_again
    s_branch L_next
L_exit:
    s_endpgm
L_redo:
    s_waitcnt vmcnt(0) lgkmcnt(0)
    s_barrier
    s_mov_b32 s49, -1
    s_branch L_front
L_fallback:
    s_waitcnt vmcnt(0) lgkmcnt(0)
    s_barrier
    v_mbcnt_lo_u32_b32 v220, -1, 0
    v_mbcnt_hi_u32_b32 v220, -1, v220
    v_bfe_u32 v221, v220, 2, 2
    v_lshlrev_b32 v221, 10, v221
    v_and_b32 v222, 3, v220
    v_lshl_add_u32 v221, v222, 6, v221
    v_lshrrev_b32 v223, 4, v220
    v_bfe_u32 v222, v220, 2, 1
    v_lshlrev_b32 v222, 1, v222
    v_xor_b32 v222, v222, v223
    s_lshl_b32 s52, s7, 1
    v_xor_b32 v222, s52, v222
    v_lshl_add_u32 v221, v222, 4, v221
    s_lshl_b32 s53, s7, 13
    v_add_u32 v0, s53, v221
    v_xor_b32 v1, 0x2000, v0
    v_lshlrev_b32 v221, 10, v223
    v_bfe_u32 v222, v220, 2, 2
    v_lshl_add_u32 v221, v222, 6, v221
    v_and_b32 v222, 3, v220
    v_lshl_add_u32 v221, v222, 3, v221
    v_and_b32 v222, 1, v223
    v_lshl_add_u32 v221, v222, 5, v221
    s_add_u32 s53, s53, 65536
    v_add_u32 v2, s53, v221
    v_xor_b32 v3, 32, v2
    v_xor_b32 v4, 0x2000, v2
    v_xor_b32 v5, 32, v4
    v_and_b32 v221, 3, v220
    v_lshlrev_b32 v221, 4, v221
    v_bfe_u32 v222, v220, 2, 2
    v_lshl_add_u32 v221, v222, 8, v221
    v_lshl_add_u32 v6, v223, 6, v221
    v_xor_b32 v7, 32, v6
    v_mov_b32 v8, v6
    v_mov_b32 v9, v7
    s_mov_b32 s48, 0
    s_mov_b32 s46, s81
    s_mov_b32 m0, s81
    v_accvgpr_write_b32 a0, 0
    v_accvgpr_write_b32 a1, 0
    v_accvgpr_write_b32 a2, 0
    v_accvgpr_write_b32 a3, 0
    v_accvgpr_write_b32 a4, 0
    v_accvgpr_write_b32 a5, 0
    v_accvgpr_write_b32 a6, 0
    v_accvgpr_write_b32 a7, 0
    v_accvgpr_write_b32 a8, 0
    v_accvgpr_write_b32 a9, 0
    v_accvgpr_write_b32 a10, 0
    v_accvgpr_write_b32 a11, 0
    v_accvgpr_write_b32 a12, 0
    v_accvgpr_write_b32 a13, 0
    v_accvgpr_write_b32 a14, 0
    v_accvgpr_write_b32 a15, 0
    v_accvgpr_write_b32 a16, 0
    v_accvgpr_write_b32 a17, 0
    v_accvgpr_write_b32 a18, 0
    v_accvgpr_write_b32 a19, 0
    v_accvgpr_write_b32 a20, 0
    v_accvgpr_write_b32 a21, 0
    v_accvgpr_write_b32 a22, 0
    v_accvgpr_write_b32 a23, 0
    v_accvgpr_write_b32 a24, 0
    v_accvgpr_write_b32 a25, 0
    v_accvgpr_write_b32 a26, 0
    v_accvgpr_write_b32 a27, 0
    v_accvgpr_write_b32 a28, 0
    v_accvgpr_write_b32 a29, 0
    v_accvgpr_write_b32 a30, 0
    v_accvgpr_write_b32 a31, 0
    v_accvgpr_write_b32 a32, 0
    v_accvgpr_write_b32 a33, 0
    v_accvgpr_write_b32 a34, 0
    v_accvgpr_write_b32 a35, 0
    v_accvgpr_write_b32 a36, 0
    v_accvgpr_write_b32 a37, 0
    v_accvgpr_write_b32 a38, 0
    v_accvgpr_write_b32 a39, 0
    v_accvgpr_write_b32 a40, 0
    v_accvgpr_write_b32 a41, 0
    v_accvgpr_write_b32 a42, 0
    v_accvgpr_write_b32 a43, 0
    v_accvgpr_write_b32 a44, 0
    v_accvgpr_write_b32 a45, 0
    v_accvgpr_write_b32 a46, 0
    v_accvgpr_write_b32 a47, 0
    v_accvgpr_write_b32 a48, 0
    v_accvgpr_write_b32 a49, 0
    v_accvgpr_write_b32 a50, 0
    v_accvgpr_write_b32 a51, 0
    v_accvgpr_write_b32 a52, 0
    v_accvgpr_write_b32 a53, 0
    v_accvgpr_write_b32 a54, 0
    v_accvgpr_write_b32 a55, 0
    v_accvgpr_write_b32 a56, 0
    v_accvgpr_write_b32 a57, 0
    v_accvgpr_write_b32 a58, 0
    v_accvgpr_write_b32 a59, 0
    v_accvgpr_write_b32 a60, 0
    v_accvgpr_write_b32 a61, 0
    v_accvgpr_write_b32 a62, 0
    v_accvgpr_write_b32 a63, 0
    v_accvgpr_write_b32 a64, 0
    v_accvgpr_write_b32 a65, 0
    v_accvgpr_write_b32 a66, 0
    v_accvgpr_write_b32 a67, 0
    v_accvgpr_write_b32 a68, 0
    v_accvgpr_write_b32 a69, 0
    v_accvgpr_write_b32 a70, 0
    v_accvgpr_write_b32 a71, 0
    v_accvgpr_write_b32 a72, 0
    v_accvgpr_write_b32 a73, 0
    v_accvgpr_write_b32 a74, 0
    v_accvgpr_write_b32 a75, 0
    v_accvgpr_write_b32 a76, 0
    v_accvgpr_write_b32 a77, 0
    v_accvgpr_write_b32 a78, 0
    v_accvgpr_write_b32 a79, 0
    v_accvgpr_write_b32 a80, 0
    v_accvgpr_write_b32 a81, 0
    v_accvgpr_write_b32 a82, 0
    v_accvgpr_write_b32 a83, 0
    v_accvgpr_write_b32 a84, 0
    v_accvgpr_write_b32 a85, 0
    v_accvgpr_write_b32 a86, 0
    v_accvgpr_write_b32 a87, 0
    v_accvgpr_write_b32 a88, 0
    v_accvgpr_write_b32 a89, 0
    v_accvgpr_write_b32 a90, 0
    v_accvgpr_write_b32 a91, 0
    v_accvgpr_write_b32 a92, 0
    v_accvgpr_write_b32 a93, 0
    v_accvgpr_write_b32 a94, 0
    v_accvgpr_write_b32 a95, 0
    v_accvgpr_write_b32 a96, 0
    v_accvgpr_write_b32 a97, 0
    v_accvgpr_write_b32 a98, 0
    v_accvgpr_write_b32 a99, 0
    v_accvgpr_write_b32 a100, 0
    v_accvgpr_write_b32 a101, 0
    v_accvgpr_write_b32 a102, 0
    v_accvgpr_write_b32 a103, 0
    v_accvgpr_write_b32 a104, 0
    v_accvgpr_write_b32 a105, 0
    v_accvgpr_write_b32 a106, 0
    v_accvgpr_write_b32 a107, 0
    v_accvgpr_write_b32 a108, 0
    v_accvgpr_write_b32 a109, 0
    v_accvgpr_write_b32 a110, 0
    v_accvgpr_write_b32 a111, 0
    v_accvgpr_write_b32 a112, 0
    v_accvgpr_write_b32 a113, 0
    v_accvgpr_write_b32 a114, 0
    v_accvgpr_write_b32 a115, 0
    v_accvgpr_write_b32 a116, 0
    v_accvgpr_write_b32 a117, 0
    v_accvgpr_write_b32 a118, 0
    v_accvgpr_write_b32 a119, 0
    v_accvgpr_write_b32 a120, 0
    v_accvgpr_write_b32 a121, 0
    v_accvgpr_write_b32 a122, 0
    v_accvgpr_write_b32 a123, 0
    v_accvgpr_write_b32 a124, 0
    v_accvgpr_write_b32 a125, 0
    v_accvgpr_write_b32 a126, 0
    v_accvgpr_write_b32 a127, 0
    v_accvgpr_write_b32 a128, 0
    v_accvgpr_write_b32 a129, 0
    v_accvgpr_write_b32 a130, 0
    v_accvgpr_write_b32 a131, 0
    v_accvgpr_write_b32 a132, 0
    v_accvgpr_write_b32 a133, 0
    v_accvgpr_write_b32 a134, 0
    v_accvgpr_write_b32 a135, 0
    v_accvgpr_write_b32 a136, 0
    v_accvgpr_write_b32 a137, 0
    v_accvgpr_write_b32 a138, 0
    v_accvgpr_write_b32 a139, 0
    v_accvgpr_write_b32 a140, 0
    v_accvgpr_write_b32 a141, 0
    v_accvgpr_write_b32 a142, 0
    v_accvgpr_write_b32 a143, 0
    v_accvgpr_write_b32 a144, 0
    v_accvgpr_write_b32 a145, 0
    v_accvgpr_write_b32 a146, 0
    v_accvgpr_write_b32 a147, 0
    v_accvgpr_write_b32 a148, 0
    v_accvgpr_write_b32 a149, 0
    v_accvgpr_write_b32 a150, 0
    v_accvgpr_write_b32 a151, 0
    v_accvgpr_write_b32 a152, 0
    v_accvgpr_write_b32 a153, 0
    v_accvgpr_write_b32 a154, 0
    v_accvgpr_write_b32 a155, 0
    v_accvgpr_write_b32 a156, 0
    v_accvgpr_write_b32 a157, 0
    v_accvgpr_write_b32 a158, 0
    v_accvgpr_write_b32 a159, 0
    v_accvgpr_write_b32 a160, 0
    v_accvgpr_write_b32 a161, 0
    v_accvgpr_write_b32 a162, 0
    v_accvgpr_write_b32 a163, 0
    v_accvgpr_write_b32 a164, 0
    v_accvgpr_write_b32 a165, 0
    v_accvgpr_write_b32 a166, 0
    v_accvgpr_write_b32 a167, 0
    v_accvgpr_write_b32 a168, 0
    v_accvgpr_write_b32 a169, 0
    v_accvgpr_write_b32 a170, 0
    v_accvgpr_write_b32 a171, 0
    v_accvgpr_write_b32 a172, 0
    v_accvgpr_write_b32 a173, 0
    v_accvgpr_write_b32 a174, 0
    v_accvgpr_write_b32 a175, 0
    v_accvgpr_write_b32 a176, 0
    v_accvgpr_write_b32 a177, 0
    v_accvgpr_write_b32 a178, 0
    v_accvgpr_write_b32 a179, 0
    v_mov_b32 v10, 0
    v_mov_b32 v11, 0
    v_mov_b32 v12, 0
    v_mov_b32 v224, 0xff61b1e6
    v_mov_b32 v225, 0xff61b1e6
    v_mov_b32 v226, 0xff61b1e6
    v_mov_b32 v227, 0xff61b1e6
    v_mov_b32 v228, 0xff61b1e6
L_fb_loop:
    buffer_load_dwordx4 v6, s[28:31], s46 offen offset:0 lds
    buffer_load_dwordx4 v7, s[28:31], s46 offen offset:1024 lds
    buffer_load_dwordx4 v6, s[28:31], s46 offen offset:2048 lds
    buffer_load_dwordx4 v7, s[28:31], s46 offen offset:3072 lds
    s_waitcnt vmcnt(0)
    s_barrier
    ds_read_b128 a[192:195], v0 offset:0
    ds_read_b128 a[196:199], v0 offset:256
    ds_read_b128 a[200:203], v0 offset:512
    ds_read_b128 a[204:207], v0 offset:768
    ds_read_b128 a[208:211], v0 offset:4096
    ds_read_b128 a[212:215], v0 offset:4352
    ds_read_b128 a[216:219], v0 offset:4608
    ds_read_b128 a[220:223], v0 offset:4864
    s_waitcnt lgkmcnt(0)
    v_mfma_f32_16x16x32_bf16 v[132:135], a[192:195], v[32:35], 0
    v_mfma_f32_16x16x32_bf16 v[132:135], a[196:199], v[36:39], v[132:135]
    v_mfma_f32_16x16x32_bf16 v[132:135], a[200:203], v[40:43], v[132:135]
    v_mfma_f32_16x16x32_bf16 v[132:135], a[204:207], v[44:47], v[132:135]
    v_mfma_f32_16x16x32_bf16 v[136:139], a[208:211], v[32:35], 0
    v_mfma_f32_16x16x32_bf16 v[136:139], a[212:215], v[36:39], v[136:139]
    v_mfma_f32_16x16x32_bf16 v[136:139], a[216:219], v[40:43], v[136:139]
    v_mfma_f32_16x16x32_bf16 v[136:139], a[220:223], v[44:47], v[136:139]
    v_mfma_f32_16x16x32_bf16 v[140:143], a[192:195], v[48:51], 0
    v_mfma_f32_16x16x32_bf16 v[140:143], a[196:199], v[52:55], v[140:143]
    v_mfma_f32_16x16x32_bf16 v[140:143], a[200:203], v[56:59], v[140:143]
    v_mfma_f32_16x16x32_bf16 v[140:143], a[204:207], v[60:63], v[140:143]
    v_mfma_f32_16x16x32_bf16 v[144:147], a[208:211], v[48:51], 0
    v_mfma_f32_16x16x32_bf16 v[144:147], a[212:215], v[52:55], v[144:147]
    v_mfma_f32_16x16x32_bf16 v[144:147], a[216:219], v[56:59], v[144:147]
    v_mfma_f32_16x16x32_bf16 v[144:147], a[220:223], v[60:63], v[144:147]
    v_mfma_f32_16x16x32_bf16 v[148:151], a[192:195], v[64:67], 0
    v_mfma_f32_16x16x32_bf16 v[148:151], a[196:199], v[68:71], v[148:151]
    v_mfma_f32_16x16x32_bf16 v[148:151], a[200:203], v[72:75], v[148:151]
    v_mfma_f32_16x16x32_bf16 v[148:151], a[204:207], v[76:79], v[148:151]
    v_mfma_f32_16x16x32_bf16 v[152:155], a[208:211], v[64:67], 0
    v_mfma_f32_16x16x32_bf16 v[152:155], a[212:215], v[68:71], v[152:155]
    v_mfma_f32_16x16x32_bf16 v[152:155], a[216:219], v[72:75], v[152:155]
    v_mfma_f32_16x16x32_bf16 v[152:155], a[220:223], v[76:79], v[152:155]
    v_mfma_f32_16x16x32_bf16 v[156:159], a[192:195], v[80:83], 0
    v_mfma_f32_16x16x32_bf16 v[156:159], a[196:199], v[84:87], v[156:159]
    v_mfma_f32_16x16x32_bf16 v[156:159], a[200:203], v[88:91], v[156:159]
    v_mfma_f32_16x16x32_bf16 v[156:159], a[204:207], v[92:95], v[156:159]
    v_mfma_f32_16x16x32_bf16 v[160:163], a[208:211], v[80:83], 0
    v_mfma_f32_16x16x32_bf16 v[160:163], a[212:215], v[84:87], v[160:163]
    v_mfma_f32_16x16x32_bf16 v[160:163], a[216:219], v[88:91], v[160:163]
    v_mfma_f32_16x16x32_bf16 v[160:163], a[220:223], v[92:95], v[160:163]
    v_mfma_f32_16x16x32_bf16 v[164:167], a[192:195], v[96:99], 0
    v_mfma_f32_16x16x32_bf16 v[164:167], a[196:199], v[100:103], v[164:167]
    v_mfma_f32_16x16x32_bf16 v[164:167], a[200:203], v[104:107], v[164:167]
    v_mfma_f32_16x16x32_bf16 v[164:167], a[204:207], v[108:111], v[164:167]
    v_mfma_f32_16x16x32_bf16 v[168:171], a[208:211], v[96:99], 0
    v_mfma_f32_16x16x32_bf16 v[168:171], a[212:215], v[100:103], v[168:171]
    v_mfma_f32_16x16x32_bf16 v[168:171], a[216:219], v[104:107], v[168:171]
    v_mfma_f32_16x16x32_bf16 v[168:171], a[220:223], v[108:111], v[168:171]
    s_nop 7
    v_max3_f32 v224, v224, v132, v133
    v_max3_f32 v224, v224, v134, v135
    v_max3_f32 v224, v224, v136, v137
    v_max3_f32 v224, v224, v138, v139
    v_max3_f32 v225, v225, v140, v141
    v_max3_f32 v225, v225, v142, v143
    v_max3_f32 v225, v225, v144, v145
    v_max3_f32 v225, v225, v146, v147
    v_max3_f32 v226, v226, v148, v149
    v_max3_f32 v226, v226, v150, v151
    v_max3_f32 v226, v226, v152, v153
    v_max3_f32 v226, v226, v154, v155
    v_max3_f32 v227, v227, v156, v157
    v_max3_f32 v227, v227, v158, v159
    v_max3_f32 v227, v227, v160, v161
    v_max3_f32 v227, v227, v162, v163
    v_max3_f32 v228, v228, v164, v165
    v_max3_f32 v228, v228, v166, v167
    v_max3_f32 v228, v228, v168, v169
    v_max3_f32 v228, v228, v170, v171
    s_nop 1
    ds_read_b128 a[192:195], v1 offset:0
    ds_read_b128 a[196:199], v1 offset:256
    ds_read_b128 a[200:203], v1 offset:512
    ds_read_b128 a[204:207], v1 offset:768
    ds_read_b128 a[208:211], v1 offset:4096
    ds_read_b128 a[212:215], v1 offset:4352
    ds_read_b128 a[216:219], v1 offset:4608
    ds_read_b128 a[220:223], v1 offset:4864
    s_waitcnt lgkmcnt(0)
    v_mfma_f32_16x16x32_bf16 v[132:135], a[192:195], v[32:35], 0
    v_mfma_f32_16x16x32_bf16 v[132:135], a[196:199], v[36:39], v[132:135]
    v_mfma_f32_16x16x32_bf16 v[132:135], a[200:203], v[40:43], v[132:135]
    v_mfma_f32_16x16x32_bf16 v[132:135], a[204:207], v[44:47], v[132:135]
    v_mfma_f32_16x16x32_bf16 v[136:139], a[208:211], v[32:35], 0
    v_mfma_f32_16x16x32_bf16 v[136:139], a[212:215], v[36:39], v[136:139]
    v_mfma_f32_16x16x32_bf16 v[136:139], a[216:219], v[40:43], v[136:139]
    v_mfma_f32_16x16x32_bf16 v[136:139], a[220:223], v[44:47], v[136:139]
    v_mfma_f32_16x16x32_bf16 v[140:143], a[192:195], v[48:51], 0
    v_mfma_f32_16x16x32_bf16 v[140:143], a[196:199], v[52:55], v[140:143]
    v_mfma_f32_16x16x32_bf16 v[140:143], a[200:203], v[56:59], v[140:143]
    v_mfma_f32_16x16x32_bf16 v[140:143], a[204:207], v[60:63], v[140:143]
    v_mfma_f32_16x16x32_bf16 v[144:147], a[208:211], v[48:51], 0
    v_mfma_f32_16x16x32_bf16 v[144:147], a[212:215], v[52:55], v[144:147]
    v_mfma_f32_16x16x32_bf16 v[144:147], a[216:219], v[56:59], v[144:147]
    v_mfma_f32_16x16x32_bf16 v[144:147], a[220:223], v[60:63], v[144:147]
    v_mfma_f32_16x16x32_bf16 v[148:151], a[192:195], v[64:67], 0
    v_mfma_f32_16x16x32_bf16 v[148:151], a[196:199], v[68:71], v[148:151]
    v_mfma_f32_16x16x32_bf16 v[148:151], a[200:203], v[72:75], v[148:151]
    v_mfma_f32_16x16x32_bf16 v[148:151], a[204:207], v[76:79], v[148:151]
    v_mfma_f32_16x16x32_bf16 v[152:155], a[208:211], v[64:67], 0
    v_mfma_f32_16x16x32_bf16 v[152:155], a[212:215], v[68:71], v[152:155]
    v_mfma_f32_16x16x32_bf16 v[152:155], a[216:219], v[72:75], v[152:155]
    v_mfma_f32_16x16x32_bf16 v[152:155], a[220:223], v[76:79], v[152:155]
    v_mfma_f32_16x16x32_bf16 v[156:159], a[192:195], v[80:83], 0
    v_mfma_f32_16x16x32_bf16 v[156:159], a[196:199], v[84:87], v[156:159]
    v_mfma_f32_16x16x32_bf16 v[156:159], a[200:203], v[88:91], v[156:159]
    v_mfma_f32_16x16x32_bf16 v[156:159], a[204:207], v[92:95], v[156:159]
    v_mfma_f32_16x16x32_bf16 v[160:163], a[208:211], v[80:83], 0
    v_mfma_f32_16x16x32_bf16 v[160:163], a[212:215], v[84:87], v[160:163]
    v_mfma_f32_16x16x32_bf16 v[160:163], a[216:219], v[88:91], v[160:163]
    v_mfma_f32_16x16x32_bf16 v[160:163], a[220:223], v[92:95], v[160:163]
    v_mfma_f32_16x16x32_bf16 v[164:167], a[192:195], v[96:99], 0
    v_mfma_f32_16x16x32_bf16 v[164:167], a[196:199], v[100:103], v[164:167]
    v_mfma_f32_16x16x32_bf16 v[164:167], a[200:203], v[104:107], v[164:167]
    v_mfma_f32_16x16x32_bf16 v[164:167], a[204:207], v[108:111], v[164:167]
    v_mfma_f32_16x16x32_bf16 v[168:171], a[208:211], v[96:99], 0
    v_mfma_f32_16x16x32_bf16 v[168:171], a[212:215], v[100:103], v[168:171]
    v_mfma_f32_16x16x32_bf16 v[168:171], a[216:219], v[104:107], v[168:171]
    v_mfma_f32_16x16x32_bf16 v[168:171], a[220:223], v[108:111], v[168:171]
    s_nop 7
    v_max3_f32 v224, v224, v132, v133
    v_max3_f32 v224, v224, v134, v135
    v_max3_f32 v224, v224, v136, v137
    v_max3_f32 v224, v224, v138, v139
    v_max3_f32 v225, v225, v140, v141
    v_max3_f32 v225, v225, v142, v143
    v_max3_f32 v225, v225, v144, v145
    v_max3_f32 v225, v225, v146, v147
    v_max3_f32 v226, v226, v148, v149
    v_max3_f32 v226, v226, v150, v151
    v_max3_f32 v226, v226, v152, v153
    v_max3_f32 v226, v226, v154, v155
    v_max3_f32 v227, v227, v156, v157
    v_max3_f32 v227, v227, v158, v159
    v_max3_f32 v227, v227, v160, v161
    v_max3_f32 v227, v227, v162, v163
    v_max3_f32 v228, v228, v164, v165
    v_max3_f32 v228, v228, v166, v167
    v_max3_f32 v228, v228, v168, v169
    v_max3_f32 v228, v228, v170, v171
    s_nop 1
    s_barrier
    s_add_u32 s46, s46, 16384
    s_add_u32 s48, s48, 1
    s_cmp_lt_u32 s48, 16
    s_cbranch_scc1 L_fb_loop
    v_mov_b32 v220, v224
    s_nop 1
    v_permlane32_swap_b32 v224, v220
    v_max_f32 v224, v224, v220
    v_mov_b32 v220, v224
    s_nop 1
    v_permlane16_swap_b32 v224, v220
    v_min_f32_e64 v112, -v224, -v220
    v_min_f32_e64 v113, -v224, -v220
    v_min_f32_e64 v114, -v224, -v220
    v_min_f32_e64 v115, -v224, -v220
    v_mov_b32 v220, v225
    s_nop 1
    v_permlane32_swap_b32 v225, v220
    v_max_f32 v225, v225, v220
    v_mov_b32 v220, v225
    s_nop 1
    v_permlane16_swap_b32 v225, v220
    v_min_f32_e64 v116, -v225, -v220
    v_min_f32_e64 v117, -v225, -v220
    v_min_f32_e64 v118, -v225, -v220
    v_min_f32_e64 v119, -v225, -v220
    v_mov_b32 v220, v226
    s_nop 1
    v_permlane32_swap_b32 v226, v220
    v_max_f32 v226, v226, v220
    v_mov_b32 v220, v226
    s_nop 1
    v_permlane16_swap_b32 v226, v220
    v_min_f32_e64 v120, -v226, -v220
    v_min_f32_e64 v121, -v226, -v220
    v_min_f32_e64 v122, -v226, -v220
    v_min_f32_e64 v123, -v226, -v220
    v_mov_b32 v220, v227
    s_nop 1
    v_permlane32_swap_b32 v227, v220
    v_max_f32 v227, v227, v220
    v_mov_b32 v220, v227
    s_nop 1
    v_permlane16_swap_b32 v227, v220
    v_min_f32_e64 v124, -v227, -v220
    v_min_f32_e64 v125, -v227, -v220
    v_min_f32_e64 v126, -v227, -v220
    v_min_f32_e64 v127, -v227, -v220
    v_mov_b32 v220, v228
    s_nop 1
    v_permlane32_swap_b32 v228, v220
    v_max_f32 v228, v228, v220
    v_mov_b32 v220, v228
    s_nop 1
    v_permlane16_swap_b32 v228, v220
    v_min_f32_e64 v128, -v228, -v220
    v_min_f32_e64 v129, -v228, -v220
    v_min_f32_e64 v130, -v228, -v220
    v_min_f32_e64 v131, -v228, -v220
    s_add_u32 m0, s81, 0
    s_add_u32 s63, s81, 0
    buffer_load_dwordx4 v6, s[28:31], s63 offen offset:0 lds
    buffer_load_dwordx4 v7, s[28:31], s63 offen offset:1024 lds
    buffer_load_dwordx4 v6, s[28:31], s63 offen offset:2048 lds
    buffer_load_dwordx4 v7, s[28:31], s63 offen offset:3072 lds
    s_add_u32 m0, s81, 65536
    s_add_u32 s63, s81, 0
    buffer_load_dwordx4 v6, s[32:35], s63 offen offset:0 lds
    buffer_load_dwordx4 v7, s[32:35], s63 offen offset:1024 lds
    buffer_load_dwordx4 v6, s[32:35], s63 offen offset:2048 lds
    buffer_load_dwordx4 v7, s[32:35], s63 offen offset:3072 lds
    s_add_u32 m0, s81, 16384
    s_add_u32 s63, s81, 16384
    buffer_load_dwordx4 v6, s[28:31], s63 offen offset:0 lds
    buffer_load_dwordx4 v7, s[28:31], s63 offen offset:1024 lds
    buffer_load_dwordx4 v6, s[28:31], s63 offen offset:2048 lds
    buffer_load_dwordx4 v7, s[28:31], s63 offen offset:3072 lds
    s_add_u32 m0, s81, 81920
    s_add_u32 s63, s81, 16384
    buffer_load_dwordx4 v6, s[32:35], s63 offen offset:0 lds
    buffer_load_dwordx4 v7, s[32:35], s63 offen offset:1024 lds
    buffer_load_dwordx4 v6, s[32:35], s63 offen offset:2048 lds
    buffer_load_dwordx4 v7, s[32:35], s63 offen offset:3072 lds
    s_add_u32 m0, s81, 32768
    s_add_u32 s63, s81, 32768
    buffer_load_dwordx4 v6, s[28:31], s63 offen offset:0 lds
    buffer_load_dwordx4 v7, s[28:31], s63 offen offset:1024 lds
    buffer_load_dwordx4 v6, s[28:31], s63 offen offset:2048 lds
    buffer_load_dwordx4 v7, s[28:31], s63 offen offset:3072 lds
    s_add_u32 m0, s81, 98304
    s_add_u32 s63, s81, 32768
    buffer_load_dwordx4 v6, s[32:35], s63 offen offset:0 lds
    buffer_load_dwordx4 v7, s[32:35], s63 offen offset:1024 lds
    buffer_load_dwordx4 v6, s[32:35], s63 offen offset:2048 lds
    buffer_load_dwordx4 v7, s[32:35], s63 offen offset:3072 lds
    s_add_u32 m0, s81, 49152
    s_add_u32 s63, s81, 49152
    buffer_load_dwordx4 v6, s[28:31], s63 offen offset:0 lds
    buffer_load_dwordx4 v7, s[28:31], s63 offen offset:1024 lds
    buffer_load_dwordx4 v6, s[28:31], s63 offen offset:2048 lds
    buffer_load_dwordx4 v7, s[28:31], s63 offen offset:3072 lds
    s_waitcnt vmcnt(0)
    s_barrier
    ds_read_b128 a[192:195], v0 offset:0
    ds_read_b128 a[196:199], v0 offset:256
    ds_read_b128 a[200:203], v0 offset:512
    ds_read_b128 a[204:207], v0 offset:768
    ds_read_b128 a[208:211], v0 offset:4096
    ds_read_b128 a[212:215], v0 offset:4352
    ds_read_b128 a[216:219], v0 offset:4608
    ds_read_b128 a[220:223], v0 offset:4864
    s_waitcnt lgkmcnt(0)
    v_mfma_f32_16x16x32_bf16 v[132:135], a[192:195], v[32:35], v[112:115]
    v_mfma_f32_16x16x32_bf16 v[132:135], a[196:199], v[36:39], v[132:135]
    v_mfma_f32_16x16x32_bf16 v[132:135], a[200:203], v[40:43], v[132:135]
    v_mfma_f32_16x16x32_bf16 v[132:135], a[204:207], v[44:47], v[132:135]
    v_mfma_f32_16x16x32_bf16 v[136:139], a[208:211], v[32:35], v[112:115]
    v_mfma_f32_16x16x32_bf16 v[136:139], a[212:215], v[36:39], v[136:139]
    v_mfma_f32_16x16x32_bf16 v[136:139], a[216:219], v[40:43], v[136:139]
    v_mfma_f32_16x16x32_bf16 v[136:139], a[220:223], v[44:47], v[136:139]
    v_mfma_f32_16x16x32_bf16 v[140:143], a[192:195], v[48:51], v[116:119]
    v_mfma_f32_16x16x32_bf16 v[140:143], a[196:199], v[52:55], v[140:143]
    v_mfma_f32_16x16x32_bf16 v[140:143], a[200:203], v[56:59], v[140:143]
    v_mfma_f32_16x16x32_bf16 v[140:143], a[204:207], v[60:63], v[140:143]
    v_mfma_f32_16x16x32_bf16 v[144:147], a[208:211], v[48:51], v[116:119]
    v_mfma_f32_16x16x32_bf16 v[144:147], a[212:215], v[52:55], v[144:147]
    v_mfma_f32_16x16x32_bf16 v[144:147], a[216:219], v[56:59], v[144:147]
    v_mfma_f32_16x16x32_bf16 v[144:147], a[220:223], v[60:63], v[144:147]
    v_mfma_f32_16x16x32_bf16 v[148:151], a[192:195], v[64:67], v[120:123]
    v_mfma_f32_16x16x32_bf16 v[148:151], a[196:199], v[68:71], v[148:151]
    v_mfma_f32_16x16x32_bf16 v[148:151], a[200:203], v[72:75], v[148:151]
    v_mfma_f32_16x16x32_bf16 v[148:151], a[204:207], v[76:79], v[148:151]
    v_mfma_f32_16x16x32_bf16 v[152:155], a[208:211], v[64:67], v[120:123]
    v_mfma_f32_16x16x32_bf16 v[152:155], a[212:215], v[68:71], v[152:155]
    v_mfma_f32_16x16x32_bf16 v[152:155], a[216:219], v[72:75], v[152:155]
    v_mfma_f32_16x16x32_bf16 v[152:155], a[220:223], v[76:79], v[152:155]
    v_mfma_f32_16x16x32_bf16 v[156:159], a[192:195], v[80:83], v[124:127]
    v_mfma_f32_16x16x32_bf16 v[156:159], a[196:199], v[84:87], v[156:159]
    v_mfma_f32_16x16x32_bf16 v[156:159], a[200:203], v[88:91], v[156:159]
    v_mfma_f32_16x16x32_bf16 v[156:159], a[204:207], v[92:95], v[156:159]
    v_mfma_f32_16x16x32_bf16 v[160:163], a[208:211], v[80:83], v[124:127]
    v_mfma_f32_16x16x32_bf16 v[160:163], a[212:215], v[84:87], v[160:163]
    v_mfma_f32_16x16x32_bf16 v[160:163], a[216:219], v[88:91], v[160:163]
    v_mfma_f32_16x16x32_bf16 v[160:163], a[220:223], v[92:95], v[160:163]
    v_mfma_f32_16x16x32_bf16 v[164:167], a[192:195], v[96:99], v[128:131]
    v_mfma_f32_16x16x32_bf16 v[164:167], a[196:199], v[100:103], v[164:167]
    v_mfma_f32_16x16x32_bf16 v[164:167], a[200:203], v[104:107], v[164:167]
    v_mfma_f32_16x16x32_bf16 v[164:167], a[204:207], v[108:111], v[164:167]
    v_mfma_f32_16x16x32_bf16 v[168:171], a[208:211], v[96:99], v[128:131]
    v_mfma_f32_16x16x32_bf16 v[168:171], a[212:215], v[100:103], v[168:171]
    v_mfma_f32_16x16x32_bf16 v[168:171], a[216:219], v[104:107], v[168:171]
    v_mfma_f32_16x16x32_bf16 v[168:171], a[220:223], v[108:111], v[168:171]
    ds_read_b128 a[192:195], v1 offset:0
    ds_read_b128 a[196:199], v1 offset:256
    ds_read_b128 a[200:203], v1 offset:512
    ds_read_b128 a[204:207], v1 offset:768
    ds_read_b128 a[208:211], v1 offset:4096
    ds_read_b128 a[212:215], v1 offset:4352
    ds_read_b128 a[216:219], v1 offset:4608
    ds_read_b128 a[220:223], v1 offset:4864
    s_nop 7
    v_exp_f32 v132, v132
    v_exp_f32 v133, v133
    v_exp_f32 v134, v134
    v_exp_f32 v135, v135
    v_exp_f32 v140, v140
    v_exp_f32 v141, v141
    v_exp_f32 v142, v142
    v_exp_f32 v143, v143
    v_exp_f32 v148, v148
    v_exp_f32 v149, v149
    v_exp_f32 v150, v150
    v_exp_f32 v151, v151
    v_exp_f32 v156, v156
    v_exp_f32 v157, v157
    v_exp_f32 v158, v158
    v_exp_f32 v159, v159
    v_exp_f32 v136, v136
    v_exp_f32 v137, v137
    v_exp_f32 v138, v138
    v_exp_f32 v139, v139
    v_exp_f32 v144, v144
    v_exp_f32 v145, v145
    s_nop 0
    v_cvt_pk_bf16_f32 v132, v132, v133
    v_cvt_pk_bf16_f32 v133, v134, v135
    v_cvt_pk_bf16_f32 v140, v140, v141
    v_cvt_pk_bf16_f32 v141, v142, v143
    v_cvt_pk_bf16_f32 v148, v148, v149
    v_cvt_pk_bf16_f32 v149, v150, v151
    v_cvt_pk_bf16_f32 v156, v156, v157
    v_cvt_pk_bf16_f32 v157, v158, v159
    v_cvt_pk_bf16_f32 v134, v136, v137
    v_cvt_pk_bf16_f32 v135, v138, v139
    v_cvt_pk_bf16_f32 v142, v144, v145
    s_add_u32 s45, s81, 114688
    s_mov_b32 s44, s81
    s_mov_b32 s48, -1
    s_add_u32 s47, s81, 49152
    s_add_u32 s46, s81, 65536
    s_waitcnt lgkmcnt(0)
    s_branch L_loop_mid
L_end:
.section .rodata,"a"
.p2align 6
.amdhsa_kernel concat_heads__gqa_block_cached__gqa_block_cached__near_ridge_kernel
  .amdhsa_next_free_vgpr 512
  .amdhsa_next_free_sgpr 102
  .amdhsa_accum_offset 256
  .amdhsa_group_segment_fixed_size 0
  .amdhsa_kernarg_size 104
  .amdhsa_user_sgpr_count 2
  .amdhsa_user_sgpr_kernarg_segment_ptr 1
  .amdhsa_system_sgpr_workgroup_id_x 1
.end_amdhsa_kernel
```
